```python
import torch

def _softmax(x, axis=-1):
    return torch.softmax(x, dim=axis)

def _gelu(x):
    return torch.nn.functional.gelu(x, approximate='tanh')

def _silu(x):
    return torch.nn.functional.silu(x)

def _sigmoid(x):
    return torch.sigmoid(x)

def _layernorm(x, axis=-1, eps=1e-05):
    m = x.mean(dim=axis, keepdim=True)
    v = x.var(dim=axis, keepdim=True, unbiased=False)
    return (x - m) / torch.sqrt(v + eps)

def _scatter_add(tgt, idx, src, axis=0):
    return tgt.clone().index_add_(axis, idx, src)

def _segment_sum(src, seg, n):
    out = torch.zeros((n,) + src.shape[1:], dtype=src.dtype)
    return out.index_add_(0, seg, src)

def _pad(x, pw):
    flat = tuple((v for pair in reversed(pw) for v in pair))
    return torch.nn.functional.pad(x, flat)
kernel_name = 'adaLN_cond__spectral_gfnet__dense_activation_mish__prompt'

def setup_inputs():

    _w = lambda a: (lambda t: t.to(torch.bfloat16) if t.is_floating_point() else t)(torch.as_tensor(a))

    def _A_setup():
        B, S, D = (1, 2048, 512)
        Df = D // 2 + 1
        return {'x': _w((lambda *s: torch.randn(*s, dtype=torch.bfloat16) * 0.05)(B, S, D)), 'w_r': _w((lambda *s: torch.randn(*s, dtype=torch.bfloat16) * 1.6)(S, Df) * 0.02), 'w_i': _w((lambda *s: torch.randn(*s, dtype=torch.bfloat16) * 1.6)(S, Df) * 0.02)}
    _A_in = _A_setup()

    def _B_setup():
        B, S, D, F = (1, 2048, 512, 1376)
        return {'x': _w((lambda *s: torch.randn(*s, dtype=torch.bfloat16) * 0.05)(B, S, D)), 'w1': _w((lambda *s: torch.randn(*s, dtype=torch.bfloat16) * 0.8)(D, F) * D ** (-0.5)), 'b1': _w((lambda *s: torch.randn(*s, dtype=torch.bfloat16) * 0.4)(F)), 'w2': _w((lambda *s: torch.randn(*s, dtype=torch.bfloat16) * 0.2)(F, D) * F ** (-0.5))}
    _B_in = _B_setup()
    return {'A_x': _A_in['x'], 'A_w_r': _A_in['w_r'], 'A_w_i': _A_in['w_i'], 'B_x': _B_in['x'], 'B_w1': _B_in['w1'], 'B_b1': _B_in['b1'], 'B_w2': _B_in['w2'], 'c': _w((lambda *s: torch.randn(*s, dtype=torch.bfloat16) * 0.2)(1, 512) * 8.0), 'w_mod': _w((lambda *s: torch.randn(*s, dtype=torch.bfloat16) * 0.2)(512, 6 * 512) * 512 ** (-0.5) * 8.0)}

def reference(A_x, A_w_r, A_w_i, B_x, B_w1, B_b1, B_w2, c, w_mod):

    def _A_ref(x, w_r, w_i):
        B, S, D = x.shape
        X = (lambda x, axes=(-2, -1): torch.fft.rfft2(x.float(), dim=axes))(x, axes=(-2, -1))
        W = w_r + 1j * w_i
        X = X * W
        y = (lambda x, s, axes=(-2, -1): torch.fft.irfft2(x, s=s, dim=axes).to(torch.bfloat16))(X, (S, D), axes=(-2, -1))
        return y

    def _B_ref(x, w1, b1, w2):
        h = torch.einsum('bsd,df->bsf', x, w1) + b1
        sp = torch.log1p(torch.exp(-torch.abs(h))) + torch.where(h > 0, h, torch.zeros_like(h))
        act = h * torch.tanh(sp)
        return torch.einsum('bsf,fd->bsd', act, w2)
    x = A_x
    mod = (_silu(c) @ w_mod).reshape(c.shape[0], 6, 1, -1)
    sa, ca, ga, sb, cb, gb = (mod[:, 0].clone(), mod[:, 1].clone(), mod[:, 2].clone(), mod[:, 3].clone(), mod[:, 4].clone(), mod[:, 5].clone())
    h = _layernorm(x, axis=-1) * (1 + ca) + sa
    x = x + ga * _A_ref(h, A_w_r, A_w_i)
    h = _layernorm(x, axis=-1) * (1 + cb) + sb
    x = x + gb * _B_ref(h, B_w1, B_b1, B_w2)
    return x
```

```asm
; @launch grid=(256,1,1) block=(256,1,1) lds=160768
.amdgcn_target "amdgcn-amd-amdhsa--gfx950"
.text
.globl adaLN_cond__spectral_gfnet__dense_activation_mish__prompt_kernel
.p2align 8
.type adaLN_cond__spectral_gfnet__dense_activation_mish__prompt_kernel,@function
adaLN_cond__spectral_gfnet__dense_activation_mish__prompt_kernel:
    s_load_dwordx16 s[4:19], s[0:1], 0
    s_load_dwordx8 s[20:27], s[0:1], 64
    s_cmp_ge_u32 s2, 256
    s_cbranch_scc1 L_end
    s_getpc_b64 s[98:99]
    s_bfe_u32 s57, s2, 0x20003
    v_lshrrev_b32 v1, 6, v0
    v_cmp_eq_u32 vcc, s57, v1
    s_cbranch_vccz L_ipf
    v_lshlrev_b32 v1, 7, v0
    global_load_dword v1, v1, s[98:99]
L_ipf:
    s_and_b32 s57, s2, 7
    s_lshl_b32 s57, s57, 1
    s_lshr_b32 s58, s2, 7
    s_add_u32 s57, s57, s58
    s_bfe_u32 s58, s2, 0x20003
    s_lshl_b32 s59, s57, 2
    s_add_u32 s59, s59, s58
    s_bfe_u32 s60, s2, 0x20005
    s_mul_i32 s57, s60, 786432
    s_lshl_b32 s58, s59, 5
    s_add_u32 s57, s57, s58
    v_lshrrev_b32 v3, 1, v0
    v_mul_u32_u24 v9, 6144, v3
    v_and_b32 v2, 1, v0
    v_lshl_add_u32 v9, v2, 4, v9
    v_add_u32 v2, s57, v9
    s_lshl_b32 s58, s60, 8
    v_lshl_add_u32 v3, v3, 1, s58
    v_lshlrev_b32 v10, 4, v0
    s_lshl_b32 s58, s2, 13
    s_add_u32 s58, s58, 2099200
    v_add_u32 v11, s58, v10
    v_mov_b32 v12, -1
    v_mov_b32 v13, -1
    v_mov_b32 v14, -1
    v_mov_b32 v15, -1
    s_waitcnt lgkmcnt(0)
    global_load_dwordx4 v[4:7], v2, s[20:21]
    global_load_ushort v8, v3, s[18:19]
    s_load_dword s52, s[26:27], 0
    global_store_dwordx4 v11, v[12:15], s[26:27] offset:-2048 sc1
    global_store_dwordx4 v11, v[12:15], s[26:27] offset:2048 sc1
    v_and_b32 v17, 63, v0
    v_lshlrev_b32 v20, 4, v17
    s_lshl_b32 s60, s60, 13
    s_lshl_b32 s59, s59, 7
    s_add_u32 s59, s59, s60
    s_add_u32 s59, s59, 163840
    v_add_u32 v16, s59, v20
    v_lshrrev_b32 v18, 6, v0
    s_nop 0
    v_readfirstlane_b32 s53, v18
    v_and_b32 v18, 15, v0
    v_lshrrev_b32 v19, 4, v17
    s_lshr_b32 s54, s2, 7
    s_and_b32 s55, s2, 31
    s_lshr_b32 s56, s2, 5
    s_mov_b32 s61, 200000
    s_getreg_b32 s76, hwreg(HW_REG_XCC_ID, 0, 4)
    s_lshl_b32 s78, s55, 3
    s_add_u32 s78, s78, s56
    s_mov_b32 s64, 196611
    s_mov_b32 s65, 196611
    s_mov_b32 s66, 65537
    s_mov_b32 s67, 65537
    s_mov_b32 s68, 0xffff
    s_mov_b32 s69, 0
    s_mov_b32 s28, s12
    s_mov_b32 s29, s13
    s_mov_b32 s30, 1409024
    s_mov_b32 s31, 0x20000
    s_mov_b32 s32, s16
    s_mov_b32 s33, s17
    s_mov_b32 s34, 1409024
    s_mov_b32 s35, 0x20000
    s_mov_b32 s36, s26
    s_mov_b32 s37, s27
    s_mov_b32 s38, 23068672
    s_mov_b32 s39, 0x20000
    s_mov_b32 s40, s14
    s_mov_b32 s41, s15
    s_mov_b32 s42, 2752
    s_mov_b32 s43, 0x20000
    s_mov_b32 s44, s6
    s_mov_b32 s45, s7
    s_mov_b32 s46, 1052672
    s_mov_b32 s47, 0x20000
    s_mov_b32 s48, s8
    s_mov_b32 s49, s9
    s_mov_b32 s50, 1052672
    s_mov_b32 s51, 0x20000
    v_mov_b32 v22, 0x3727c5ac
    v_and_b32 v24, 1, v0
    v_lshl_add_u32 v24, v24, 2, v19
    s_lshl_b32 s57, s53, 6
    v_lshl_add_u32 v21, v24, 3, s57
    v_cvt_f32_u32 v23, v18
    v_lshlrev_b32 v24, 2, v19
    v_cvt_f32_u32 v52, v24
    s_lshr_b32 s57, s2, 4
    s_lshl_b32 s57, s57, 2
    s_add_u32 s57, s57, s53
    s_lshl_b32 s57, s57, 5
    s_and_b32 s58, s2, 15
    s_lshl_b32 s58, s58, 1
    s_add_u32 s57, s57, s58
    s_lshl_b32 s79, s57, 10
    v_add_u32 v53, s79, v20
    s_and_b32 s57, s2, 15
    s_lshl_b32 s57, s57, 2
    s_add_u32 s57, s57, s54
    s_bfe_u32 s58, s2, 0x30004
    s_lshl_b32 s58, s58, 8
    s_add_u32 s80, s57, s58
    v_bfe_u32 v24, v17, 1, 2
    v_xor_b32 v24, v24, v19
    v_lshlrev_b32 v24, 5, v24
    v_and_b32 v26, 1, v17
    v_lshl_add_u32 v24, v26, 4, v24
    v_lshrrev_b32 v25, 3, v17
    v_mov_b32 v27, 2752
    v_mad_u32_u24 v54, v25, v27, v24
    v_lshl_add_u32 v25, v25, 10, v24
    s_lshl_b32 s57, s56, 7
    v_add_u32 v42, s57, v25
    v_add_u32 v43, 7168, v42
    s_mul_i32 s72, s53, 360448
    s_cmp_eq_u32 s53, 3
    s_cselect_b32 s57, 16384, 0
    s_cselect_b32 s58, 0x1000000, 0
    s_sub_u32 s73, s72, s57
    s_sub_u32 s74, s73, s57
    s_add_u32 s75, s72, s58
    s_mul_i32 s70, s53, 21504
    s_add_u32 s70, s70, 66560
    s_mul_i32 s71, s53, 9216
    s_add_u32 s71, s71, 26624
    v_lshrrev_b32 v24, 2, v17
    v_and_b32 v25, 3, v17
    v_lshlrev_b32 v25, 3, v25
    v_lshl_add_u32 v26, v24, 7, v25
    v_bfe_u32 v27, v17, 3, 2
    s_add_u32 s57, s53, 0
    s_and_b32 s57, s57, 3
    v_xor_b32 v28, s57, v27
    v_lshl_add_u32 v28, v28, 5, v26
    v_add_u32 v44, s70, v28
    v_add_u32 v48, s71, v28
    s_add_u32 s57, s53, 1
    s_and_b32 s57, s57, 3
    v_xor_b32 v28, s57, v27
    v_lshl_add_u32 v28, v28, 5, v26
    v_add_u32 v45, s70, v28
    v_add_u32 v49, s71, v28
    s_add_u32 s57, s53, 2
    s_and_b32 s57, s57, 3
    v_xor_b32 v28, s57, v27
    v_lshl_add_u32 v28, v28, 5, v26
    v_add_u32 v46, s70, v28
    v_add_u32 v50, s71, v28
    s_add_u32 s57, s53, 3
    s_and_b32 s57, s57, 3
    v_xor_b32 v28, s57, v27
    v_lshl_add_u32 v28, v28, 5, v26
    v_add_u32 v47, s70, v28
    v_add_u32 v51, s71, v28
    s_sub_u32 s81, s53, 2
    s_lshl_b32 s81, s81, 8
    s_add_u32 s81, s81, s2
    s_and_b32 s57, s81, 15
    s_lshr_b32 s58, s81, 4
    s_mul_i32 s59, s57, 44032
    s_lshl_b32 s60, s58, 7
    s_add_u32 s82, s59, s60
    s_lshl_b32 s57, s81, 12
    s_add_u32 s57, s57, 18874368
    s_add_u32 s58, s53, 0
    s_and_b32 s58, s58, 3
    s_lshl_b32 s58, s58, 10
    s_add_u32 s84, s57, s58
    s_add_u32 s58, s53, 1
    s_and_b32 s58, s58, 3
    s_lshl_b32 s58, s58, 10
    s_add_u32 s85, s57, s58
    s_add_u32 s58, s53, 2
    s_and_b32 s58, s58, 3
    s_lshl_b32 s58, s58, 10
    s_add_u32 s86, s57, s58
    s_add_u32 s58, s53, 3
    s_and_b32 s58, s58, 3
    s_lshl_b32 s58, s58, 10
    s_add_u32 s87, s57, s58
    s_and_b32 s57, s2, 7
    s_lshl_b32 s57, s57, 2
    s_lshr_b32 s58, s2, 6
    s_add_u32 s57, s57, s58
    s_lshl_b32 s57, s57, 2
    s_bfe_u32 s58, s2, 0x20003
    s_add_u32 s57, s57, s58
    s_bfe_u32 s59, s2, 0x10005
    s_mul_i32 s58, s59, 1572864
    s_lshl_b32 s60, s57, 5
    s_add_u32 s58, s58, s60
    s_add_u32 s58, s58, 2048
    v_add_u32 v56, s58, v9
    v_add_u32 v57, 786432, v56
    s_lshl_b32 s58, s59, 9
    v_and_b32 v55, 0xfe, v0
    v_add_u32 v55, s58, v55
    s_lshl_b32 s59, s59, 13
    s_lshl_b32 s57, s57, 6
    s_add_u32 s57, s57, s59
    s_add_u32 s57, s57, 20480
    v_add_u32 v58, s57, v20
    s_lshr_b32 s57, s2, 3
    s_lshl_b32 s57, s57, 2
    s_add_u32 s57, s57, s53
    s_mul_i32 s57, s57, 24576
    s_and_b32 s58, s2, 7
    s_lshl_b32 s58, s58, 9
    s_add_u32 s57, s57, s58
    s_add_u32 s57, s57, 2048
    v_lshrrev_b32 v9, 2, v18
    v_mul_u32_u24 v9, 5632, v9
    v_lshl_add_u32 v9, v18, 7, v9
    v_add_u32 v9, s57, v9
    s_lshl_b32 s57, s2, 2
    s_add_u32 s57, s57, s53
    s_mul_i32 s57, s57, 1408
    v_lshl_add_u32 v59, v18, 7, s57
    s_lshl_b32 s57, s53, 6
    s_add_u32 s57, s57, s80
    s_mul_i32 s58, s53, 2304
    s_mov_b32 exec_hi, 3
    s_add_u32 s59, s57, 0
    s_mul_i32 s59, s59, 514
    s_and_b32 s59, s59, -16
    s_add_u32 m0, s58, 0
    s_nop 0
    buffer_load_dwordx4 v20, s[44:47], s59 offen  lds
    s_add_u32 m0, s58, 576
    s_nop 0
    buffer_load_dwordx4 v20, s[48:51], s59 offen  lds
    s_add_u32 s59, s57, 2
    s_mul_i32 s59, s59, 514
    s_and_b32 s59, s59, -16
    s_add_u32 m0, s58, 1152
    s_nop 0
    buffer_load_dwordx4 v20, s[44:47], s59 offen  lds
    s_add_u32 m0, s58, 1728
    s_nop 0
    buffer_load_dwordx4 v20, s[48:51], s59 offen  lds
    s_mov_b64 exec, -1
    v_add_u32 v11, 4194304, v11
    global_store_dwordx4 v11, v[12:15], s[26:27] offset:-2048 sc1
    global_store_dwordx4 v11, v[12:15], s[26:27] offset:2048 sc1
    v_mul_f32 v36, 0x3d000000, v23
    v_mul_f32 v24, v52, v36
    v_add_f32 v25, v24, v36
    v_add_f32 v26, v25, v36
    v_add_f32 v27, v26, v36
    v_cos_f32 v28, v24
    v_sin_f32 v32, v24
    v_cos_f32 v29, v25
    v_sin_f32 v33, v25
    v_cos_f32 v30, v26
    v_sin_f32 v34, v26
    v_cos_f32 v31, v27
    v_sin_f32 v35, v27
    v_cvt_pk_bf16_f32 v64, v28, v29
    v_cvt_pk_bf16_f32 v68, -v32, -v33
    v_cvt_pk_bf16_f32 v65, v30, v31
    v_cvt_pk_bf16_f32 v69, -v34, -v35
    v_add_f32 v37, 0x41800000, v52
    v_mul_f32 v24, v37, v36
    v_add_f32 v25, v24, v36
    v_add_f32 v26, v25, v36
    v_add_f32 v27, v26, v36
    v_cos_f32 v28, v24
    v_sin_f32 v32, v24
    v_cos_f32 v29, v25
    v_sin_f32 v33, v25
    v_cos_f32 v30, v26
    v_sin_f32 v34, v26
    v_cos_f32 v31, v27
    v_sin_f32 v35, v27
    v_cvt_pk_bf16_f32 v66, v28, v29
    v_cvt_pk_bf16_f32 v70, -v32, -v33
    v_cvt_pk_bf16_f32 v67, v30, v31
    v_cvt_pk_bf16_f32 v71, -v34, -v35
    s_mov_b64 exec, s[66:67]
    v_mov_b32 v68, 0xbf803f80
    v_mov_b32 v69, 0xbf803f80
    v_mov_b32 v70, 0xbf803f80
    v_mov_b32 v71, 0xbf803f80
    s_mov_b64 exec, -1
    v_mul_f32 v36, 0x3b000000, v23
    v_mul_f32 v24, v52, v36
    v_add_f32 v25, v24, v36
    v_add_f32 v26, v25, v36
    v_add_f32 v27, v26, v36
    v_cos_f32 v72, v24
    v_sin_f32 v76, v24
    v_cos_f32 v73, v25
    v_sin_f32 v77, v25
    v_cos_f32 v74, v26
    v_sin_f32 v78, v26
    v_cos_f32 v75, v27
    v_sin_f32 v79, v27
    v_mul_f32 v36, 0x3d800000, v23
    v_mul_f32 v24, v52, v36
    v_add_f32 v25, v24, v36
    v_add_f32 v26, v25, v36
    v_add_f32 v27, v26, v36
    v_cos_f32 v28, v24
    v_sin_f32 v32, v24
    v_cos_f32 v29, v25
    v_sin_f32 v33, v25
    v_cos_f32 v30, v26
    v_sin_f32 v34, v26
    v_cos_f32 v31, v27
    v_sin_f32 v35, v27
    v_lshrrev_b32 v37, 3, v18
    v_mov_b32 v39, 2147516416
    v_mul_lo_u32 v38, v37, v39
    v_cvt_pk_bf16_f32 v80, v28, v32
    v_cvt_pk_bf16_f32 v84, -v32, v28
    v_xor_b32 v84, v84, v38
    v_cvt_pk_bf16_f32 v81, v29, v33
    v_cvt_pk_bf16_f32 v85, -v33, v29
    v_xor_b32 v85, v85, v38
    v_cvt_pk_bf16_f32 v82, v30, v34
    v_cvt_pk_bf16_f32 v86, -v34, v30
    v_xor_b32 v86, v86, v38
    v_cvt_pk_bf16_f32 v83, v31, v35
    v_cvt_pk_bf16_f32 v87, -v35, v31
    v_xor_b32 v87, v87, v38
    v_cvt_f32_u32 v38, v37
    v_fmac_f32 v36, 0xbef00000, v38
    v_lshlrev_b32 v37, 4, v37
    v_mul_f32 v24, v52, v36
    v_add_f32 v25, v24, v36
    v_add_f32 v26, v25, v36
    v_add_f32 v27, v26, v36
    v_cos_f32 v28, v24
    v_sin_f32 v32, v24
    v_cos_f32 v29, v25
    v_sin_f32 v33, v25
    v_cos_f32 v30, v26
    v_sin_f32 v34, v26
    v_cos_f32 v31, v27
    v_sin_f32 v35, v27
    s_mov_b64 exec, s[66:67]
    v_mov_b32 v32, -1.0
    v_mov_b32 v33, 1.0
    v_mov_b32 v34, -1.0
    v_mov_b32 v35, 1.0
    s_mov_b64 exec, -1
    v_cvt_pk_bf16_f32 v88, v28, 0
    v_cvt_pk_bf16_f32 v92, -v32, 0
    v_lshlrev_b32 v88, v37, v88
    v_lshlrev_b32 v92, v37, v92
    v_cvt_pk_bf16_f32 v89, v29, 0
    v_cvt_pk_bf16_f32 v93, -v33, 0
    v_lshlrev_b32 v89, v37, v89
    v_lshlrev_b32 v93, v37, v93
    v_cvt_pk_bf16_f32 v90, v30, 0
    v_cvt_pk_bf16_f32 v94, -v34, 0
    v_lshlrev_b32 v90, v37, v90
    v_lshlrev_b32 v94, v37, v94
    v_cvt_pk_bf16_f32 v91, v31, 0
    v_cvt_pk_bf16_f32 v95, -v35, 0
    v_lshlrev_b32 v91, v37, v91
    v_lshlrev_b32 v95, v37, v95
    s_and_b32 s57, s53, 1
    s_lshl_b32 s57, s57, 3
    v_lshl_add_u32 v62, v19, 1, s57
    v_bfe_u32 v24, v17, 1, 1
    v_add_u32 v62, v62, v24
    s_lshr_b32 s58, s53, 1
    v_bfe_u32 v25, v17, 2, 2
    s_lshl_b32 s59, s58, 2
    v_add_u32 v63, s59, v25
    s_lshl_b32 s58, s58, 8
    v_lshl_add_u32 v96, v62, 4, s58
    v_lshl_add_u32 v96, v25, 2, v96
    v_and_b32 v26, 1, v17
    v_mov_b32 v27, 1088
    v_mad_u32_u24 v96, v26, v27, v96
    v_lshl_add_u32 v28, v26, 1, s80
    v_lshlrev_b32 v28, 1, v28
    v_and_b32 v28, 15, v28
    v_mov_b32 v27, 1152
    v_mad_u32_u24 v28, v26, v27, v28
    s_and_b32 s57, s53, 1
    s_lshl_b32 s57, s57, 3
    v_and_b32 v33, 4, v17
    v_add3_u32 v33, v33, v24, s57
    v_lshrrev_b32 v34, 5, v17
    v_lshl_add_u32 v33, v34, 1, v33
    s_lshr_b32 s57, s53, 1
    s_lshl_b32 s57, s57, 2
    v_bfe_u32 v34, v17, 3, 2
    v_add_u32 v34, s57, v34
    v_lshl_add_u32 v29, v34, 5, v33
    v_lshl_add_u32 v98, v29, 1, v28
    v_sub_u32 v30, 256, v29
    v_add_u32 v31, 16, v29
    v_cmp_eq_u32 vcc, 0, v33
    s_nop 1
    v_cndmask_b32 v30, v30, v31, vcc
    v_lshl_add_u32 v99, v30, 1, v28
    v_lshrrev_b32 v100, 2, v0
    v_and_b32 v32, 3, v17
    v_lshlrev_b32 v32, 4, v32
    s_mul_i32 s58, s2, 8320
    s_add_u32 s58, s58, 20449280
    v_add_u32 v97, s58, v10
    s_bfe_u32 s57, s2, 0x20002
    s_lshl_b32 s57, s57, 12
    s_lshr_b32 s58, s2, 4
    s_lshl_b32 s58, s58, 8
    s_add_u32 s57, s57, s58
    s_and_b32 s58, s2, 3
    s_lshl_b32 s58, s58, 6
    s_add_u32 s57, s57, s58
    s_add_u32 s57, s57, 2097152
    v_lshl_add_u32 v102, v100, 14, v32
    v_add_u32 v102, s57, v102
    v_add_u32 v103, 1048576, v102
    s_mul_i32 s57, s56, 176
    s_mul_i32 s58, s53, 48
    s_add_u32 s83, s57, s58
    s_cmp_eq_u32 s56, 7
    s_cselect_b32 s57, 16, 0
    s_sub_u32 s83, s83, s57
    s_cmp_eq_u32 s53, 3
    s_cselect_b32 s57, 16, 0
    s_cmp_ge_u32 s56, 6
    s_cselect_b32 s57, s57, 0
    s_sub_u32 s83, s83, s57
    s_lshl_b32 s83, s83, 1
    s_lshr_b32 s57, s83, 5
    s_add_u32 s57, s57, 0
    s_lshr_b32 s58, s57, 2
    s_lshl_b32 s58, s58, 16
    s_and_b32 s57, s57, 3
    s_lshl_b32 s57, s57, 10
    s_add_u32 s57, s57, s58
    s_add_u32 s88, s57, 18874368
    s_lshr_b32 s57, s83, 5
    s_add_u32 s57, s57, 1
    s_lshr_b32 s58, s57, 2
    s_lshl_b32 s58, s58, 16
    s_and_b32 s57, s57, 3
    s_lshl_b32 s57, s57, 10
    s_add_u32 s57, s57, s58
    s_add_u32 s89, s57, 18874368
    s_lshr_b32 s57, s83, 5
    s_add_u32 s57, s57, 2
    s_lshr_b32 s58, s57, 2
    s_lshl_b32 s58, s58, 16
    s_and_b32 s57, s57, 3
    s_lshl_b32 s57, s57, 10
    s_add_u32 s57, s57, s58
    s_add_u32 s90, s57, 18874368
    s_cmp_ge_u32 s56, 6
    s_cselect_b32 s57, 2, 3
    s_cmp_ge_u32 s53, s57
    s_cselect_b32 s90, 0x2000000, s90
    v_lshrrev_b32 v24, 2, v0
    v_lshlrev_b32 v24, 6, v24
    v_mov_b32 v25, 163840
    v_add3_u32 v104, v24, v10, v25
    v_add_u32 v105, 8192, v104
    v_add_u32 v106, 16384, v104
    v_add_u32 v107, 24576, v104
    s_and_b32 s57, s2, 7
    s_lshl_b32 s57, s57, 10
    s_bfe_u32 s58, s2, 0x20003
    s_lshl_b32 s58, s58, 7
    s_add_u32 s57, s57, s58
    s_add_u32 s57, s57, 163904
    v_and_b32 v24, 3, v17
    v_lshl_add_u32 v24, v24, 13, s57
    v_bfe_u32 v25, v17, 2, 1
    v_lshl_add_u32 v108, v25, 9, v24
    v_and_b32 v24, 1, v0
    v_lshlrev_b32 v24, 10, v24
    v_bfe_u32 v25, v0, 1, 6
    v_lshl_add_u32 v24, v25, 4, v24
    v_lshrrev_b32 v25, 7, v0
    v_lshl_add_u32 v62, v25, 11, v24
    s_lshl_b32 s57, s53, 11
    v_add_u32 v63, s57, v20
    v_lshl_add_u32 v100, v17, 3, s57
    s_mul_i32 s57, s53, 2304
    v_add_u32 v101, s57, v20
    s_cmp_ge_u32 s53, 2
    s_cselect_b32 s92, 1.0, 0
    s_mov_b32 s93, s92
    s_waitcnt vmcnt(8)
    v_lshlrev_b32 v8, 16, v8
    v_mul_f32 v32, 0xbfb8aa3b, v8
    v_exp_f32 v32, v32
    s_nop 0
    v_add_f32 v32, 1.0, v32
    v_rcp_f32 v32, v32
    s_nop 0
    v_mul_f32 v8, v8, v32
    v_cvt_pk_bf16_f32 v8, v8, v8
    v_and_b32 v8, 0xffff0000, v8
    v_lshlrev_b32 v24, 16, v4
    v_and_b32 v25, 0xffff0000, v4
    v_lshlrev_b32 v26, 16, v5
    v_and_b32 v27, 0xffff0000, v5
    v_lshlrev_b32 v28, 16, v6
    v_and_b32 v29, 0xffff0000, v6
    v_lshlrev_b32 v30, 16, v7
    v_and_b32 v31, 0xffff0000, v7
    global_load_dwordx4 v[236:239], v53, s[4:5]
    global_load_dwordx4 v[232:235], v53, s[4:5] offset:1024
    v_mov_b32 v32, v8
    v_pk_mul_f32 v[24:25], v[24:25], v[32:33] op_sel_hi:[1,0]
    v_pk_mul_f32 v[26:27], v[26:27], v[32:33] op_sel_hi:[1,0]
    v_pk_mul_f32 v[28:29], v[28:29], v[32:33] op_sel_hi:[1,0]
    v_pk_mul_f32 v[30:31], v[30:31], v[32:33] op_sel_hi:[1,0]
    s_nop 0
    v_permlane32_swap_b32 v24, v28
    v_permlane32_swap_b32 v25, v29
    v_permlane32_swap_b32 v26, v30
    v_permlane32_swap_b32 v27, v31
    v_pk_add_f32 v[24:25], v[24:25], v[28:29]
    v_pk_add_f32 v[26:27], v[26:27], v[30:31]
    s_nop 1
    v_permlane16_swap_b32 v24, v26
    v_permlane16_swap_b32 v25, v27
    v_pk_add_f32 v[24:25], v[24:25], v[26:27]
    s_nop 1
    v_add_f32_dpp v24, v24, v24 row_ror:2 row_mask:0xf bank_mask:0xf
    v_add_f32_dpp v25, v25, v25 row_ror:2 row_mask:0xf bank_mask:0xf
    s_nop 0
    v_add_f32_dpp v24, v24, v24 row_ror:4 row_mask:0xf bank_mask:0xf
    v_add_f32_dpp v25, v25, v25 row_ror:4 row_mask:0xf bank_mask:0xf
    s_nop 0
    v_add_f32_dpp v24, v24, v24 row_ror:8 row_mask:0xf bank_mask:0xf
    v_add_f32_dpp v25, v25, v25 row_ror:8 row_mask:0xf bank_mask:0xf
    s_mov_b64 exec, s[64:65]
    ds_write_b64 v21, v[24:25] offset:22528
    s_mov_b64 exec, -1
    s_waitcnt lgkmcnt(0)
    s_mul_i32 s52, s52, 1664525
    s_add_u32 s52, s52, 1013904223
    s_waitcnt vmcnt(8)
    s_waitcnt lgkmcnt(0)
    s_barrier
    s_cmp_lg_u32 s53, 0
    s_cbranch_scc1 L_pubA
    ds_read_b128 v[24:27], v20 offset:22528
    ds_read_b128 v[28:31], v20 offset:22592
    ds_read_b128 v[32:35], v20 offset:22656
    ds_read_b128 v[36:39], v20 offset:22720
    s_waitcnt lgkmcnt(2)
    v_pk_add_f32 v[24:25], v[24:25], v[28:29]
    v_pk_add_f32 v[26:27], v[26:27], v[30:31]
    s_waitcnt lgkmcnt(0)
    v_pk_add_f32 v[32:33], v[32:33], v[36:37]
    v_pk_add_f32 v[34:35], v[34:35], v[38:39]
    v_pk_add_f32 v[24:25], v[24:25], v[32:33]
    v_pk_add_f32 v[26:27], v[26:27], v[34:35]
    v_mov_b32 v29, s52
    v_mov_b32 v31, s52
    v_cvt_pk_bf16_f32 v28, v24, v25
    v_cvt_pk_bf16_f32 v30, v26, v27
    s_mov_b64 exec, 0xf0
    v_mov_b32 v28, s76
    v_mov_b32 v30, s76
    s_mov_b64 exec, 255
    global_store_dwordx4 v16, v[28:31], s[26:27] sc1
    s_mov_b64 exec, -1
L_pubA:
    s_cmp_ge_u32 s81, 352
    s_cbranch_scc1 L_rl_a
    s_add_u32 m0, s70, 17408
    s_add_u32 s60, s82, 0
    buffer_load_dwordx4 v54, s[28:31], s60 offen  lds
    s_add_u32 m0, s70, 18432
    s_add_u32 s60, s82, 22016
    buffer_load_dwordx4 v54, s[28:31], s60 offen  lds
    s_add_u32 m0, s70, 19456
    s_add_u32 s60, s82, 704512
    buffer_load_dwordx4 v54, s[28:31], s60 offen  lds
    s_add_u32 m0, s70, 20480
    s_add_u32 s60, s82, 726528
    buffer_load_dwordx4 v54, s[28:31], s60 offen  lds
L_rl_a:
    v_add_u32 v8, 6144, v97
    s_cmp_lg_u32 s53, 0
    s_cbranch_scc1 L_w256a
    v_and_b32 v24, 1, v17
    v_lshl_add_u32 v24, v24, 1, s80
    v_bfe_u32 v25, v17, 1, 1
    v_lshlrev_b32 v25, 9, v25
    v_and_b32 v26, 4, v17
    v_cmp_ne_u32 vcc, 0, v26
    v_add_u32 v27, 0, v24
    v_sub_u32 v28, 2048, v27
    v_and_b32 v28, 2047, v28
    v_cndmask_b32 v27, v27, v28, vcc
    v_mov_b32 v29, 514
    v_mad_u32_u24 v32, v27, v29, v25
    v_add_u32 v27, 64, v24
    v_sub_u32 v28, 2048, v27
    v_and_b32 v28, 2047, v28
    v_cndmask_b32 v27, v27, v28, vcc
    v_mad_u32_u24 v33, v27, v29, v25
    v_add_u32 v27, 128, v24
    v_sub_u32 v28, 2048, v27
    v_and_b32 v28, 2047, v28
    v_cndmask_b32 v27, v27, v28, vcc
    v_mad_u32_u24 v34, v27, v29, v25
    v_add_u32 v27, 192, v24
    v_sub_u32 v28, 2048, v27
    v_and_b32 v28, 2047, v28
    v_cndmask_b32 v27, v27, v28, vcc
    v_mad_u32_u24 v35, v27, v29, v25
    s_mov_b64 exec, 0xff
    buffer_load_ushort v4, v32, s[44:47], 0 offen
    buffer_load_ushort v244, v32, s[48:51], 0 offen
    buffer_load_ushort v5, v33, s[44:47], 0 offen
    buffer_load_ushort v245, v33, s[48:51], 0 offen
    buffer_load_ushort v6, v34, s[44:47], 0 offen
    buffer_load_ushort v246, v34, s[48:51], 0 offen
    buffer_load_ushort v7, v35, s[44:47], 0 offen
    buffer_load_ushort v247, v35, s[48:51], 0 offen
    s_mov_b64 exec, -1
L_w256a:
    v_cvt_f32_u32 v16, s54
    v_fma_f32 v37, v23, 2.0, v16
    v_mul_f32 v36, 0x3c800000, v37
    v_mul_f32 v24, v52, v36
    v_add_f32 v25, v24, v36
    v_add_f32 v26, v25, v36
    v_add_f32 v27, v26, v36
    v_cos_f32 v28, v24
    v_sin_f32 v32, v24
    v_cos_f32 v29, v25
    v_sin_f32 v33, v25
    v_cos_f32 v30, v26
    v_sin_f32 v34, v26
    v_cos_f32 v31, v27
    v_sin_f32 v35, v27
    v_cvt_pk_bf16_f32 v220, v28, v32
    v_cvt_pk_bf16_f32 v216, -v32, v28
    v_cvt_pk_bf16_f32 v221, v29, v33
    v_cvt_pk_bf16_f32 v217, -v33, v29
    v_cvt_pk_bf16_f32 v222, v30, v34
    v_cvt_pk_bf16_f32 v218, -v34, v30
    v_cvt_pk_bf16_f32 v223, v31, v35
    v_cvt_pk_bf16_f32 v219, -v35, v31
    v_add_f32 v24, 0x41800000, v52
    v_mul_f32 v24, v24, v36
    v_add_f32 v25, v24, v36
    v_add_f32 v26, v25, v36
    v_add_f32 v27, v26, v36
    v_cos_f32 v28, v24
    v_sin_f32 v32, v24
    v_cos_f32 v29, v25
    v_sin_f32 v33, v25
    v_cos_f32 v30, v26
    v_sin_f32 v34, v26
    v_cos_f32 v31, v27
    v_sin_f32 v35, v27
    v_cvt_pk_bf16_f32 v212, v28, v32
    v_cvt_pk_bf16_f32 v208, -v32, v28
    v_cvt_pk_bf16_f32 v213, v29, v33
    v_cvt_pk_bf16_f32 v209, -v33, v29
    v_cvt_pk_bf16_f32 v214, v30, v34
    v_cvt_pk_bf16_f32 v210, -v34, v30
    v_cvt_pk_bf16_f32 v215, v31, v35
    v_cvt_pk_bf16_f32 v211, -v35, v31
    v_mul_f32 v36, 0x3a000000, v37
    s_lshl_b32 s57, s53, 3
    v_cvt_f32_u32 v38, s57
    v_fmac_f32 v38, 0.5, v52
    v_mul_f32 v24, v38, v36
    v_add_f32 v25, v24, v36
    v_cos_f32 v188, v24
    v_sin_f32 v184, v24
    v_cos_f32 v189, v25
    v_sin_f32 v185, v25
    v_fma_f32 v37, v23, 2.0, v16
    v_add_f32 v37, 0x42000000, v37
    v_mul_f32 v36, 0x3c800000, v37
    v_mul_f32 v24, v52, v36
    v_add_f32 v25, v24, v36
    v_add_f32 v26, v25, v36
    v_add_f32 v27, v26, v36
    v_cos_f32 v28, v24
    v_sin_f32 v32, v24
    v_cos_f32 v29, v25
    v_sin_f32 v33, v25
    v_cos_f32 v30, v26
    v_sin_f32 v34, v26
    v_cos_f32 v31, v27
    v_sin_f32 v35, v27
    v_cvt_pk_bf16_f32 v204, v28, v32
    v_cvt_pk_bf16_f32 v200, -v32, v28
    v_cvt_pk_bf16_f32 v205, v29, v33
    v_cvt_pk_bf16_f32 v201, -v33, v29
    v_cvt_pk_bf16_f32 v206, v30, v34
    v_cvt_pk_bf16_f32 v202, -v34, v30
    v_cvt_pk_bf16_f32 v207, v31, v35
    v_cvt_pk_bf16_f32 v203, -v35, v31
    v_add_f32 v24, 0x41800000, v52
    v_mul_f32 v24, v24, v36
    v_add_f32 v25, v24, v36
    v_add_f32 v26, v25, v36
    v_add_f32 v27, v26, v36
    v_cos_f32 v28, v24
    v_sin_f32 v32, v24
    v_cos_f32 v29, v25
    v_sin_f32 v33, v25
    v_cos_f32 v30, v26
    v_sin_f32 v34, v26
    v_cos_f32 v31, v27
    v_sin_f32 v35, v27
    v_cvt_pk_bf16_f32 v196, v28, v32
    v_cvt_pk_bf16_f32 v192, -v32, v28
    v_cvt_pk_bf16_f32 v197, v29, v33
    v_cvt_pk_bf16_f32 v193, -v33, v29
    v_cvt_pk_bf16_f32 v198, v30, v34
    v_cvt_pk_bf16_f32 v194, -v34, v30
    v_cvt_pk_bf16_f32 v199, v31, v35
    v_cvt_pk_bf16_f32 v195, -v35, v31
    v_mul_f32 v36, 0x3a000000, v37
    s_lshl_b32 s57, s53, 3
    v_cvt_f32_u32 v38, s57
    v_fmac_f32 v38, 0.5, v52
    v_mul_f32 v24, v38, v36
    v_add_f32 v25, v24, v36
    v_cos_f32 v190, v24
    v_sin_f32 v186, v24
    v_cos_f32 v191, v25
    v_sin_f32 v187, v25
    s_mov_b64 exec, 0x7ff
    buffer_load_dword v59, v59, s[32:35], 0 offen
    s_mov_b64 exec, -1
    s_mov_b64 exec, s[68:69]
    global_load_dword v9, v9, s[20:21]
    s_mov_b64 exec, -1
    v_add_u32 v32, 131072, v63
    s_waitcnt vmcnt(3)
    ds_write_b128 v32, v[236:239] offset:21504
    s_waitcnt vmcnt(2)
    ds_write_b128 v32, v[232:235] offset:22528
    v_lshlrev_b32 v120, 16, v236
    v_and_b32 v121, 0xffff0000, v236
    v_lshlrev_b32 v122, 16, v237
    v_and_b32 v123, 0xffff0000, v237
    v_lshlrev_b32 v124, 16, v238
    v_and_b32 v125, 0xffff0000, v238
    v_lshlrev_b32 v126, 16, v239
    v_and_b32 v127, 0xffff0000, v239
    v_lshlrev_b32 v128, 16, v232
    v_and_b32 v129, 0xffff0000, v232
    v_lshlrev_b32 v130, 16, v233
    v_and_b32 v131, 0xffff0000, v233
    v_lshlrev_b32 v132, 16, v234
    v_and_b32 v133, 0xffff0000, v234
    v_lshlrev_b32 v134, 16, v235
    v_and_b32 v135, 0xffff0000, v235
    v_pk_add_f32 v[24:25], v[120:121], v[122:123]
    v_pk_mul_f32 v[26:27], v[120:121], v[120:121]
    v_pk_add_f32 v[24:25], v[24:25], v[124:125]
    v_pk_fma_f32 v[26:27], v[122:123], v[122:123], v[26:27]
    v_pk_add_f32 v[24:25], v[24:25], v[126:127]
    v_pk_fma_f32 v[26:27], v[124:125], v[124:125], v[26:27]
    v_pk_fma_f32 v[26:27], v[126:127], v[126:127], v[26:27]
    v_pk_add_f32 v[28:29], v[128:129], v[130:131]
    v_pk_mul_f32 v[30:31], v[128:129], v[128:129]
    v_pk_add_f32 v[28:29], v[28:29], v[132:133]
    v_pk_fma_f32 v[30:31], v[130:131], v[130:131], v[30:31]
    v_pk_add_f32 v[28:29], v[28:29], v[134:135]
    v_pk_fma_f32 v[30:31], v[132:133], v[132:133], v[30:31]
    v_pk_fma_f32 v[30:31], v[134:135], v[134:135], v[30:31]
    v_add_f32 v24, v24, v25
    v_add_f32 v28, v28, v29
    v_add_f32 v26, v26, v27
    v_add_f32 v30, v30, v31
    v_permlane32_swap_b32 v24, v28
    s_nop 0
    v_permlane32_swap_b32 v26, v30
    v_add_f32 v24, v24, v28
    v_add_f32 v26, v26, v30
    s_nop 1
    v_permlane16_swap_b32 v24, v26
    v_add_f32 v24, v24, v26
    s_nop 1
    v_add_f32_dpp v24, v24, v24 row_ror:1 row_mask:0xf bank_mask:0xf
    s_nop 1
    v_add_f32_dpp v24, v24, v24 row_ror:2 row_mask:0xf bank_mask:0xf
    s_nop 1
    v_add_f32_dpp v24, v24, v24 row_ror:4 row_mask:0xf bank_mask:0xf
    s_nop 1
    v_add_f32_dpp v24, v24, v24 row_ror:8 row_mask:0xf bank_mask:0xf
    v_mov_b32 v25, v24
    s_nop 1
    v_permlane16_swap_b32 v24, v25
    v_mul_f32 v24, 0x3b000000, v24
    v_mul_f32 v26, v24, v24
    v_fmamk_f32 v25, v25, 0x3b000000, v22
    v_sub_f32 v25, v25, v26
    v_max_f32 v25, v25, v22
    v_rsq_f32 v136, v25
    s_nop 0
    v_mul_f32 v137, v24, v136
    v_mov_b32 v138, v136
    v_sub_f32 v137, 0, v137
    v_mov_b32 v139, v137
    v_permlane32_swap_b32 v136, v138
    s_nop 0
    v_permlane32_swap_b32 v137, v139
    v_pk_fma_f32 v[120:121], v[120:121], v[136:137], v[136:137] op_sel:[0,0,1] op_sel_hi:[1,0,1]
    v_pk_fma_f32 v[122:123], v[122:123], v[136:137], v[136:137] op_sel:[0,0,1] op_sel_hi:[1,0,1]
    v_pk_fma_f32 v[124:125], v[124:125], v[136:137], v[136:137] op_sel:[0,0,1] op_sel_hi:[1,0,1]
    v_pk_fma_f32 v[126:127], v[126:127], v[136:137], v[136:137] op_sel:[0,0,1] op_sel_hi:[1,0,1]
    v_pk_fma_f32 v[128:129], v[128:129], v[138:139], v[138:139] op_sel:[0,0,1] op_sel_hi:[1,0,1]
    v_pk_fma_f32 v[130:131], v[130:131], v[138:139], v[138:139] op_sel:[0,0,1] op_sel_hi:[1,0,1]
    v_pk_fma_f32 v[132:133], v[132:133], v[138:139], v[138:139] op_sel:[0,0,1] op_sel_hi:[1,0,1]
    v_pk_fma_f32 v[134:135], v[134:135], v[138:139], v[138:139] op_sel:[0,0,1] op_sel_hi:[1,0,1]
    s_waitcnt lgkmcnt(0)
    s_barrier
    ds_read_u16 v112, v98 offset:0
    ds_read_u16 v252, v98 offset:576
    ds_read_u16 v113, v98 offset:2304
    ds_read_u16 v253, v98 offset:2880
    ds_read_u16 v114, v98 offset:4608
    ds_read_u16 v254, v98 offset:5184
    ds_read_u16 v115, v98 offset:6912
    ds_read_u16 v255, v98 offset:7488
    ds_read_u16 v116, v99 offset:0
    ds_read_u16 v248, v99 offset:576
    ds_read_u16 v117, v99 offset:2304
    ds_read_u16 v249, v99 offset:2880
    ds_read_u16 v118, v99 offset:4608
    ds_read_u16 v250, v99 offset:5184
    ds_read_u16 v119, v99 offset:6912
    ds_read_u16 v251, v99 offset:7488
    s_waitcnt lgkmcnt(14)
    v_lshl_or_b32 v112, v252, 16, v112
    s_waitcnt lgkmcnt(12)
    v_lshl_or_b32 v113, v253, 16, v113
    s_waitcnt lgkmcnt(10)
    v_lshl_or_b32 v114, v254, 16, v114
    s_waitcnt lgkmcnt(8)
    v_lshl_or_b32 v115, v255, 16, v115
    s_waitcnt lgkmcnt(6)
    v_lshl_or_b32 v116, v248, 16, v116
    s_waitcnt lgkmcnt(4)
    v_lshl_or_b32 v117, v249, 16, v117
    s_waitcnt lgkmcnt(2)
    v_lshl_or_b32 v118, v250, 16, v118
    s_waitcnt lgkmcnt(0)
    v_lshl_or_b32 v119, v251, 16, v119
    s_waitcnt vmcnt(2)
    ds_read_b64_tr_b16 a[192:193], v44 offset:17408
    ds_read_b64_tr_b16 a[194:195], v44 offset:19456
    ds_read_b64_tr_b16 a[196:197], v45 offset:17408
    ds_read_b64_tr_b16 a[198:199], v45 offset:19456
    ds_read_b64_tr_b16 a[200:201], v46 offset:17408
    ds_read_b64_tr_b16 a[202:203], v46 offset:19456
    ds_read_b64_tr_b16 a[204:205], v47 offset:17408
    ds_read_b64_tr_b16 a[206:207], v47 offset:19456
    s_cmp_lg_u32 s53, 0
    s_cbranch_scc1 L_w256b
    s_waitcnt vmcnt(2)
    v_lshlrev_b32 v24, 16, v4
    s_waitcnt vmcnt(2)
    v_lshlrev_b32 v25, 16, v244
    s_waitcnt vmcnt(2)
    v_lshlrev_b32 v26, 16, v5
    s_waitcnt vmcnt(2)
    v_lshlrev_b32 v27, 16, v245
    s_waitcnt vmcnt(2)
    v_lshlrev_b32 v28, 16, v6
    s_waitcnt vmcnt(2)
    v_lshlrev_b32 v29, 16, v246
    s_waitcnt vmcnt(2)
    v_lshlrev_b32 v30, 16, v7
    s_waitcnt vmcnt(2)
    v_lshlrev_b32 v31, 16, v247
    v_and_b32 v32, 2, v17
    v_cvt_f32_u32 v32, v32
    v_sub_f32 v32, 1.0, v32
    v_add_f32_dpp v24, v24, v24 row_shl:4 row_mask:0xf bank_mask:0xf
    v_subrev_f32_dpp v25, v25, v25 row_shl:4 row_mask:0xf bank_mask:0xf
    v_add_f32_dpp v26, v26, v26 row_shl:4 row_mask:0xf bank_mask:0xf
    v_subrev_f32_dpp v27, v27, v27 row_shl:4 row_mask:0xf bank_mask:0xf
    v_add_f32_dpp v28, v28, v28 row_shl:4 row_mask:0xf bank_mask:0xf
    v_subrev_f32_dpp v29, v29, v29 row_shl:4 row_mask:0xf bank_mask:0xf
    v_add_f32_dpp v30, v30, v30 row_shl:4 row_mask:0xf bank_mask:0xf
    v_subrev_f32_dpp v31, v31, v31 row_shl:4 row_mask:0xf bank_mask:0xf
    v_mul_f32 v33, v32, v24
    s_nop 1
    v_add_f32_dpp v24, v24, v33 quad_perm:[2,3,0,1] row_mask:0xf bank_mask:0xf
    v_mul_f32 v33, v32, v25
    s_nop 1
    v_add_f32_dpp v25, v25, v33 quad_perm:[2,3,0,1] row_mask:0xf bank_mask:0xf
    v_mul_f32 v33, v32, v26
    s_nop 1
    v_add_f32_dpp v26, v26, v33 quad_perm:[2,3,0,1] row_mask:0xf bank_mask:0xf
    v_mul_f32 v33, v32, v27
    s_nop 1
    v_add_f32_dpp v27, v27, v33 quad_perm:[2,3,0,1] row_mask:0xf bank_mask:0xf
    v_mul_f32 v33, v32, v28
    s_nop 1
    v_add_f32_dpp v28, v28, v33 quad_perm:[2,3,0,1] row_mask:0xf bank_mask:0xf
    v_mul_f32 v33, v32, v29
    s_nop 1
    v_add_f32_dpp v29, v29, v33 quad_perm:[2,3,0,1] row_mask:0xf bank_mask:0xf
    v_mul_f32 v33, v32, v30
    s_nop 1
    v_add_f32_dpp v30, v30, v33 quad_perm:[2,3,0,1] row_mask:0xf bank_mask:0xf
    v_mul_f32 v33, v32, v31
    s_nop 1
    v_add_f32_dpp v31, v31, v33 quad_perm:[2,3,0,1] row_mask:0xf bank_mask:0xf
    v_mul_f32 v24, 0x3e800000, v24
    v_mul_f32 v25, 0x3e800000, v25
    v_mul_f32 v26, 0x3e800000, v26
    v_mul_f32 v27, 0x3e800000, v27
    v_mul_f32 v28, 0x3e800000, v28
    v_mul_f32 v29, 0x3e800000, v29
    v_mul_f32 v30, 0x3e800000, v30
    v_mul_f32 v31, 0x3e800000, v31
    v_cvt_pk_bf16_f32 v4, v24, v25
    v_cvt_pk_bf16_f32 v5, v26, v27
    v_cvt_pk_bf16_f32 v6, v28, v29
    v_cvt_pk_bf16_f32 v7, v30, v31
L_w256b:
    global_load_dwordx4 v[236:239], v104, s[26:27] sc1
    global_load_dwordx4 v[232:235], v105, s[26:27] sc1
    global_load_dwordx4 v[228:231], v106, s[26:27] sc1
    global_load_dwordx4 v[224:227], v107, s[26:27] sc1
    global_load_dwordx2 v[252:253], v108, s[26:27] sc1
    s_waitcnt lgkmcnt(0)
    s_waitcnt vmcnt(0)
L_A:
    v_sad_u32 v24, v253, s52, 0
    v_sad_u32 v24, v237, s52, v24
    v_sad_u32 v24, v239, s52, v24
    v_sad_u32 v24, v233, s52, v24
    v_sad_u32 v24, v235, s52, v24
    v_sad_u32 v24, v229, s52, v24
    v_sad_u32 v24, v231, s52, v24
    v_sad_u32 v24, v225, s52, v24
    v_sad_u32 v24, v227, s52, v24
    v_cmp_ne_u32 vcc, 0, v24
    s_cbranch_vccnz L_A_retry
L_A_ok:
    v_cmp_ne_u32 vcc, s76, v252
    global_store_dwordx4 v97, v[112:115], s[26:27] offset:-2048 sc1
    global_store_dwordx4 v97, v[116:119], s[26:27] offset:2048 sc1
    s_cmp_lg_u32 s53, 0
    s_cbranch_scc1 L_w256c
    s_mov_b64 exec, 0xff
    global_store_dwordx4 v8, v[4:7], s[26:27] sc1
    s_mov_b64 exec, -1
L_w256c:
    s_cmp_ge_u32 s81, 352
    s_cbranch_scc1 L_rl_c
    buffer_store_dwordx4 a[192:195], v20, s[36:39], s84 offen sc1
    buffer_store_dwordx4 a[196:199], v20, s[36:39], s85 offen sc1
    buffer_store_dwordx4 a[200:203], v20, s[36:39], s86 offen sc1
    buffer_store_dwordx4 a[204:207], v20, s[36:39], s87 offen sc1
L_rl_c:
    s_or_b32 s77, vcc_lo, vcc_hi
    s_add_u32 m0, s71, 0
    s_add_u32 s63, s72, 0
    buffer_load_dwordx4 v42, s[32:35], s63 offen offset:0 lds
    v_lshlrev_b32 v24, 16, v236
    v_and_b32 v25, 0xffff0000, v236
    v_lshlrev_b32 v26, 16, v238
    v_and_b32 v27, 0xffff0000, v238
    v_lshlrev_b32 v28, 16, v232
    v_and_b32 v29, 0xffff0000, v232
    v_lshlrev_b32 v30, 16, v234
    v_and_b32 v31, 0xffff0000, v234
    v_lshlrev_b32 v32, 16, v228
    v_and_b32 v33, 0xffff0000, v228
    v_lshlrev_b32 v34, 16, v230
    v_and_b32 v35, 0xffff0000, v230
    v_lshlrev_b32 v36, 16, v224
    v_and_b32 v37, 0xffff0000, v224
    v_lshlrev_b32 v38, 16, v226
    v_and_b32 v39, 0xffff0000, v226
    v_pk_add_f32 v[24:25], v[24:25], v[28:29]
    v_pk_add_f32 v[26:27], v[26:27], v[30:31]
    v_pk_add_f32 v[32:33], v[32:33], v[36:37]
    v_pk_add_f32 v[34:35], v[34:35], v[38:39]
    v_pk_add_f32 v[24:25], v[24:25], s[92:93]
    v_pk_add_f32 v[26:27], v[26:27], s[92:93]
    v_pk_add_f32 v[24:25], v[24:25], v[32:33]
    v_pk_add_f32 v[26:27], v[26:27], v[34:35]
    ds_write_b128 v62, v[24:27] offset:18432
    buffer_load_dwordx4 v43, s[32:35], s63 offen offset:1024 lds
    s_waitcnt lgkmcnt(0)
    s_barrier
    ds_read_b128 v[236:239], v20 offset:18432
    ds_read_b128 v[232:235], v20 offset:19456
    ds_read_b128 v[228:231], v20 offset:20480
    ds_read_b128 v[224:227], v20 offset:21504
    s_waitcnt lgkmcnt(1)
    v_pk_fma_f32 v[120:121], v[120:121], v[228:229], v[236:237]
    v_pk_fma_f32 v[122:123], v[122:123], v[230:231], v[238:239]
    s_waitcnt lgkmcnt(0)
    v_pk_fma_f32 v[124:125], v[124:125], v[224:225], v[232:233]
    v_pk_fma_f32 v[126:127], v[126:127], v[226:227], v[234:235]
    v_cvt_pk_bf16_f32 v24, v120, v121
    v_cvt_pk_bf16_f32 v25, v122, v123
    v_cvt_pk_bf16_f32 v26, v124, v125
    v_cvt_pk_bf16_f32 v27, v126, v127
    ds_write_b128 v63, v[24:27] offset:9216
    v_pk_fma_f32 v[128:129], v[128:129], v[228:229], v[236:237]
    v_pk_fma_f32 v[130:131], v[130:131], v[230:231], v[238:239]
    v_pk_fma_f32 v[132:133], v[132:133], v[224:225], v[232:233]
    v_pk_fma_f32 v[134:135], v[134:135], v[226:227], v[234:235]
    v_cvt_pk_bf16_f32 v28, v128, v129
    v_cvt_pk_bf16_f32 v29, v130, v131
    v_cvt_pk_bf16_f32 v30, v132, v133
    v_cvt_pk_bf16_f32 v31, v134, v135
    ds_write_b128 v63, v[28:31] offset:10240
    s_waitcnt lgkmcnt(0)
    ds_read_b64_tr_b16 v[32:33], v100 offset:9216
    ds_read_b64_tr_b16 v[34:35], v100 offset:9728
    s_add_u32 m0, s71, 2048
    s_add_u32 s63, s72, 16384
    buffer_load_dwordx4 v42, s[32:35], s63 offen offset:0 lds
    ds_read_b64_tr_b16 v[36:37], v100 offset:10240
    ds_read_b64_tr_b16 v[38:39], v100 offset:10752
    s_waitcnt lgkmcnt(2)
    v_mfma_f32_16x16x32_bf16 v[252:255], v[32:35], v[64:67], 0
    v_mfma_f32_16x16x32_bf16 v[244:247], v[32:35], v[68:71], 0
    s_waitcnt lgkmcnt(0)
    v_mfma_f32_16x16x32_bf16 v[248:251], v[36:39], v[64:67], 0
    v_mfma_f32_16x16x32_bf16 v[240:243], v[36:39], v[68:71], 0
    s_nop 3
    v_pk_mul_f32 v[120:121], v[252:253], v[72:73]
    v_pk_mul_f32 v[128:129], v[244:245], v[72:73]
    v_pk_mul_f32 v[122:123], v[254:255], v[74:75]
    v_pk_mul_f32 v[130:131], v[246:247], v[74:75]
    v_pk_mul_f32 v[124:125], v[248:249], v[72:73]
    v_pk_mul_f32 v[132:133], v[240:241], v[72:73]
    v_pk_mul_f32 v[126:127], v[250:251], v[74:75]
    buffer_load_dwordx4 v43, s[32:35], s63 offen offset:1024 lds
    v_pk_mul_f32 v[134:135], v[242:243], v[74:75]
    v_pk_fma_f32 v[120:121], v[244:245], v[76:77], v[120:121]
    v_pk_fma_f32 v[128:129], v[252:253], v[76:77], v[128:129] neg_lo:[0,1,0] neg_hi:[0,1,0]
    v_pk_fma_f32 v[122:123], v[246:247], v[78:79], v[122:123]
    v_pk_fma_f32 v[130:131], v[254:255], v[78:79], v[130:131] neg_lo:[0,1,0] neg_hi:[0,1,0]
    v_pk_fma_f32 v[124:125], v[240:241], v[76:77], v[124:125]
    v_pk_fma_f32 v[132:133], v[248:249], v[76:77], v[132:133] neg_lo:[0,1,0] neg_hi:[0,1,0]
    v_pk_fma_f32 v[126:127], v[242:243], v[78:79], v[126:127]
    v_pk_fma_f32 v[134:135], v[250:251], v[78:79], v[134:135] neg_lo:[0,1,0] neg_hi:[0,1,0]
    v_cvt_pk_bf16_f32 v24, v120, v128
    v_cvt_pk_bf16_f32 v25, v121, v129
    v_cvt_pk_bf16_f32 v26, v122, v130
    v_cvt_pk_bf16_f32 v27, v123, v131
    v_cvt_pk_bf16_f32 v28, v124, v132
    v_cvt_pk_bf16_f32 v29, v125, v133
    v_cvt_pk_bf16_f32 v30, v126, v134
    v_cvt_pk_bf16_f32 v31, v127, v135
    v_mfma_f32_16x16x32_bf16 v[252:255], v[80:83], v[24:27], 0
    v_mfma_f32_16x16x32_bf16 v[244:247], v[84:87], v[24:27], 0
    v_mfma_f32_16x16x32_bf16 v[236:239], v[88:91], v[24:27], 0
    v_mfma_f32_16x16x32_bf16 v[228:231], v[92:95], v[24:27], 0
    v_mfma_f32_16x16x32_bf16 v[248:251], v[80:83], v[28:31], 0
    v_mfma_f32_16x16x32_bf16 v[240:243], v[84:87], v[28:31], 0
    v_mfma_f32_16x16x32_bf16 v[232:235], v[88:91], v[28:31], 0
    v_mfma_f32_16x16x32_bf16 v[224:227], v[92:95], v[28:31], 0
    s_nop 1
    v_cvt_pk_bf16_f32 v32, v252, v244
    v_cvt_pk_bf16_f32 v33, v253, v245
    v_cvt_pk_bf16_f32 v34, v254, v246
    v_cvt_pk_bf16_f32 v35, v255, v247
    v_cvt_pk_bf16_f32 v36, v248, v240
    v_cvt_pk_bf16_f32 v37, v249, v241
    v_cvt_pk_bf16_f32 v38, v250, v242
    v_cvt_pk_bf16_f32 v39, v251, v243
    s_mov_b64 exec, s[66:67]
    v_cvt_pk_bf16_f32 v32, v236, v228
    v_cvt_pk_bf16_f32 v33, v237, v229
    v_cvt_pk_bf16_f32 v34, v238, v230
    v_cvt_pk_bf16_f32 v35, v239, v231
    v_cvt_pk_bf16_f32 v36, v232, v224
    v_cvt_pk_bf16_f32 v37, v233, v225
    v_cvt_pk_bf16_f32 v38, v234, v226
    v_cvt_pk_bf16_f32 v39, v235, v227
    s_mov_b64 exec, -1
    ds_write_b128 v101, v[32:35] offset:0
    ds_write_b128 v101, v[36:39] offset:1088
    s_waitcnt vmcnt(4)
    s_waitcnt lgkmcnt(0)
    s_barrier
    ds_read2st64_b32 v[24:25], v96 offset0:0 offset1:9
    ds_read2st64_b32 v[26:27], v96 offset0:18 offset1:27
    ds_read2st64_b32 v[28:29], v96 offset0:2 offset1:11
    ds_read2st64_b32 v[30:31], v96 offset0:20 offset1:29
    s_waitcnt lgkmcnt(2)
    global_store_dwordx4 v102, v[24:27], s[26:27] sc1
    s_waitcnt lgkmcnt(0)
    global_store_dwordx4 v103, v[28:31], s[26:27] sc1
    global_load_dwordx4 v[228:231], v56, s[20:21]
    global_load_ushort v60, v55, s[18:19] offset:0
    global_load_dwordx4 v[224:227], v57, s[20:21]
    global_load_ushort v61, v55, s[18:19] offset:256
    s_cmp_eq_u32 s77, 0
    s_cbranch_scc0 L_shared
    s_cmp_lg_u32 s2, 0
    s_cbranch_scc1 L_epoch
    v_mov_b32 v24, 0
    v_mov_b32 v25, s52
    s_mov_b64 exec, 1
    global_store_dword v24, v25, s[26:27] sc1
    s_mov_b64 exec, -1
L_epoch:
    s_add_u32 m0, s71, 4096
    s_add_u32 s63, s72, 49152
    buffer_load_dwordx4 v42, s[32:35], s63 offen offset:0 lds
    v_add_f32 v37, 0x00000000, v23
    v_mul_f32 v36, 0x3d000000, v37
    v_mul_f32 v24, v52, v36
    v_add_f32 v25, v24, v36
    v_add_f32 v26, v25, v36
    v_add_f32 v27, v26, v36
    v_cos_f32 v28, v24
    v_sin_f32 v32, v24
    v_cos_f32 v29, v25
    v_sin_f32 v33, v25
    buffer_load_dwordx4 v43, s[32:35], s63 offen offset:1024 lds
    v_cos_f32 v30, v26
    v_sin_f32 v34, v26
    v_cos_f32 v31, v27
    v_sin_f32 v35, v27
    v_cvt_pk_bf16_f32 v180, v28, v32
    v_cvt_pk_bf16_f32 v176, -v32, v28
    v_cvt_pk_bf16_f32 v181, v29, v33
    v_cvt_pk_bf16_f32 v177, -v33, v29
    v_cvt_pk_bf16_f32 v182, v30, v34
    v_cvt_pk_bf16_f32 v178, -v34, v30
    s_add_u32 m0, s71, 6144
    s_add_u32 s63, s72, 65536
    buffer_load_dwordx4 v42, s[32:35], s63 offen offset:0 lds
    v_cvt_pk_bf16_f32 v183, v31, v35
    v_cvt_pk_bf16_f32 v179, -v35, v31
    v_add_f32 v24, 0x41800000, v52
    v_mul_f32 v24, v24, v36
    v_add_f32 v25, v24, v36
    v_add_f32 v26, v25, v36
    v_add_f32 v27, v26, v36
    v_cos_f32 v28, v24
    v_sin_f32 v32, v24
    v_cos_f32 v29, v25
    v_sin_f32 v33, v25
    buffer_load_dwordx4 v43, s[32:35], s63 offen offset:1024 lds
    v_cos_f32 v30, v26
    v_sin_f32 v34, v26
    v_cos_f32 v31, v27
    v_sin_f32 v35, v27
    v_cvt_pk_bf16_f32 v172, v28, v32
    v_cvt_pk_bf16_f32 v168, -v32, v28
    v_cvt_pk_bf16_f32 v173, v29, v33
    v_cvt_pk_bf16_f32 v169, -v33, v29
    v_cvt_pk_bf16_f32 v174, v30, v34
    v_cvt_pk_bf16_f32 v170, -v34, v30
    s_add_u32 m0, s70, 0
    s_add_u32 s63, s72, 98304
    buffer_load_dwordx4 v42, s[32:35], s63 offen offset:0 lds
    v_cvt_pk_bf16_f32 v175, v31, v35
    v_cvt_pk_bf16_f32 v171, -v35, v31
    s_and_b32 s57, s53, 1
    s_lshl_b32 s57, s57, 5
    s_add_u32 s57, s57, s54
    v_cvt_f32_u32 v38, s57
    v_fmac_f32 v38, 2.0, v52
    v_mul_f32 v39, 0x3a000000, v37
    v_mul_f32 v36, 0x3a800000, v37
    v_mul_f32 v24, v38, v39
    v_add_f32 v25, v24, v36
    v_add_f32 v26, v25, v36
    v_add_f32 v27, v26, v36
    v_cos_f32 v148, v24
    buffer_load_dwordx4 v43, s[32:35], s63 offen offset:1024 lds
    v_sin_f32 v140, v24
    v_cos_f32 v149, v25
    v_sin_f32 v141, v25
    v_cos_f32 v150, v26
    v_sin_f32 v142, v26
    v_cos_f32 v151, v27
    v_sin_f32 v143, v27
    s_add_u32 m0, s70, 2048
    s_add_u32 s63, s72, 114688
    buffer_load_dwordx4 v42, s[32:35], s63 offen offset:0 lds
    v_add_f32 v37, 0x41800000, v23
    v_mul_f32 v36, 0x3d000000, v37
    v_mul_f32 v24, v52, v36
    v_add_f32 v25, v24, v36
    v_add_f32 v26, v25, v36
    v_add_f32 v27, v26, v36
    v_cos_f32 v28, v24
    v_sin_f32 v32, v24
    v_cos_f32 v29, v25
    v_sin_f32 v33, v25
    buffer_load_dwordx4 v43, s[32:35], s63 offen offset:1024 lds
    v_cos_f32 v30, v26
    v_sin_f32 v34, v26
    v_cos_f32 v31, v27
    v_sin_f32 v35, v27
    v_cvt_pk_bf16_f32 v164, v28, v32
    v_cvt_pk_bf16_f32 v160, -v32, v28
    v_cvt_pk_bf16_f32 v165, v29, v33
    v_cvt_pk_bf16_f32 v161, -v33, v29
    v_cvt_pk_bf16_f32 v166, v30, v34
    v_cvt_pk_bf16_f32 v162, -v34, v30
    s_add_u32 m0, s70, 4096
    s_add_u32 s63, s73, 147456
    buffer_load_dwordx4 v42, s[32:35], s63 offen offset:0 lds
    v_cvt_pk_bf16_f32 v167, v31, v35
    v_cvt_pk_bf16_f32 v163, -v35, v31
    v_add_f32 v24, 0x41800000, v52
    v_mul_f32 v24, v24, v36
    v_add_f32 v25, v24, v36
    v_add_f32 v26, v25, v36
    v_add_f32 v27, v26, v36
    v_cos_f32 v28, v24
    v_sin_f32 v32, v24
    v_cos_f32 v29, v25
    v_sin_f32 v33, v25
    buffer_load_dwordx4 v43, s[32:35], s63 offen offset:1024 lds
    v_cos_f32 v30, v26
    v_sin_f32 v34, v26
    v_cos_f32 v31, v27
    v_sin_f32 v35, v27
    v_cvt_pk_bf16_f32 v156, v28, v32
    v_cvt_pk_bf16_f32 v152, -v32, v28
    v_cvt_pk_bf16_f32 v157, v29, v33
    v_cvt_pk_bf16_f32 v153, -v33, v29
    v_cvt_pk_bf16_f32 v158, v30, v34
    v_cvt_pk_bf16_f32 v154, -v34, v30
    s_add_u32 m0, s70, 6144
    s_add_u32 s63, s73, 163840
    buffer_load_dwordx4 v42, s[32:35], s63 offen offset:0 lds
    v_cvt_pk_bf16_f32 v159, v31, v35
    v_cvt_pk_bf16_f32 v155, -v35, v31
    s_and_b32 s57, s53, 1
    s_lshl_b32 s57, s57, 5
    s_add_u32 s57, s57, s54
    v_cvt_f32_u32 v38, s57
    v_fmac_f32 v38, 2.0, v52
    v_mul_f32 v39, 0x3a000000, v37
    v_mul_f32 v36, 0x3a800000, v37
    v_mul_f32 v24, v38, v39
    v_add_f32 v25, v24, v36
    v_add_f32 v26, v25, v36
    v_add_f32 v27, v26, v36
    v_cos_f32 v144, v24
    buffer_load_dwordx4 v43, s[32:35], s63 offen offset:1024 lds
    v_sin_f32 v136, v24
    v_cos_f32 v145, v25
    v_sin_f32 v137, v25
    v_cos_f32 v146, v26
    v_sin_f32 v138, v26
    v_cos_f32 v147, v27
    v_sin_f32 v139, v27
    s_add_u32 m0, s70, 8192
    s_add_u32 s63, s73, 180224
    buffer_load_dwordx4 v42, s[32:35], s63 offen offset:0 lds
    s_and_b32 s57, s2, 127
    s_lshl_b32 s58, s57, 14
    s_lshl_b32 s59, s53, 12
    s_add_u32 s58, s58, s59
    s_add_u32 s58, s58, 2097152
    v_add_u32 v16, s58, v20
    s_lshr_b32 s59, s53, 1
    s_or_b32 s76, s57, s59
    s_bfe_u32 s58, s2, 0x30004
    s_lshl_b32 s58, s58, 3
    s_and_b32 s60, s2, 7
    s_add_u32 s58, s58, s60
    s_lshl_b32 s58, s58, 7
    s_and_b32 s60, s2, 8
    buffer_load_dwordx4 v43, s[32:35], s63 offen offset:1024 lds
    s_lshl_b32 s60, s60, 3
    s_add_u32 s58, s58, s60
    s_cmp_eq_u32 s76, 0
    s_cselect_b32 s58, 8192, s58
    s_lshl_b32 s59, s59, 5
    s_add_u32 s58, s58, s59
    s_and_b32 s59, s53, 1
    s_lshl_b32 s60, s54, 4
    s_add_u32 s60, s60, s59
    s_mul_i32 s60, s60, 66560
    s_add_u32 s58, s58, s60
    s_add_u32 s58, s58, 20447232
    v_lshrrev_b32 v24, 1, v18
    v_lshl_add_u32 v25, v19, 4, v24
    s_add_u32 m0, s70, 10240
    s_add_u32 s63, s73, 196608
    buffer_load_dwordx4 v42, s[32:35], s63 offen offset:0 lds
    v_mul_u32_u24 v25, 8320, v25
    v_and_b32 v26, 1, v18
    v_lshl_add_u32 v25, v26, 4, v25
    v_add_u32 v8, s58, v25
    v_add_u32 v9, 532480, v8
    s_lshl_b32 s58, s53, 9
    v_lshrrev_b32 v27, 1, v19
    v_lshl_add_u32 v27, v27, 4, v18
    v_lshl_add_u32 v27, v27, 4, s58
    v_and_b32 v28, 1, v19
    v_lshl_add_u32 v62, v28, 3, v27
    s_lshl_b32 s58, s53, 11
    v_add_u32 v63, s58, v20
    v_and_b32 v27, 3, v24
    buffer_load_dwordx4 v43, s[32:35], s63 offen offset:1024 lds
    v_lshl_add_u32 v27, v27, 2, v26
    v_lshl_add_u32 v27, v19, 4, v27
    v_lshrrev_b32 v28, 3, v18
    v_lshlrev_b32 v28, 11, v28
    v_lshl_add_u32 v27, v27, 4, v28
    s_lshl_b32 s59, s59, 10
    s_lshr_b32 s60, s53, 1
    s_lshl_b32 s60, s60, 5
    s_add_u32 s59, s59, s60
    v_add_u32 v1, s59, v27
    v_lshrrev_b32 v27, 2, v18
    v_lshl_add_u32 v27, v19, 4, v27
    v_lshlrev_b32 v27, 14, v27
    v_and_b32 v28, 3, v18
    s_add_u32 m0, s70, 12288
    s_add_u32 s63, s73, 229376
    buffer_load_dwordx4 v42, s[32:35], s63 offen offset:0 lds
    v_lshl_add_u32 v27, v28, 4, v27
    s_lshl_b32 s58, s53, 16
    s_lshl_b32 s59, s54, 13
    s_add_u32 s58, s58, s59
    s_lshl_b32 s57, s57, 6
    s_add_u32 s58, s58, s57
    s_add_u32 s58, s58, 6291456
    v_add_u32 v2, s58, v27
    v_add_u32 v3, 1048576, v2
    v_add_u32 v53, 4096, v20
    v_add_u32 v54, 8192, v20
    v_add_u32 v55, 12288, v20
    s_mul_i32 s77, s54, 0x80008000
    s_cmp_lg_u32 s76, 0
    s_cbranch_scc1 L_zaddr
    s_and_b32 s59, s53, 1
    s_lshl_b32 s59, s59, 4
    v_add_u32 v24, s59, v18
    v_lshlrev_b32 v25, 10, v19
    v_lshl_add_u32 v56, v24, 3, v25
    v_lshl_add_u32 v24, v24, 1, s54
    v_lshl_add_u32 v24, v19, 8, v24
    v_sub_u32 v25, 2048, v24
    v_and_b32 v25, 2046, v25
    v_lshlrev_b32 v92, 2, v25
    v_sub_u32 v25, 1984, v24
    v_and_b32 v25, 2046, v25
    v_lshlrev_b32 v93, 2, v25
    v_sub_u32 v25, 1920, v24
    v_and_b32 v25, 2046, v25
    v_lshlrev_b32 v94, 2, v25
    v_sub_u32 v25, 1856, v24
    v_and_b32 v25, 2046, v25
    v_lshlrev_b32 v95, 2, v25
    v_sub_u32 v25, 1024, v24
    v_and_b32 v25, 2046, v25
    v_lshlrev_b32 v104, 2, v25
    v_sub_u32 v25, 960, v24
    v_and_b32 v25, 2046, v25
    v_lshlrev_b32 v105, 2, v25
    v_sub_u32 v25, 896, v24
    v_and_b32 v25, 2046, v25
    v_lshlrev_b32 v106, 2, v25
    v_sub_u32 v25, 832, v24
    v_and_b32 v25, 2046, v25
    v_lshlrev_b32 v107, 2, v25
L_zaddr:
    buffer_load_dwordx4 v43, s[32:35], s63 offen offset:1024 lds
    s_add_u32 m0, s70, 14336
    s_add_u32 s63, s73, 245760
    buffer_load_dwordx4 v42, s[32:35], s63 offen offset:0 lds
    buffer_load_dwordx4 v43, s[32:35], s63 offen offset:1024 lds
    s_add_u32 m0, s70, 16384
    s_add_u32 s63, s73, 278528
    buffer_load_dwordx4 v42, s[32:35], s63 offen offset:0 lds
    buffer_load_dwordx4 v43, s[32:35], s63 offen offset:1024 lds
    s_add_u32 m0, s70, 18432
    s_add_u32 s63, s73, 294912
    buffer_load_dwordx4 v42, s[32:35], s63 offen offset:0 lds
    buffer_load_dwordx4 v43, s[32:35], s63 offen offset:1024 lds
    s_waitcnt vmcnt(26)
    v_lshlrev_b32 v60, 16, v60
    v_mul_f32 v32, 0xbfb8aa3b, v60
    v_exp_f32 v32, v32
    s_nop 0
    v_add_f32 v32, 1.0, v32
    v_rcp_f32 v32, v32
    s_nop 0
    v_mul_f32 v60, v60, v32
    v_cvt_pk_bf16_f32 v60, v60, v60
    v_and_b32 v60, 0xffff0000, v60
    s_waitcnt vmcnt(24)
    v_lshlrev_b32 v61, 16, v61
    v_mul_f32 v32, 0xbfb8aa3b, v61
    v_exp_f32 v32, v32
    s_nop 0
    v_add_f32 v32, 1.0, v32
    v_rcp_f32 v32, v32
    s_nop 0
    v_mul_f32 v61, v61, v32
    v_cvt_pk_bf16_f32 v61, v61, v61
    v_and_b32 v61, 0xffff0000, v61
    v_lshlrev_b32 v24, 16, v228
    v_and_b32 v25, 0xffff0000, v228
    v_lshlrev_b32 v26, 16, v229
    v_and_b32 v27, 0xffff0000, v229
    v_lshlrev_b32 v28, 16, v230
    v_and_b32 v29, 0xffff0000, v230
    v_lshlrev_b32 v30, 16, v231
    v_and_b32 v31, 0xffff0000, v231
    v_lshlrev_b32 v32, 16, v224
    v_and_b32 v33, 0xffff0000, v224
    v_lshlrev_b32 v34, 16, v225
    v_and_b32 v35, 0xffff0000, v225
    v_lshlrev_b32 v36, 16, v226
    v_and_b32 v37, 0xffff0000, v226
    v_lshlrev_b32 v38, 16, v227
    v_and_b32 v39, 0xffff0000, v227
    v_pk_mul_f32 v[24:25], v[24:25], v[60:61] op_sel_hi:[1,0]
    v_pk_mul_f32 v[26:27], v[26:27], v[60:61] op_sel_hi:[1,0]
    v_pk_mul_f32 v[28:29], v[28:29], v[60:61] op_sel_hi:[1,0]
    v_pk_mul_f32 v[30:31], v[30:31], v[60:61] op_sel_hi:[1,0]
    v_pk_fma_f32 v[24:25], v[32:33], v[60:61], v[24:25] op_sel:[0,1,0] op_sel_hi:[1,1,1]
    v_pk_fma_f32 v[26:27], v[34:35], v[60:61], v[26:27] op_sel:[0,1,0] op_sel_hi:[1,1,1]
    v_pk_fma_f32 v[28:29], v[36:37], v[60:61], v[28:29] op_sel:[0,1,0] op_sel_hi:[1,1,1]
    v_pk_fma_f32 v[30:31], v[38:39], v[60:61], v[30:31] op_sel:[0,1,0] op_sel_hi:[1,1,1]
    s_nop 0
    v_permlane32_swap_b32 v24, v28
    v_permlane32_swap_b32 v25, v29
    v_permlane32_swap_b32 v26, v30
    v_permlane32_swap_b32 v27, v31
    v_pk_add_f32 v[24:25], v[24:25], v[28:29]
    v_pk_add_f32 v[26:27], v[26:27], v[30:31]
    s_nop 1
    v_permlane16_swap_b32 v24, v26
    v_permlane16_swap_b32 v25, v27
    v_pk_add_f32 v[24:25], v[24:25], v[26:27]
    s_nop 1
    v_add_f32_dpp v24, v24, v24 row_ror:2 row_mask:0xf bank_mask:0xf
    v_add_f32_dpp v25, v25, v25 row_ror:2 row_mask:0xf bank_mask:0xf
    s_nop 0
    v_add_f32_dpp v24, v24, v24 row_ror:4 row_mask:0xf bank_mask:0xf
    v_add_f32_dpp v25, v25, v25 row_ror:4 row_mask:0xf bank_mask:0xf
    s_nop 0
    v_add_f32_dpp v24, v24, v24 row_ror:8 row_mask:0xf bank_mask:0xf
    v_add_f32_dpp v25, v25, v25 row_ror:8 row_mask:0xf bank_mask:0xf
    s_mov_b64 exec, s[64:65]
    ds_write_b64 v21, v[24:25] offset:22784
    s_mov_b64 exec, -1
    s_waitcnt lgkmcnt(0)
    s_barrier
    s_cmp_lg_u32 s53, 1
    s_cbranch_scc1 L_pubM
    ds_read_b128 v[24:27], v20 offset:22784
    ds_read_b128 v[28:31], v20 offset:22848
    ds_read_b128 v[32:35], v20 offset:22912
    ds_read_b128 v[36:39], v20 offset:22976
    s_waitcnt lgkmcnt(2)
    v_pk_add_f32 v[24:25], v[24:25], v[28:29]
    v_pk_add_f32 v[26:27], v[26:27], v[30:31]
    s_waitcnt lgkmcnt(0)
    v_pk_add_f32 v[32:33], v[32:33], v[36:37]
    v_pk_add_f32 v[34:35], v[34:35], v[38:39]
    v_pk_add_f32 v[24:25], v[24:25], v[32:33]
    v_pk_add_f32 v[26:27], v[26:27], v[34:35]
    v_mov_b32 v117, s52
    v_mov_b32 v119, s52
    v_cvt_pk_bf16_f32 v116, v24, v25
    v_cvt_pk_bf16_f32 v118, v26, v27
L_pubM:
    s_waitcnt lgkmcnt(0)
    global_load_dwordx4 v[120:123], v16, s[26:27] offset:0 sc1
    global_load_dwordx4 v[124:127], v16, s[26:27] offset:1024 sc1
    global_load_dwordx4 v[128:131], v16, s[26:27] offset:2048 sc1
    global_load_dwordx4 v[132:135], v16, s[26:27] offset:3072 sc1
    s_cmp_lg_u32 s53, 1
    s_cbranch_scc1 L_pubM2
    s_mov_b64 exec, 15
    global_store_dwordx4 v58, v[116:119], s[26:27] sc1
    s_mov_b64 exec, -1
L_pubM2:
    s_waitcnt vmcnt(0)
L_B:
    v_max3_u32 v24, v120, v121, v122
    v_max3_u32 v24, v24, v123, v124
    v_max3_u32 v24, v24, v125, v126
    v_max3_u32 v24, v24, v127, v128
    v_max3_u32 v24, v24, v129, v130
    v_max3_u32 v24, v24, v131, v132
    v_max3_u32 v24, v24, v133, v134
    v_max_u32 v24, v24, v135
    v_cmp_eq_u32 vcc, -1, v24
    s_cbranch_vccnz L_B_retry
L_B_ok:
    s_barrier
    global_load_dwordx4 v[4:7], v8, s[26:27] sc1
    global_load_dwordx4 v[64:67], v9, s[26:27] sc1
    s_cmp_lg_u32 s76, 0
    s_cbranch_scc1 L_bq
    global_load_dwordx4 v[108:111], v8, s[26:27] offset:32 sc1
    global_load_dwordx4 v[112:115], v9, s[26:27] offset:32 sc1
L_bq:
    s_add_u32 s63, s88, 0
    buffer_load_dwordx4 a[0:3], v20, s[36:39], s63 offen sc1
    v_mfma_f32_16x16x32_bf16 v[252:255], v[120:123], v[220:223], 0
    v_xor_b32 v128, s77, v128
    v_xor_b32 v129, s77, v129
    v_mfma_f32_16x16x32_bf16 v[244:247], v[120:123], v[216:219], 0
    v_xor_b32 v130, s77, v130
    v_xor_b32 v131, s77, v131
    v_mfma_f32_16x16x32_bf16 v[248:251], v[120:123], v[204:207], 0
    v_xor_b32 v132, s77, v132
    v_xor_b32 v133, s77, v133
    v_mfma_f32_16x16x32_bf16 v[240:243], v[120:123], v[200:203], 0
    v_xor_b32 v134, s77, v134
    v_xor_b32 v135, s77, v135
    v_mfma_f32_16x16x32_bf16 v[252:255], v[124:127], v[212:215], v[252:255]
    buffer_load_dwordx4 a[12:15], v53, s[36:39], s63 offen sc1
    v_mfma_f32_16x16x32_bf16 v[244:247], v[124:127], v[208:211], v[244:247]
    v_mfma_f32_16x16x32_bf16 v[248:251], v[124:127], v[196:199], v[248:251]
    v_mfma_f32_16x16x32_bf16 v[240:243], v[124:127], v[192:195], v[240:243]
    v_mfma_f32_16x16x32_bf16 v[252:255], v[128:131], v[220:223], v[252:255]
    v_mfma_f32_16x16x32_bf16 v[244:247], v[128:131], v[216:219], v[244:247]
    v_mfma_f32_16x16x32_bf16 v[248:251], v[128:131], v[204:207], v[248:251]
    v_mfma_f32_16x16x32_bf16 v[240:243], v[128:131], v[200:203], v[240:243]
    buffer_load_dwordx4 a[24:27], v54, s[36:39], s63 offen sc1
    v_mfma_f32_16x16x32_bf16 v[252:255], v[132:135], v[212:215], v[252:255]
    v_mfma_f32_16x16x32_bf16 v[244:247], v[132:135], v[208:211], v[244:247]
    v_mfma_f32_16x16x32_bf16 v[248:251], v[132:135], v[196:199], v[248:251]
    v_mfma_f32_16x16x32_bf16 v[240:243], v[132:135], v[192:195], v[240:243]
    s_nop 4
    v_pk_mul_f32 v[236:237], v[252:253], v[188:189]
    v_pk_mul_f32 v[228:229], v[244:245], v[188:189]
    v_pk_mul_f32 v[238:239], v[254:255], v[188:189]
    v_pk_mul_f32 v[230:231], v[246:247], v[188:189]
    v_pk_mul_f32 v[232:233], v[248:249], v[190:191]
    v_pk_mul_f32 v[224:225], v[240:241], v[190:191]
    v_pk_mul_f32 v[234:235], v[250:251], v[190:191]
    v_pk_mul_f32 v[226:227], v[242:243], v[190:191]
    v_pk_fma_f32 v[236:237], v[244:245], v[184:185], v[236:237]
    buffer_load_dwordx4 a[36:39], v55, s[36:39], s63 offen sc1
    v_pk_fma_f32 v[228:229], v[252:253], v[184:185], v[228:229] neg_lo:[0,1,0] neg_hi:[0,1,0]
    v_pk_fma_f32 v[238:239], v[246:247], v[184:185], v[238:239]
    v_pk_fma_f32 v[230:231], v[254:255], v[184:185], v[230:231] neg_lo:[0,1,0] neg_hi:[0,1,0]
    v_pk_fma_f32 v[232:233], v[240:241], v[186:187], v[232:233]
    v_pk_fma_f32 v[224:225], v[248:249], v[186:187], v[224:225] neg_lo:[0,1,0] neg_hi:[0,1,0]
    v_pk_fma_f32 v[234:235], v[242:243], v[186:187], v[234:235]
    v_pk_fma_f32 v[226:227], v[250:251], v[186:187], v[226:227] neg_lo:[0,1,0] neg_hi:[0,1,0]
    v_cvt_pk_bf16_f32 v24, v236, v228
    v_cvt_pk_bf16_f32 v25, v237, v229
    v_cvt_pk_bf16_f32 v26, v238, v230
    v_cvt_pk_bf16_f32 v27, v239, v231
    v_cvt_pk_bf16_f32 v28, v232, v224
    v_cvt_pk_bf16_f32 v29, v233, v225
    v_cvt_pk_bf16_f32 v30, v234, v226
    v_cvt_pk_bf16_f32 v31, v235, v227
    ds_write_b64 v62, v[24:25] offset:0
    ds_write_b64 v62, v[26:27] offset:4096
    ds_write_b64 v62, v[28:29] offset:2048
    ds_write_b64 v62, v[30:31] offset:6144
    s_waitcnt lgkmcnt(0)
    s_barrier
    ds_read_b128 v[120:123], v63 offset:0
    ds_read_b128 v[124:127], v63 offset:1024
    s_waitcnt lgkmcnt(1)
    v_mfma_f32_16x16x32_bf16 v[252:255], v[180:183], v[120:123], 0
    s_add_u32 s63, s89, 0
    buffer_load_dwordx4 a[4:7], v20, s[36:39], s63 offen sc1
    s_waitcnt vmcnt(6)
    v_lshlrev_b32 v68, 16, v4
    v_and_b32 v84, 0xffff0000, v4
    v_mfma_f32_16x16x32_bf16 v[244:247], v[176:179], v[120:123], 0
    v_lshlrev_b32 v69, 16, v5
    v_and_b32 v85, 0xffff0000, v5
    v_mfma_f32_16x16x32_bf16 v[248:251], v[164:167], v[120:123], 0
    v_lshlrev_b32 v70, 16, v6
    v_and_b32 v86, 0xffff0000, v6
    v_mfma_f32_16x16x32_bf16 v[240:243], v[160:163], v[120:123], 0
    v_lshlrev_b32 v71, 16, v7
    v_and_b32 v87, 0xffff0000, v7
    s_waitcnt lgkmcnt(0)
    v_mfma_f32_16x16x32_bf16 v[252:255], v[172:175], v[124:127], v[252:255]
    s_waitcnt vmcnt(5)
    v_lshlrev_b32 v80, 16, v64
    buffer_load_dwordx4 a[16:19], v53, s[36:39], s63 offen sc1
    v_and_b32 v88, 0xffff0000, v64
    v_mfma_f32_16x16x32_bf16 v[244:247], v[168:171], v[124:127], v[244:247]
    v_lshlrev_b32 v81, 16, v65
    v_and_b32 v89, 0xffff0000, v65
    v_mfma_f32_16x16x32_bf16 v[248:251], v[156:159], v[124:127], v[248:251]
    v_lshlrev_b32 v82, 16, v66
    v_and_b32 v90, 0xffff0000, v66
    v_mfma_f32_16x16x32_bf16 v[240:243], v[152:155], v[124:127], v[240:243]
    v_lshlrev_b32 v83, 16, v67
    v_and_b32 v91, 0xffff0000, v67
    v_pk_mul_f32 v[236:237], v[252:253], v[68:69]
    v_pk_mul_f32 v[228:229], v[244:245], v[68:69] neg_lo:[0,1] neg_hi:[0,1]
    v_pk_mul_f32 v[238:239], v[254:255], v[70:71]
    v_pk_mul_f32 v[230:231], v[246:247], v[70:71] neg_lo:[0,1] neg_hi:[0,1]
    v_pk_mul_f32 v[232:233], v[248:249], v[80:81]
    s_nop 0
    v_pk_mul_f32 v[224:225], v[240:241], v[80:81] neg_lo:[0,1] neg_hi:[0,1]
    buffer_load_dwordx4 a[28:31], v54, s[36:39], s63 offen sc1
    v_pk_mul_f32 v[234:235], v[250:251], v[82:83]
    v_pk_mul_f32 v[226:227], v[242:243], v[82:83] neg_lo:[0,1] neg_hi:[0,1]
    v_pk_fma_f32 v[236:237], v[244:245], v[84:85], v[236:237] neg_lo:[0,1,0] neg_hi:[0,1,0]
    v_pk_fma_f32 v[228:229], v[252:253], v[84:85], v[228:229] neg_lo:[0,1,0] neg_hi:[0,1,0]
    v_pk_fma_f32 v[238:239], v[246:247], v[86:87], v[238:239] neg_lo:[0,1,0] neg_hi:[0,1,0]
    v_pk_fma_f32 v[230:231], v[254:255], v[86:87], v[230:231] neg_lo:[0,1,0] neg_hi:[0,1,0]
    v_pk_fma_f32 v[232:233], v[240:241], v[88:89], v[232:233] neg_lo:[0,1,0] neg_hi:[0,1,0]
    v_pk_fma_f32 v[224:225], v[248:249], v[88:89], v[224:225] neg_lo:[0,1,0] neg_hi:[0,1,0]
    v_pk_fma_f32 v[234:235], v[242:243], v[90:91], v[234:235] neg_lo:[0,1,0] neg_hi:[0,1,0]
    v_pk_fma_f32 v[226:227], v[250:251], v[90:91], v[226:227] neg_lo:[0,1,0] neg_hi:[0,1,0]
    s_and_b32 s57, s2, 127
    s_cbranch_scc1 L_nospec
    s_cmp_lg_u32 s76, 0
    s_cbranch_scc1 L_spec_w
    v_add_u32 v32, 18432, v56
    ds_write2_b32 v32, v252, v244 offset0:0 offset1:1
    v_add_u32 v32, 18688, v56
    ds_write2_b32 v32, v253, v245 offset0:0 offset1:1
    v_add_u32 v32, 18944, v56
    ds_write2_b32 v32, v254, v246 offset0:0 offset1:1
    v_add_u32 v32, 19200, v56
    ds_write2_b32 v32, v255, v247 offset0:0 offset1:1
    v_add_u32 v32, 22528, v56
    ds_write2_b32 v32, v248, v240 offset0:0 offset1:1
    v_add_u32 v32, 22784, v56
    ds_write2_b32 v32, v249, v241 offset0:0 offset1:1
    v_add_u32 v32, 23040, v56
    ds_write2_b32 v32, v250, v242 offset0:0 offset1:1
    v_add_u32 v32, 23296, v56
    ds_write2_b32 v32, v251, v243 offset0:0 offset1:1
    s_waitcnt vmcnt(7)
    v_lshlrev_b32 v220, 16, v108
    v_and_b32 v212, 0xffff0000, v108
    v_lshlrev_b32 v221, 16, v109
    v_and_b32 v213, 0xffff0000, v109
    v_lshlrev_b32 v222, 16, v110
    v_and_b32 v214, 0xffff0000, v110
    v_lshlrev_b32 v223, 16, v111
    v_and_b32 v215, 0xffff0000, v111
    s_waitcnt vmcnt(7)
    v_lshlrev_b32 v216, 16, v112
    v_and_b32 v208, 0xffff0000, v112
    v_lshlrev_b32 v217, 16, v113
    v_and_b32 v209, 0xffff0000, v113
    v_lshlrev_b32 v218, 16, v114
    v_and_b32 v210, 0xffff0000, v114
    v_lshlrev_b32 v219, 16, v115
    v_and_b32 v211, 0xffff0000, v115
L_spec_w:
    s_waitcnt lgkmcnt(0)
    s_barrier
    s_cmp_lg_u32 s76, 0
    s_cbranch_scc1 L_spec_r
    ds_read_b64 v[24:25], v92 offset:18432
    ds_read_b64 v[26:27], v93 offset:18432
    ds_read_b64 v[28:29], v94 offset:18432
    ds_read_b64 v[30:31], v95 offset:18432
    ds_read_b64 v[32:33], v104 offset:18432
    ds_read_b64 v[34:35], v105 offset:18432
    ds_read_b64 v[36:37], v106 offset:18432
    ds_read_b64 v[38:39], v107 offset:18432
    s_waitcnt lgkmcnt(7)
    v_fmac_f32 v236, v220, v24
    v_fmac_f32 v228, v220, v25
    v_fmac_f32 v236, v212, v25
    v_fma_f32 v228, -v212, v24, v228
    s_waitcnt lgkmcnt(6)
    v_fmac_f32 v237, v221, v26
    v_fmac_f32 v229, v221, v27
    v_fmac_f32 v237, v213, v27
    v_fma_f32 v229, -v213, v26, v229
    s_waitcnt lgkmcnt(5)
    v_fmac_f32 v238, v222, v28
    v_fmac_f32 v230, v222, v29
    v_fmac_f32 v238, v214, v29
    v_fma_f32 v230, -v214, v28, v230
    s_waitcnt lgkmcnt(4)
    v_fmac_f32 v239, v223, v30
    v_fmac_f32 v231, v223, v31
    v_fmac_f32 v239, v215, v31
    v_fma_f32 v231, -v215, v30, v231
    s_waitcnt lgkmcnt(3)
    v_fmac_f32 v232, v216, v32
    v_fmac_f32 v224, v216, v33
    v_fmac_f32 v232, v208, v33
    v_fma_f32 v224, -v208, v32, v224
    s_waitcnt lgkmcnt(2)
    v_fmac_f32 v233, v217, v34
    v_fmac_f32 v225, v217, v35
    v_fmac_f32 v233, v209, v35
    v_fma_f32 v225, -v209, v34, v225
    s_waitcnt lgkmcnt(1)
    v_fmac_f32 v234, v218, v36
    v_fmac_f32 v226, v218, v37
    v_fmac_f32 v234, v210, v37
    v_fma_f32 v226, -v210, v36, v226
    s_waitcnt lgkmcnt(0)
    v_fmac_f32 v235, v219, v38
    v_fmac_f32 v227, v219, v39
    v_fmac_f32 v235, v211, v39
    v_fma_f32 v227, -v211, v38, v227
L_spec_r:
L_nospec:
    buffer_load_dwordx4 a[40:43], v55, s[36:39], s63 offen sc1
    v_cvt_pk_bf16_f32 v120, v236, v228
    v_cvt_pk_bf16_f32 v121, v237, v229
    v_cvt_pk_bf16_f32 v122, v238, v230
    v_cvt_pk_bf16_f32 v123, v239, v231
    v_cvt_pk_bf16_f32 v124, v232, v224
    v_cvt_pk_bf16_f32 v125, v233, v225
    v_cvt_pk_bf16_f32 v126, v234, v226
    v_cvt_pk_bf16_f32 v127, v235, v227
    v_mfma_f32_16x16x32_bf16 v[252:255], v[120:123], v[180:183], 0
    v_mfma_f32_16x16x32_bf16 v[244:247], v[120:123], v[176:179], 0
    v_mfma_f32_16x16x32_bf16 v[248:251], v[120:123], v[164:167], 0
    v_mfma_f32_16x16x32_bf16 v[240:243], v[120:123], v[160:163], 0
    v_mfma_f32_16x16x32_bf16 v[252:255], v[124:127], v[172:175], v[252:255]
    s_add_u32 s63, s90, 0
    buffer_load_dwordx4 a[8:11], v20, s[36:39], s63 offen sc1
    v_mfma_f32_16x16x32_bf16 v[244:247], v[124:127], v[168:171], v[244:247]
    v_mfma_f32_16x16x32_bf16 v[248:251], v[124:127], v[156:159], v[248:251]
    v_mfma_f32_16x16x32_bf16 v[240:243], v[124:127], v[152:155], v[240:243]
    s_nop 2
    v_pk_mul_f32 v[236:237], v[252:253], v[148:149]
    s_nop 1
    v_pk_mul_f32 v[228:229], v[244:245], v[148:149]
    v_pk_mul_f32 v[238:239], v[254:255], v[150:151]
    v_pk_mul_f32 v[230:231], v[246:247], v[150:151]
    v_pk_mul_f32 v[232:233], v[248:249], v[144:145]
    v_pk_mul_f32 v[224:225], v[240:241], v[144:145]
    v_pk_mul_f32 v[234:235], v[250:251], v[146:147]
    v_pk_mul_f32 v[226:227], v[242:243], v[146:147]
    v_pk_fma_f32 v[236:237], v[244:245], v[140:141], v[236:237]
    v_pk_fma_f32 v[228:229], v[252:253], v[140:141], v[228:229] neg_lo:[0,1,0] neg_hi:[0,1,0]
    v_pk_fma_f32 v[238:239], v[246:247], v[142:143], v[238:239]
    v_pk_fma_f32 v[230:231], v[254:255], v[142:143], v[230:231] neg_lo:[0,1,0] neg_hi:[0,1,0]
    v_pk_fma_f32 v[232:233], v[240:241], v[136:137], v[232:233]
    buffer_load_dwordx4 a[20:23], v53, s[36:39], s63 offen sc1
    v_pk_fma_f32 v[224:225], v[248:249], v[136:137], v[224:225] neg_lo:[0,1,0] neg_hi:[0,1,0]
    v_pk_fma_f32 v[234:235], v[242:243], v[138:139], v[234:235]
    v_pk_fma_f32 v[226:227], v[250:251], v[138:139], v[226:227] neg_lo:[0,1,0] neg_hi:[0,1,0]
    v_cvt_pk_bf16_f32 v24, v236, v228
    v_cvt_pk_bf16_f32 v25, v237, v229
    v_cvt_pk_bf16_f32 v26, v238, v230
    v_cvt_pk_bf16_f32 v27, v239, v231
    v_cvt_pk_bf16_f32 v28, v232, v224
    v_cvt_pk_bf16_f32 v29, v233, v225
    v_cvt_pk_bf16_f32 v30, v234, v226
    v_cvt_pk_bf16_f32 v31, v235, v227
    ds_write_b128 v1, v[24:27] offset:8192
    ds_write_b128 v1, v[28:31] offset:12288
    s_waitcnt lgkmcnt(0)
    s_barrier
    ds_read_b128 v[120:123], v63 offset:8192
    ds_read_b128 v[124:127], v63 offset:9216
    s_waitcnt lgkmcnt(1)
    v_mfma_f32_16x16x32_bf16 v[252:255], v[180:183], v[120:123], 0
    v_mfma_f32_16x16x32_bf16 v[244:247], v[176:179], v[120:123], 0
    v_mfma_f32_16x16x32_bf16 v[248:251], v[164:167], v[120:123], 0
    buffer_load_dwordx4 a[32:35], v54, s[36:39], s63 offen sc1
    v_mfma_f32_16x16x32_bf16 v[240:243], v[160:163], v[120:123], 0
    s_waitcnt lgkmcnt(0)
    v_mfma_f32_16x16x32_bf16 v[252:255], v[172:175], v[124:127], v[252:255]
    v_mfma_f32_16x16x32_bf16 v[244:247], v[168:171], v[124:127], v[244:247]
    v_mfma_f32_16x16x32_bf16 v[248:251], v[156:159], v[124:127], v[248:251]
    v_mfma_f32_16x16x32_bf16 v[240:243], v[152:155], v[124:127], v[240:243]
    s_nop 5
    v_cvt_pk_bf16_f32 v24, v252, v244
    v_cvt_pk_bf16_f32 v25, v253, v245
    v_cvt_pk_bf16_f32 v26, v254, v246
    v_cvt_pk_bf16_f32 v27, v255, v247
    v_cvt_pk_bf16_f32 v28, v248, v240
    buffer_load_dwordx4 a[44:47], v55, s[36:39], s63 offen sc1
    v_cvt_pk_bf16_f32 v29, v249, v241
    v_cvt_pk_bf16_f32 v30, v250, v242
    v_cvt_pk_bf16_f32 v31, v251, v243
    global_store_dwordx4 v2, v[24:27], s[26:27] sc1
    global_store_dwordx4 v3, v[28:31], s[26:27] sc1
    v_add_u32 v8, 22528, v10
    v_add_u32 v9, 30720, v10
    v_lshlrev_b32 v21, 5, v18
    v_lshl_add_u32 v21, v19, 3, v21
    s_lshl_b32 s57, s53, 11
    s_add_u32 s57, s57, 152576
    v_add_u32 v16, s57, v21
    ds_read_b64 v[64:65], v16 offset:0
    ds_read_b64 v[66:67], v16 offset:512
    ds_read_b64 v[68:69], v16 offset:1024
    ds_read_b64 v[70:71], v16 offset:1536
    v_lshl_add_u32 v24, v19, 3, s83
    buffer_load_dwordx2 v[136:137], v24, s[40:43], 0 offen offset:0
    buffer_load_dwordx2 v[138:139], v24, s[40:43], 0 offen offset:32
    buffer_load_dwordx2 v[140:141], v24, s[40:43], 0 offen offset:64
    s_mul_i32 s57, s2, 8320
    s_lshl_b32 s58, s53, 11
    s_add_u32 s57, s57, s58
    s_add_u32 s57, s57, 20447232
    v_lshl_add_u32 v41, v18, 7, s57
    s_mov_b64 exec, s[68:69]
    global_load_dword v41, v41, s[26:27]
    s_mov_b64 exec, -1
    s_lshl_b32 s57, s55, 10
    s_add_u32 s57, s57, 65536
    v_lshrrev_b32 v40, 3, v17
    v_lshl_add_u32 v40, v40, 7, s57
    global_load_dword v40, v40, s[26:27]
    ds_read_b64_tr_b16 a[192:193], v48 offset:0
    ds_read_b64_tr_b16 a[196:197], v49 offset:0
    ds_read_b64_tr_b16 a[200:201], v50 offset:0
    ds_read_b64_tr_b16 a[204:205], v51 offset:0
    ds_read_b64_tr_b16 a[194:195], v48 offset:2048
    ds_read_b64_tr_b16 a[198:199], v49 offset:2048
    ds_read_b64_tr_b16 a[202:203], v50 offset:2048
    ds_read_b64_tr_b16 a[206:207], v51 offset:2048
    ds_read_b64_tr_b16 a[208:209], v48 offset:4096
    ds_read_b64_tr_b16 a[212:213], v49 offset:4096
    ds_read_b64_tr_b16 a[216:217], v50 offset:4096
    ds_read_b64_tr_b16 a[220:221], v51 offset:4096
    ds_read_b64_tr_b16 a[210:211], v48 offset:6144
    ds_read_b64_tr_b16 a[214:215], v49 offset:6144
    ds_read_b64_tr_b16 a[218:219], v50 offset:6144
    ds_read_b64_tr_b16 a[222:223], v51 offset:6144
    ds_read_b64_tr_b16 a[224:225], v44 offset:0
    ds_read_b64_tr_b16 a[228:229], v45 offset:0
    ds_read_b64_tr_b16 a[232:233], v46 offset:0
    ds_read_b64_tr_b16 a[236:237], v47 offset:0
    ds_read_b64_tr_b16 a[226:227], v44 offset:2048
    ds_read_b64_tr_b16 a[230:231], v45 offset:2048
    ds_read_b64_tr_b16 a[234:235], v46 offset:2048
    ds_read_b64_tr_b16 a[238:239], v47 offset:2048
    ds_read_b64_tr_b16 a[240:241], v44 offset:4096
    ds_read_b64_tr_b16 a[244:245], v45 offset:4096
    ds_read_b64_tr_b16 a[248:249], v46 offset:4096
    ds_read_b64_tr_b16 a[252:253], v47 offset:4096
    ds_read_b64_tr_b16 a[242:243], v44 offset:6144
    ds_read_b64_tr_b16 a[246:247], v45 offset:6144
    ds_read_b64_tr_b16 a[250:251], v46 offset:6144
    ds_read_b64_tr_b16 a[254:255], v47 offset:6144
    global_load_dwordx4 v[104:107], v8, s[26:27] offset:-2048 sc1
    s_waitcnt vmcnt(20)
    global_load_dwordx4 v[108:111], v8, s[26:27] offset:2048 sc1
    s_waitcnt vmcnt(21)
    global_load_dwordx4 v[112:115], v9, s[26:27] offset:-2048 sc1
    global_load_dwordx4 v[116:119], v9, s[26:27] offset:2048 sc1
    s_add_u32 s63, s88, 16384
    buffer_load_dwordx4 a[48:51], v20, s[36:39], s63 offen sc1
    v_lshrrev_b32 v37, 1, v19
    v_lshlrev_b32 v1, 31, v37
    v_add_u32 v2, -1, v37
    v_and_b32 v3, 1, v18
    v_lshlrev_b32 v3, 31, v3
    v_or_b32 v3, 0.5, v3
    v_cndmask_b32 v3, 0, v3, s[68:69]
    v_mov_b32 v97, 1.0
    v_cndmask_b32 v97, v97, 0.5, s[68:69]
    s_lshr_b32 s57, s79, 15
    v_cvt_f32_u32 v98, s57
    v_mul_f32 v98, 0x3c800000, v98
    v_cvt_f32_u32 v99, v37
    v_mul_f32 v99, v99, v23
    v_mul_f32 v99, 0xbef00000, v99
    v_mul_f32 v36, 0x3d800000, v23
    v_mul_f32 v24, v52, v36
    v_add_f32 v25, v24, v36
    v_add_f32 v26, v25, v36
    v_add_f32 v27, v26, v36
    v_cos_f32 v28, v24
    buffer_load_dwordx4 a[60:63], v53, s[36:39], s63 offen sc1
    v_sin_f32 v32, v24
    v_cos_f32 v29, v25
    v_sin_f32 v33, v25
    v_cos_f32 v30, v26
    v_sin_f32 v34, v26
    v_cos_f32 v31, v27
    v_sin_f32 v35, v27
    v_cvt_pk_bf16_f32 v144, v28, v32
    v_cvt_pk_bf16_f32 v148, -v32, v28
    v_xor_b32 v144, v144, v1
    v_xor_b32 v148, v148, v1
    v_cvt_pk_bf16_f32 v145, v29, v33
    v_cvt_pk_bf16_f32 v149, -v33, v29
    v_xor_b32 v145, v145, v1
    v_xor_b32 v149, v149, v1
    buffer_load_dwordx4 a[72:75], v54, s[36:39], s63 offen sc1
    v_cvt_pk_bf16_f32 v146, v30, v34
    v_cvt_pk_bf16_f32 v150, -v34, v30
    v_xor_b32 v146, v146, v1
    v_xor_b32 v150, v150, v1
    v_cvt_pk_bf16_f32 v147, v31, v35
    v_cvt_pk_bf16_f32 v151, -v35, v31
    v_xor_b32 v147, v147, v1
    v_xor_b32 v151, v151, v1
    v_fma_f32 v24, v52, v36, v99
    v_add_f32 v25, v24, v36
    v_add_f32 v26, v25, v36
    v_add_f32 v27, v26, v36
    v_cos_f32 v28, v24
    v_sin_f32 v32, v24
    v_cos_f32 v29, v25
    v_sin_f32 v33, v25
    v_cos_f32 v30, v26
    buffer_load_dwordx4 a[84:87], v55, s[36:39], s63 offen sc1
    v_sin_f32 v34, v26
    v_cos_f32 v31, v27
    v_sin_f32 v35, v27
    v_mul_f32 v38, v97, v28
    v_mul_f32 v39, v97, v32
    v_fma_f32 v39, -v3, v28, v39
    v_fma_f32 v28, v3, v32, v38
    v_mov_b32 v32, v39
    v_cvt_pk_bf16_f32 v156, v28, v32
    v_and_b32 v152, v156, v2
    v_xor_b32 v156, v156, v152
    v_cvt_pk_bf16_f32 v157, v29, v33
    v_and_b32 v153, v157, v2
    v_xor_b32 v157, v157, v153
    v_cvt_pk_bf16_f32 v158, v30, v34
    v_and_b32 v154, v158, v2
    v_xor_b32 v158, v158, v154
    v_cvt_pk_bf16_f32 v159, v31, v35
    v_and_b32 v155, v159, v2
    s_add_u32 s63, s89, 16384
    buffer_load_dwordx4 a[52:55], v20, s[36:39], s63 offen sc1
    v_xor_b32 v159, v159, v155
    v_mul_f32 v24, v52, v36
    v_xor_b32 v38, v98, v1
    v_add_f32 v24, v24, v38
    v_add_f32 v25, v24, v36
    v_add_f32 v26, v25, v36
    v_add_f32 v27, v26, v36
    v_cos_f32 v28, v24
    v_sin_f32 v32, v24
    v_cos_f32 v29, v25
    v_sin_f32 v33, v25
    v_cos_f32 v30, v26
    v_sin_f32 v34, v26
    v_cos_f32 v31, v27
    v_sin_f32 v35, v27
    buffer_load_dwordx4 a[64:67], v53, s[36:39], s63 offen sc1
    v_cvt_pk_bf16_f32 v160, v28, v32
    v_cvt_pk_bf16_f32 v164, -v32, v28
    v_xor_b32 v160, v160, v1
    v_xor_b32 v164, v164, v1
    v_cvt_pk_bf16_f32 v161, v29, v33
    v_cvt_pk_bf16_f32 v165, -v33, v29
    v_xor_b32 v161, v161, v1
    v_xor_b32 v165, v165, v1
    v_cvt_pk_bf16_f32 v162, v30, v34
    v_cvt_pk_bf16_f32 v166, -v34, v30
    v_xor_b32 v162, v162, v1
    v_xor_b32 v166, v166, v1
    v_cvt_pk_bf16_f32 v163, v31, v35
    v_cvt_pk_bf16_f32 v167, -v35, v31
    v_xor_b32 v163, v163, v1
    v_xor_b32 v167, v167, v1
    v_fma_f32 v24, v52, v36, v99
    v_add_f32 v24, v24, v98
    v_add_f32 v25, v24, v36
    v_add_f32 v26, v25, v36
    v_add_f32 v27, v26, v36
    v_cos_f32 v28, v24
    buffer_load_dwordx4 a[76:79], v54, s[36:39], s63 offen sc1
    v_sin_f32 v32, v24
    v_cos_f32 v29, v25
    v_sin_f32 v33, v25
    v_cos_f32 v30, v26
    v_sin_f32 v34, v26
    v_cos_f32 v31, v27
    v_sin_f32 v35, v27
    v_mul_f32 v38, v97, v28
    v_mul_f32 v39, v97, v32
    v_fma_f32 v39, -v3, v28, v39
    v_fma_f32 v28, v3, v32, v38
    v_mov_b32 v32, v39
    v_cvt_pk_bf16_f32 v172, v28, v32
    v_and_b32 v168, v172, v2
    v_xor_b32 v172, v172, v168
    buffer_load_dwordx4 a[88:91], v55, s[36:39], s63 offen sc1
    v_cvt_pk_bf16_f32 v173, v29, v33
    v_and_b32 v169, v173, v2
    v_xor_b32 v173, v173, v169
    v_cvt_pk_bf16_f32 v174, v30, v34
    v_and_b32 v170, v174, v2
    v_xor_b32 v174, v174, v170
    v_cvt_pk_bf16_f32 v175, v31, v35
    v_and_b32 v171, v175, v2
    v_xor_b32 v175, v175, v171
    v_add_f32 v37, 0x00000000, v23
    v_mul_f32 v36, 0x3d000000, v37
    v_mul_f32 v24, v52, v36
    v_add_f32 v25, v24, v36
    v_add_f32 v26, v25, v36
    v_add_f32 v27, v26, v36
    v_cos_f32 v28, v24
    v_sin_f32 v32, v24
    v_cos_f32 v29, v25
    v_sin_f32 v33, v25
    s_add_u32 s63, s90, 16384
    buffer_load_dwordx4 a[56:59], v20, s[36:39], s63 offen sc1
    v_cos_f32 v30, v26
    v_sin_f32 v34, v26
    v_cos_f32 v31, v27
    v_sin_f32 v35, v27
    v_fmac_f32 v32, 2.0, v3
    v_cvt_pk_bf16_f32 v176, v28, v32
    v_cvt_pk_bf16_f32 v177, v29, v33
    v_cvt_pk_bf16_f32 v178, v30, v34
    v_cvt_pk_bf16_f32 v179, v31, v35
    v_add_f32 v37, 0x41800000, v23
    v_mul_f32 v36, 0x3d000000, v37
    v_mul_f32 v24, v52, v36
    v_add_f32 v25, v24, v36
    v_add_f32 v26, v25, v36
    v_add_f32 v27, v26, v36
    v_cos_f32 v28, v24
    v_sin_f32 v32, v24
    buffer_load_dwordx4 a[68:71], v53, s[36:39], s63 offen sc1
    v_cos_f32 v29, v25
    v_sin_f32 v33, v25
    v_cos_f32 v30, v26
    v_sin_f32 v34, v26
    v_cos_f32 v31, v27
    v_sin_f32 v35, v27
    v_fmac_f32 v32, 2.0, v3
    v_cvt_pk_bf16_f32 v180, v28, v32
    v_cvt_pk_bf16_f32 v181, v29, v33
    v_cvt_pk_bf16_f32 v182, v30, v34
    v_cvt_pk_bf16_f32 v183, v31, v35
    s_waitcnt lgkmcnt(0)
    s_barrier
    v_lshlrev_b32 v80, 16, v64
    v_and_b32 v81, 0xffff0000, v64
    v_lshlrev_b32 v82, 16, v65
    v_and_b32 v83, 0xffff0000, v65
    buffer_load_dwordx4 a[80:83], v54, s[36:39], s63 offen sc1
    v_lshlrev_b32 v84, 16, v66
    v_and_b32 v85, 0xffff0000, v66
    v_lshlrev_b32 v86, 16, v67
    v_and_b32 v87, 0xffff0000, v67
    v_lshlrev_b32 v88, 16, v68
    v_and_b32 v89, 0xffff0000, v68
    v_lshlrev_b32 v90, 16, v69
    v_and_b32 v91, 0xffff0000, v69
    v_lshlrev_b32 v92, 16, v70
    v_and_b32 v93, 0xffff0000, v70
    v_lshlrev_b32 v94, 16, v71
    v_and_b32 v95, 0xffff0000, v71
    s_waitcnt vmcnt(19)
    v_lshlrev_b32 v4, 16, v136
    v_and_b32 v5, 0xffff0000, v136
    v_lshlrev_b32 v6, 16, v137
    v_and_b32 v7, 0xffff0000, v137
    s_waitcnt vmcnt(18)
    v_lshlrev_b32 v56, 16, v138
    v_and_b32 v57, 0xffff0000, v138
    v_lshlrev_b32 v58, 16, v139
    v_and_b32 v59, 0xffff0000, v139
    s_waitcnt vmcnt(17)
    v_lshlrev_b32 v60, 16, v140
    v_and_b32 v61, 0xffff0000, v140
    buffer_load_dwordx4 a[92:95], v55, s[36:39], s63 offen sc1
    v_lshlrev_b32 v62, 16, v141
    v_and_b32 v63, 0xffff0000, v141
L_M:
    s_waitcnt vmcnt(15)
    v_sad_u32 v24, v105, s52, 0
    v_sad_u32 v24, v107, s52, v24
    s_waitcnt vmcnt(14)
    v_sad_u32 v24, v109, s52, v24
    v_sad_u32 v24, v111, s52, v24
    s_waitcnt vmcnt(13)
    v_sad_u32 v24, v113, s52, v24
    v_sad_u32 v24, v115, s52, v24
    s_waitcnt vmcnt(12)
    v_sad_u32 v24, v117, s52, v24
    v_sad_u32 v24, v119, s52, v24
    v_cmp_ne_u32 vcc, 0, v24
    s_cbranch_vccnz L_M_retry
L_M_ok:
    s_cmp_ge_u32 s53, 2
    s_mov_b32 s57, 0x3fb8aa3b
    s_cselect_b32 s84, s57, 0x36000000
    s_mov_b32 s85, 0
    s_cselect_b32 s86, 0x3f317218, s57
    s_cselect_b32 s87, 0, s57
    v_lshlrev_b32 v24, 16, v104
    v_and_b32 v25, 0xffff0000, v104
    v_lshlrev_b32 v26, 16, v106
    v_and_b32 v27, 0xffff0000, v106
    v_lshlrev_b32 v28, 16, v108
    v_and_b32 v29, 0xffff0000, v108
    v_lshlrev_b32 v30, 16, v110
    v_and_b32 v31, 0xffff0000, v110
    v_lshlrev_b32 v32, 16, v112
    v_and_b32 v33, 0xffff0000, v112
    v_lshlrev_b32 v34, 16, v114
    v_and_b32 v35, 0xffff0000, v114
    v_lshlrev_b32 v36, 16, v116
    v_and_b32 v37, 0xffff0000, v116
    v_lshlrev_b32 v38, 16, v118
    v_and_b32 v39, 0xffff0000, v118
    v_pk_add_f32 v[24:25], v[24:25], v[32:33]
    v_pk_add_f32 v[26:27], v[26:27], v[34:35]
    v_pk_add_f32 v[28:29], v[28:29], v[36:37]
    v_pk_add_f32 v[30:31], v[30:31], v[38:39]
    v_pk_fma_f32 v[24:25], v[24:25], s[84:85], s[84:85] op_sel:[0,0,1] op_sel_hi:[1,0,1]
    v_pk_fma_f32 v[26:27], v[26:27], s[84:85], s[84:85] op_sel:[0,0,1] op_sel_hi:[1,0,1]
    v_pk_fma_f32 v[28:29], v[28:29], s[86:87], s[86:87] op_sel:[0,0,1] op_sel_hi:[1,0,1]
    v_pk_fma_f32 v[30:31], v[30:31], s[86:87], s[86:87] op_sel:[0,0,1] op_sel_hi:[1,0,1]
    v_add_u32 v23, 152576, v10
    ds_write_b128 v23, v[24:27] offset:0
    ds_write_b128 v23, v[28:31] offset:4096
    s_mov_b32 s84, 0x3fb8aa3b
    v_pk_mul_f32 v[4:5], v[4:5], s[84:85] op_sel_hi:[1,0]
    v_pk_mul_f32 v[6:7], v[6:7], s[84:85] op_sel_hi:[1,0]
    v_pk_mul_f32 v[56:57], v[56:57], s[84:85] op_sel_hi:[1,0]
    v_pk_mul_f32 v[58:59], v[58:59], s[84:85] op_sel_hi:[1,0]
    v_pk_mul_f32 v[60:61], v[60:61], s[84:85] op_sel_hi:[1,0]
    v_pk_mul_f32 v[62:63], v[62:63], s[84:85] op_sel_hi:[1,0]
    s_and_b32 s57, s2, 127
    s_lshl_b32 s57, s57, 14
    s_add_u32 s57, s57, 6293504
    v_add_u32 v8, s57, v10
    v_add_u32 v9, 8192, v8
    v_lshlrev_b32 v16, 1, v21
    v_add_u32 v16, 152576, v16
    s_lshl_b32 s76, s55, 16
    s_and_b32 s57, s2, 127
    s_lshl_b32 s57, s57, 1
    s_add_u32 s57, s57, s54
    s_lshl_b32 s57, s57, 13
    s_lshl_b32 s58, s53, 11
    s_add_u32 s57, s57, s58
    s_add_u32 s57, s57, 2097152
    v_add_u32 v23, s57, v20
    s_lshl_b32 s58, s55, 10
    s_lshl_b32 s59, s56, 2
    s_add_u32 s59, s59, s53
    s_lshl_b32 s59, s59, 2
    s_add_u32 s59, s59, s58
    s_add_u32 s59, s59, 65536
    v_mov_b32 v52, s59
    v_mov_b32 v1, s52
    s_waitcnt lgkmcnt(0)
    s_barrier
    global_load_dwordx4 v[120:123], v8, s[26:27] offset:-2048 sc1
    global_load_dwordx4 v[124:127], v8, s[26:27] offset:2048 sc1
    global_load_dwordx4 v[128:131], v9, s[26:27] offset:-2048 sc1
    global_load_dwordx4 v[132:135], v9, s[26:27] offset:2048 sc1
    s_add_u32 s63, s88, 32768
    buffer_load_dwordx4 a[96:99], v20, s[36:39], s63 offen sc1
    buffer_load_dwordx4 a[108:111], v53, s[36:39], s63 offen sc1
    buffer_load_dwordx4 a[120:123], v54, s[36:39], s63 offen sc1
    buffer_load_dwordx4 a[132:135], v55, s[36:39], s63 offen sc1
    s_add_u32 s63, s89, 32768
    buffer_load_dwordx4 a[100:103], v20, s[36:39], s63 offen sc1
    buffer_load_dwordx4 a[112:115], v53, s[36:39], s63 offen sc1
    buffer_load_dwordx4 a[124:127], v54, s[36:39], s63 offen sc1
    buffer_load_dwordx4 a[136:139], v55, s[36:39], s63 offen sc1
    s_waitcnt vmcnt(8)
L_C:
    v_max3_u32 v24, v120, v121, v122
    v_max3_u32 v24, v24, v123, v124
    v_max3_u32 v24, v24, v125, v126
    v_max3_u32 v24, v24, v127, v128
    v_max3_u32 v24, v24, v129, v130
    v_max3_u32 v24, v24, v131, v132
    v_max3_u32 v24, v24, v133, v134
    v_max_u32 v24, v24, v135
    v_cmp_eq_u32 vcc, -1, v24
    s_cbranch_vccnz L_C_retry
L_C_ok:
    ds_write2st64_b32 v96, v120, v121 offset0:0 offset1:9
    ds_write2st64_b32 v96, v122, v123 offset0:18 offset1:27
    ds_write2st64_b32 v96, v124, v125 offset0:2 offset1:11
    ds_write2st64_b32 v96, v126, v127 offset0:20 offset1:29
    ds_write2st64_b32 v96, v128, v129 offset0:36 offset1:45
    ds_write2st64_b32 v96, v130, v131 offset0:54 offset1:63
    ds_write2st64_b32 v96, v132, v133 offset0:38 offset1:47
    ds_write2st64_b32 v96, v134, v135 offset0:56 offset1:65
    s_waitcnt lgkmcnt(0)
    s_barrier
    s_add_u32 s63, s90, 32768
    buffer_load_dwordx4 a[104:107], v20, s[36:39], s63 offen sc1
    ds_read_b128 v[120:123], v101 offset:0
    ds_read_b128 v[124:127], v101 offset:9216
    ds_read_b128 v[128:131], v101 offset:1088
    ds_read_b128 v[132:135], v101 offset:10304
    s_waitcnt lgkmcnt(3)
    v_mfma_f32_16x16x32_bf16 v[252:255], v[120:123], v[144:147], 0
    v_mfma_f32_16x16x32_bf16 v[244:247], v[120:123], v[148:151], 0
    v_mfma_f32_16x16x32_bf16 v[236:239], v[120:123], v[152:155], 0
    v_mfma_f32_16x16x32_bf16 v[228:231], v[120:123], v[156:159], 0
    buffer_load_dwordx4 a[116:119], v53, s[36:39], s63 offen sc1
    s_waitcnt lgkmcnt(2)
    v_mfma_f32_16x16x32_bf16 v[252:255], v[124:127], v[160:163], v[252:255]
    v_mfma_f32_16x16x32_bf16 v[244:247], v[124:127], v[164:167], v[244:247]
    v_mfma_f32_16x16x32_bf16 v[236:239], v[124:127], v[168:171], v[236:239]
    v_mfma_f32_16x16x32_bf16 v[228:231], v[124:127], v[172:175], v[228:231]
    s_waitcnt lgkmcnt(1)
    v_mfma_f32_16x16x32_bf16 v[248:251], v[128:131], v[144:147], 0
    buffer_load_dwordx4 a[128:131], v54, s[36:39], s63 offen sc1
    ds_read_b128 v[64:67], v16 offset:0
    v_mfma_f32_16x16x32_bf16 v[240:243], v[128:131], v[148:151], 0
    ds_read_b128 v[68:71], v16 offset:1024
    v_mfma_f32_16x16x32_bf16 v[232:235], v[128:131], v[152:155], 0
    ds_read_b128 v[136:139], v16 offset:2048
    v_mfma_f32_16x16x32_bf16 v[224:227], v[128:131], v[156:159], 0
    ds_read_b128 v[140:143], v16 offset:3072
    s_waitcnt lgkmcnt(4)
    v_mfma_f32_16x16x32_bf16 v[248:251], v[132:135], v[160:163], v[248:251]
    buffer_load_dwordx4 a[140:143], v55, s[36:39], s63 offen sc1
    ds_read_b128 v[184:187], v16 offset:4096
    v_mfma_f32_16x16x32_bf16 v[240:243], v[132:135], v[164:167], v[240:243]
    ds_read_b128 v[188:191], v16 offset:5120
    v_mfma_f32_16x16x32_bf16 v[232:235], v[132:135], v[168:171], v[232:235]
    v_mfma_f32_16x16x32_bf16 v[224:227], v[132:135], v[172:175], v[224:227]
    v_cndmask_b32 v252, v252, v236, s[68:69]
    v_cndmask_b32 v244, v244, v228, s[68:69]
    s_nop 4
    v_cndmask_b32 v248, v248, v232, s[68:69]
    v_cndmask_b32 v240, v240, v224, s[68:69]
    s_add_u32 s63, s88, 49152
    buffer_load_dwordx4 a[144:147], v20, s[36:39], s63 offen sc1
    v_pk_mul_f32 v[236:237], v[252:253], v[72:73]
    v_pk_mul_f32 v[228:229], v[244:245], v[72:73]
    v_pk_mul_f32 v[238:239], v[254:255], v[74:75]
    v_pk_mul_f32 v[230:231], v[246:247], v[74:75]
    v_pk_mul_f32 v[232:233], v[248:249], v[72:73]
    v_pk_mul_f32 v[224:225], v[240:241], v[72:73]
    v_pk_mul_f32 v[234:235], v[250:251], v[74:75]
    v_pk_mul_f32 v[226:227], v[242:243], v[74:75]
    v_pk_fma_f32 v[236:237], v[244:245], v[76:77], v[236:237]
    v_pk_fma_f32 v[228:229], v[252:253], v[76:77], v[228:229] neg_lo:[0,1,0] neg_hi:[0,1,0]
    v_pk_fma_f32 v[238:239], v[246:247], v[78:79], v[238:239]
    v_pk_fma_f32 v[230:231], v[254:255], v[78:79], v[230:231] neg_lo:[0,1,0] neg_hi:[0,1,0]
    v_pk_fma_f32 v[232:233], v[240:241], v[76:77], v[232:233]
    v_pk_fma_f32 v[224:225], v[248:249], v[76:77], v[224:225] neg_lo:[0,1,0] neg_hi:[0,1,0]
    v_pk_fma_f32 v[234:235], v[242:243], v[78:79], v[234:235]
    v_pk_fma_f32 v[226:227], v[250:251], v[78:79], v[226:227] neg_lo:[0,1,0] neg_hi:[0,1,0]
    v_cvt_pk_bf16_f32 v24, v236, v228
    v_cvt_pk_bf16_f32 v25, v237, v229
    buffer_load_dwordx4 a[156:159], v53, s[36:39], s63 offen sc1
    v_cvt_pk_bf16_f32 v26, v238, v230
    v_cvt_pk_bf16_f32 v27, v239, v231
    v_cvt_pk_bf16_f32 v28, v232, v224
    v_cvt_pk_bf16_f32 v29, v233, v225
    v_cvt_pk_bf16_f32 v30, v234, v226
    v_cvt_pk_bf16_f32 v31, v235, v227
    v_mfma_f32_16x16x32_bf16 v[252:255], v[24:27], v[176:179], 0
    v_mfma_f32_16x16x32_bf16 v[248:251], v[24:27], v[180:183], 0
    v_mfma_f32_16x16x32_bf16 v[244:247], v[28:31], v[176:179], 0
    buffer_load_dwordx4 a[168:171], v54, s[36:39], s63 offen sc1
    v_mfma_f32_16x16x32_bf16 v[240:243], v[28:31], v[180:183], 0
    s_waitcnt lgkmcnt(5)
    s_nop 2
    v_pk_fma_f32 v[80:81], v[252:253], v[64:65], v[80:81]
    v_pk_fma_f32 v[82:83], v[254:255], v[66:67], v[82:83]
    s_waitcnt lgkmcnt(4)
    v_pk_fma_f32 v[84:85], v[248:249], v[68:69], v[84:85]
    v_pk_fma_f32 v[86:87], v[250:251], v[70:71], v[86:87]
    v_pk_fma_f32 v[88:89], v[244:245], v[64:65], v[88:89]
    v_pk_fma_f32 v[90:91], v[246:247], v[66:67], v[90:91]
    v_pk_fma_f32 v[92:93], v[240:241], v[68:69], v[92:93]
    v_pk_fma_f32 v[94:95], v[242:243], v[70:71], v[94:95]
    buffer_load_dwordx4 a[180:183], v55, s[36:39], s63 offen sc1
    s_add_u32 s63, s89, 49152
    buffer_load_dwordx4 a[148:151], v20, s[36:39], s63 offen sc1
    buffer_load_dwordx4 a[160:163], v53, s[36:39], s63 offen sc1
    v_pk_add_f32 v[24:25], v[80:81], v[82:83]
    v_pk_mul_f32 v[26:27], v[80:81], v[80:81]
    v_pk_add_f32 v[24:25], v[24:25], v[84:85]
    v_pk_fma_f32 v[26:27], v[82:83], v[82:83], v[26:27]
    v_pk_add_f32 v[24:25], v[24:25], v[86:87]
    v_pk_fma_f32 v[26:27], v[84:85], v[84:85], v[26:27]
    v_pk_fma_f32 v[26:27], v[86:87], v[86:87], v[26:27]
    v_pk_add_f32 v[28:29], v[88:89], v[90:91]
    v_pk_mul_f32 v[30:31], v[88:89], v[88:89]
    v_pk_add_f32 v[28:29], v[28:29], v[92:93]
    v_pk_fma_f32 v[30:31], v[90:91], v[90:91], v[30:31]
    v_pk_add_f32 v[28:29], v[28:29], v[94:95]
    v_pk_fma_f32 v[30:31], v[92:93], v[92:93], v[30:31]
    v_pk_fma_f32 v[30:31], v[94:95], v[94:95], v[30:31]
    v_add_f32 v24, v24, v25
    v_add_f32 v28, v28, v29
    v_add_f32 v26, v26, v27
    v_add_f32 v30, v30, v31
    v_cvt_pk_bf16_f32 v104, v80, v81
    v_permlane32_swap_b32 v24, v28
    v_permlane32_swap_b32 v26, v30
    v_add_f32 v24, v24, v28
    v_add_f32 v26, v26, v30
    v_cvt_pk_bf16_f32 v105, v82, v83
    v_cvt_pk_bf16_f32 v106, v84, v85
    v_permlane16_swap_b32 v24, v26
    v_add_f32 v24, v24, v26
    v_cvt_pk_bf16_f32 v107, v86, v87
    v_cvt_pk_bf16_f32 v108, v88, v89
    v_add_f32_dpp v24, v24, v24 row_ror:1 row_mask:0xf bank_mask:0xf
    v_cvt_pk_bf16_f32 v109, v90, v91
    v_cvt_pk_bf16_f32 v110, v92, v93
    v_add_f32_dpp v24, v24, v24 row_ror:2 row_mask:0xf bank_mask:0xf
    v_cvt_pk_bf16_f32 v111, v94, v95
    s_nop 0
    v_add_f32_dpp v24, v24, v24 row_ror:4 row_mask:0xf bank_mask:0xf
    s_nop 1
    v_add_f32_dpp v24, v24, v24 row_ror:8 row_mask:0xf bank_mask:0xf
    v_mov_b32 v25, v24
    s_nop 1
    v_permlane16_swap_b32 v24, v25
    v_mul_f32 v24, 0x3b000000, v24
    v_mul_f32 v26, v24, v24
    v_fmamk_f32 v25, v25, 0x3b000000, v22
    v_sub_f32 v25, v25, v26
    v_max_f32 v25, v25, v22
    v_rsq_f32 v192, v25
    s_nop 0
    v_mul_f32 v193, v24, v192
    v_mov_b32 v194, v192
    v_sub_f32 v193, 0, v193
    v_mov_b32 v195, v193
    v_permlane32_swap_b32 v192, v194
    s_nop 0
    v_permlane32_swap_b32 v193, v195
    v_pk_fma_f32 v[80:81], v[80:81], v[192:193], v[192:193] op_sel:[0,0,1] op_sel_hi:[1,0,1]
    v_pk_fma_f32 v[82:83], v[82:83], v[192:193], v[192:193] op_sel:[0,0,1] op_sel_hi:[1,0,1]
    v_pk_fma_f32 v[84:85], v[84:85], v[192:193], v[192:193] op_sel:[0,0,1] op_sel_hi:[1,0,1]
    v_pk_fma_f32 v[86:87], v[86:87], v[192:193], v[192:193] op_sel:[0,0,1] op_sel_hi:[1,0,1]
    s_waitcnt lgkmcnt(1)
    v_pk_fma_f32 v[80:81], v[80:81], v[184:185], v[136:137]
    v_pk_fma_f32 v[82:83], v[82:83], v[186:187], v[138:139]
    s_waitcnt lgkmcnt(0)
    v_pk_fma_f32 v[84:85], v[84:85], v[188:189], v[140:141]
    v_pk_fma_f32 v[86:87], v[86:87], v[190:191], v[142:143]
    v_cvt_pk_bf16_f32 v24, v80, v81
    v_cvt_pk_bf16_f32 v25, v82, v83
    v_cvt_pk_bf16_f32 v26, v84, v85
    v_cvt_pk_bf16_f32 v27, v86, v87
    global_store_dwordx4 v23, v[24:27], s[26:27] offset:0
    v_pk_fma_f32 v[88:89], v[88:89], v[194:195], v[194:195] op_sel:[0,0,1] op_sel_hi:[1,0,1]
    v_pk_fma_f32 v[90:91], v[90:91], v[194:195], v[194:195] op_sel:[0,0,1] op_sel_hi:[1,0,1]
    v_pk_fma_f32 v[92:93], v[92:93], v[194:195], v[194:195] op_sel:[0,0,1] op_sel_hi:[1,0,1]
    v_pk_fma_f32 v[94:95], v[94:95], v[194:195], v[194:195] op_sel:[0,0,1] op_sel_hi:[1,0,1]
    v_pk_fma_f32 v[88:89], v[88:89], v[184:185], v[136:137]
    v_pk_fma_f32 v[90:91], v[90:91], v[186:187], v[138:139]
    v_pk_fma_f32 v[92:93], v[92:93], v[188:189], v[140:141]
    v_pk_fma_f32 v[94:95], v[94:95], v[190:191], v[142:143]
    v_cvt_pk_bf16_f32 v28, v88, v89
    v_cvt_pk_bf16_f32 v29, v90, v91
    v_cvt_pk_bf16_f32 v30, v92, v93
    v_cvt_pk_bf16_f32 v31, v94, v95
    global_store_dwordx4 v23, v[28:31], s[26:27] offset:1024
    s_lshl_b32 s57, s53, 11
    s_add_u32 s57, s57, 18432
    v_add_u32 v32, s57, v21
    v_add_u32 v33, s57, v20
    ds_write_b64 v32, v[104:105] offset:0
    ds_write_b64 v32, v[106:107] offset:512
    ds_write_b64 v32, v[108:109] offset:1024
    ds_write_b64 v32, v[110:111] offset:1536
    s_waitcnt lgkmcnt(0)
    ds_read_b128 v[112:115], v33 offset:0
    ds_read_b128 v[116:119], v33 offset:1024
    s_waitcnt lgkmcnt(0)
    buffer_load_dwordx4 a[172:175], v54, s[36:39], s63 offen sc1
    ds_read_b64_tr_b16 v[144:145], v44 offset:8192
    ds_read_b64_tr_b16 v[148:149], v45 offset:8192
    ds_read_b64_tr_b16 v[152:153], v46 offset:8192
    ds_read_b64_tr_b16 v[156:157], v47 offset:8192
    ds_read_b64_tr_b16 v[146:147], v44 offset:10240
    ds_read_b64_tr_b16 v[150:151], v45 offset:10240
    ds_read_b64_tr_b16 v[154:155], v46 offset:10240
    ds_read_b64_tr_b16 v[158:159], v47 offset:10240
    ds_read_b64_tr_b16 v[160:161], v44 offset:12288
    ds_read_b64_tr_b16 v[164:165], v45 offset:12288
    ds_read_b64_tr_b16 v[168:169], v46 offset:12288
    ds_read_b64_tr_b16 v[172:173], v47 offset:12288
    ds_read_b64_tr_b16 v[162:163], v44 offset:14336
    ds_read_b64_tr_b16 v[166:167], v45 offset:14336
    ds_read_b64_tr_b16 v[170:171], v46 offset:14336
    buffer_load_dwordx4 a[184:187], v55, s[36:39], s63 offen sc1
    ds_read_b64_tr_b16 v[174:175], v47 offset:14336
    ds_read_b64_tr_b16 v[176:177], v44 offset:16384
    ds_read_b64_tr_b16 v[180:181], v45 offset:16384
    ds_read_b64_tr_b16 v[184:185], v46 offset:16384
    ds_read_b64_tr_b16 v[188:189], v47 offset:16384
    ds_read_b64_tr_b16 v[178:179], v44 offset:18432
    ds_read_b64_tr_b16 v[182:183], v45 offset:18432
    ds_read_b64_tr_b16 v[186:187], v46 offset:18432
    ds_read_b64_tr_b16 v[190:191], v47 offset:18432
    s_waitcnt vmcnt(2)
    global_store_dword v52, v1, s[26:27] offset:512
    s_lshl_b32 s57, s56, 13
    s_lshl_b32 s58, s53, 11
    s_add_u32 s57, s57, s58
    s_add_u32 s57, s57, s76
    s_add_u32 s57, s57, 10485760
    s_add_u32 s63, s90, 49152
    buffer_load_dwordx4 a[152:155], v20, s[36:39], s63 offen sc1
    v_add_u32 v33, s57, v20
    v_mul_u32_u24 v0, 1040, v18
    v_lshl_add_u32 v0, v19, 8, v0
    s_lshr_b32 s57, s53, 1
    s_lshl_b32 s57, s57, 5
    s_add_u32 s57, s57, s55
    s_lshl_b32 s57, s57, 14
    s_and_b32 s77, s53, 1
    s_lshl_b32 s77, s77, 12
    s_add_u32 s77, s77, s57
    s_add_u32 s77, s77, 2097088
    s_mul_i32 s80, s53, 4160
    v_add_u32 v76, 64, v20
    v_add_u32 v77, 48, v20
    v_add_u32 v78, 32, v20
    buffer_load_dwordx4 a[164:167], v53, s[36:39], s63 offen sc1
    v_add_u32 v79, 16, v20
    s_lshl_b32 s57, s55, 10
    s_add_u32 s57, s57, 66048
    v_and_b32 v38, 31, v17
    v_lshl_add_u32 v38, v38, 2, s57
    buffer_load_dwordx4 a[176:179], v54, s[36:39], s63 offen sc1
    buffer_load_dwordx4 a[188:191], v55, s[36:39], s63 offen sc1
    s_waitcnt lgkmcnt(0)
    s_barrier
L_D0:
    global_load_dword v16, v38, s[26:27] nt
    s_waitcnt vmcnt(0)
    v_cmp_ne_u32 vcc, s52, v16
    s_cbranch_vccnz L_D0_retry
L_D0_ok:
    s_add_u32 m0, s80, 0
    s_add_u32 s57, s77, 0
    buffer_load_dwordx4 v76, s[36:39], s57 offen offset:0 nt lds
    buffer_load_dwordx4 v77, s[36:39], s57 offen offset:1040 nt lds
    buffer_load_dwordx4 v78, s[36:39], s57 offen offset:2080 nt lds
    buffer_load_dwordx4 v79, s[36:39], s57 offen offset:3120 nt lds
    s_add_u32 m0, s80, 16640
    s_add_u32 s57, s77, 1048576
    buffer_load_dwordx4 v76, s[36:39], s57 offen offset:0 nt lds
    buffer_load_dwordx4 v77, s[36:39], s57 offen offset:1040 nt lds
    buffer_load_dwordx4 v78, s[36:39], s57 offen offset:2080 nt lds
    buffer_load_dwordx4 v79, s[36:39], s57 offen offset:3120 nt lds
    s_waitcnt vmcnt(4)
    s_barrier
    s_mov_b32 s84, 0x3f3504f3
    s_mov_b32 s85, 0.5
    ds_read_b128 v[8:11], v0 offset:0
    ds_read_b128 v[12:15], v0 offset:16
    ds_read_b128 v[48:51], v0 offset:32
    ds_read_b128 v[64:67], v0 offset:48
    s_waitcnt lgkmcnt(2)
    v_mfma_f32_16x16x32_bf16 v[80:83], a[0:3], v[8:11], v[4:7]
    ds_read_b128 v[68:71], v0 offset:64
    s_and_b32 s92, s2, 127
    s_lshl_b32 s92, s92, 1
    s_lshr_b32 s93, s2, 7
    s_add_u32 m0, s80, 33280
    s_add_u32 s57, s77, 8192
    buffer_load_dwordx4 v76, s[36:39], s57 offen offset:0 nt lds
    v_mfma_f32_16x16x32_bf16 v[84:87], a[4:7], v[8:11], v[56:59]
    s_add_u32 s92, s92, s93
    s_lshl_b32 s92, s92, 13
    v_mfma_f32_16x16x32_bf16 v[88:91], a[8:11], v[8:11], v[60:63]
    s_add_u32 s91, s92, 6291456
    s_add_u32 s92, s92, 2097152
    v_mfma_f32_16x16x32_bf16 v[80:83], a[12:15], v[12:15], v[80:83]
    ds_read_b128 v[72:75], v0 offset:80
    s_mul_i32 s93, s2, 8320
    v_mfma_f32_16x16x32_bf16 v[84:87], a[16:19], v[12:15], v[84:87]
    s_add_u32 s93, s93, 20447232
    s_lshl_b32 s59, s53, 10
    v_mfma_f32_16x16x32_bf16 v[88:91], a[20:23], v[12:15], v[88:91]
    s_add_u32 s59, s59, 4096
    buffer_load_dwordx4 v77, s[36:39], s57 offen offset:1040 nt lds
    s_waitcnt lgkmcnt(2)
    v_mfma_f32_16x16x32_bf16 v[80:83], a[24:27], v[48:51], v[80:83]
    ds_read_b128 v[8:11], v0 offset:96
    v_add_u32 v26, s59, v20
    v_mfma_f32_16x16x32_bf16 v[84:87], a[28:31], v[48:51], v[84:87]
    v_add_u32 v21, s91, v26
    v_add_u32 v22, s92, v26
    v_mfma_f32_16x16x32_bf16 v[88:91], a[32:35], v[48:51], v[88:91]
    v_add_u32 v23, s93, v26
    s_lshl_b32 s60, s53, 6
    s_add_u32 s60, s60, s55
    s_and_b32 s92, s60, 127
    v_mfma_f32_16x16x32_bf16 v[80:83], a[36:39], v[64:67], v[80:83]
    ds_read_b128 v[12:15], v0 offset:112
    s_lshl_b32 s92, s92, 1
    v_mfma_f32_16x16x32_bf16 v[84:87], a[40:43], v[64:67], v[84:87]
    buffer_load_dwordx4 v78, s[36:39], s57 offen offset:2080 nt lds
    v_mfma_f32_16x16x32_bf16 v[88:91], a[44:47], v[64:67], v[88:91]
    s_lshr_b32 s93, s60, 7
    s_waitcnt lgkmcnt(2)
    v_mfma_f32_16x16x32_bf16 v[80:83], a[48:51], v[68:71], v[80:83]
    ds_read_b128 v[48:51], v0 offset:128
    s_add_u32 s92, s92, s93
    v_mfma_f32_16x16x32_bf16 v[84:87], a[52:55], v[68:71], v[84:87]
    s_lshl_b32 s92, s92, 13
    s_add_u32 s91, s92, 6291456
    v_mfma_f32_16x16x32_bf16 v[88:91], a[56:59], v[68:71], v[88:91]
    s_add_u32 s92, s92, 2097152
    s_mul_i32 s93, s60, 8320
    v_mfma_f32_16x16x32_bf16 v[80:83], a[60:63], v[72:75], v[80:83]
    ds_read_b128 v[64:67], v0 offset:144
    s_add_u32 s93, s93, 20447232
    s_add_u32 s60, s60, 32
    s_and_b32 s95, s60, 127
    buffer_load_dwordx4 v79, s[36:39], s57 offen offset:3120 nt lds
    v_mfma_f32_16x16x32_bf16 v[84:87], a[64:67], v[72:75], v[84:87]
    s_lshl_b32 s95, s95, 1
    s_lshr_b32 s96, s60, 7
    v_mfma_f32_16x16x32_bf16 v[88:91], a[68:71], v[72:75], v[88:91]
    s_add_u32 s95, s95, s96
    s_waitcnt lgkmcnt(2)
    v_mfma_f32_16x16x32_bf16 v[80:83], a[72:75], v[8:11], v[80:83]
    ds_read_b128 v[68:71], v0 offset:160
    s_lshl_b32 s95, s95, 13
    v_mfma_f32_16x16x32_bf16 v[84:87], a[76:79], v[8:11], v[84:87]
    s_add_u32 s94, s95, 6291456
    s_add_u32 s95, s95, 2097152
    v_mfma_f32_16x16x32_bf16 v[88:91], a[80:83], v[8:11], v[88:91]
    s_add_u32 m0, s80, 49920
    s_add_u32 s57, s77, 1056768
    buffer_load_dwordx4 v76, s[36:39], s57 offen offset:0 nt lds
    v_mfma_f32_16x16x32_bf16 v[80:83], a[84:87], v[12:15], v[80:83]
    ds_read_b128 v[72:75], v0 offset:176
    s_mul_i32 s96, s60, 8320
    v_mfma_f32_16x16x32_bf16 v[84:87], a[88:91], v[12:15], v[84:87]
    s_add_u32 s96, s96, 20447232
    v_lshrrev_b32 v24, 3, v17
    v_mfma_f32_16x16x32_bf16 v[88:91], a[92:95], v[12:15], v[88:91]
    v_and_b32 v25, 7, v17
    s_waitcnt lgkmcnt(2)
    v_mfma_f32_16x16x32_bf16 v[80:83], a[96:99], v[48:51], v[80:83]
    ds_read_b128 v[8:11], v0 offset:192
    s_lshl_b32 s58, s56, 8
    v_mfma_f32_16x16x32_bf16 v[84:87], a[100:103], v[48:51], v[84:87]
    buffer_load_dwordx4 v77, s[36:39], s57 offen offset:1040 nt lds
    v_mfma_f32_16x16x32_bf16 v[88:91], a[104:107], v[48:51], v[88:91]
    s_add_u32 s58, s58, 158720
    v_lshl_add_u32 v2, v25, 5, s58
    v_mfma_f32_16x16x32_bf16 v[80:83], a[108:111], v[64:67], v[80:83]
    ds_read_b128 v[12:15], v0 offset:208
    s_lshl_b32 s60, s53, 13
    v_mfma_f32_16x16x32_bf16 v[84:87], a[112:115], v[64:67], v[84:87]
    s_lshl_b32 s58, s56, 7
    s_add_u32 s60, s60, s58
    v_mfma_f32_16x16x32_bf16 v[88:91], a[116:119], v[64:67], v[88:91]
    s_add_u32 s60, s60, s76
    s_waitcnt lgkmcnt(2)
    v_mfma_f32_16x16x32_bf16 v[80:83], a[120:123], v[68:71], v[80:83]
    ds_read_b128 v[48:51], v0 offset:224
    s_add_u32 s60, s60, 10485760
    buffer_load_dwordx4 v78, s[36:39], s57 offen offset:2080 nt lds
    v_mfma_f32_16x16x32_bf16 v[84:87], a[124:127], v[68:71], v[84:87]
    v_lshl_add_u32 v26, v25, 4, s60
    v_lshl_add_u32 v40, v24, 10, v26
    v_mfma_f32_16x16x32_bf16 v[88:91], a[128:131], v[68:71], v[88:91]
    s_lshl_b32 s58, s55, 10
    s_add_u32 s58, s58, 65536
    v_mfma_f32_16x16x32_bf16 v[80:83], a[132:135], v[72:75], v[80:83]
    ds_read_b128 v[64:67], v0 offset:240
    s_lshl_b32 s59, s53, 5
    v_mfma_f32_16x16x32_bf16 v[84:87], a[136:139], v[72:75], v[84:87]
    s_add_u32 s59, s59, s58
    v_lshl_add_u32 v3, v25, 2, s59
    v_mfma_f32_16x16x32_bf16 v[88:91], a[140:143], v[72:75], v[88:91]
    buffer_load_dwordx4 v79, s[36:39], s57 offen offset:3120 nt lds
    s_waitcnt vmcnt(8)
    s_barrier
    s_waitcnt lgkmcnt(2)
    v_mfma_f32_16x16x32_bf16 v[80:83], a[144:147], v[8:11], v[80:83]
    ds_read_b128 v[68:71], v0 offset:16640
    global_store_dwordx4 v33, v[112:115], s[26:27] offset:0 sc1
    v_mfma_f32_16x16x32_bf16 v[84:87], a[148:151], v[8:11], v[84:87]
    global_store_dwordx4 v33, v[116:119], s[26:27] offset:1024 sc1
    v_mfma_f32_16x16x32_bf16 v[88:91], a[152:155], v[8:11], v[88:91]
    v_mfma_f32_16x16x32_bf16 v[80:83], a[156:159], v[12:15], v[80:83]
    ds_read_b128 v[72:75], v0 offset:16656
    s_add_u32 m0, s70, 0
    s_add_u32 s63, s74, 327680
    buffer_load_dwordx4 v42, s[32:35], s63 offen offset:0 lds
    v_mfma_f32_16x16x32_bf16 v[84:87], a[160:163], v[12:15], v[84:87]
    v_mfma_f32_16x16x32_bf16 v[88:91], a[164:167], v[12:15], v[88:91]
    buffer_load_dwordx4 v43, s[32:35], s63 offen offset:1024 lds
    s_waitcnt lgkmcnt(2)
    v_mfma_f32_16x16x32_bf16 v[80:83], a[168:171], v[48:51], v[80:83]
    ds_read_b128 v[8:11], v0 offset:16672
    v_mfma_f32_16x16x32_bf16 v[84:87], a[172:175], v[48:51], v[84:87]
    s_add_u32 m0, s70, 2048
    s_add_u32 s63, s74, 344064
    buffer_load_dwordx4 v42, s[32:35], s63 offen offset:0 lds
    v_mfma_f32_16x16x32_bf16 v[88:91], a[176:179], v[48:51], v[88:91]
    v_mfma_f32_16x16x32_bf16 v[80:83], a[180:183], v[64:67], v[80:83]
    ds_read_b128 v[12:15], v0 offset:16688
    buffer_load_dwordx4 v43, s[32:35], s63 offen offset:1024 lds
    v_mfma_f32_16x16x32_bf16 v[84:87], a[184:187], v[64:67], v[84:87]
    v_mfma_f32_16x16x32_bf16 v[88:91], a[188:191], v[64:67], v[88:91]
    s_waitcnt lgkmcnt(2)
    v_mfma_f32_16x16x32_bf16 v[92:95], a[0:3], v[68:71], v[4:7]
    ds_read_b128 v[48:51], v0 offset:16704
    s_add_u32 m0, s70, 4096
    s_add_u32 s63, s72, 32768
    buffer_load_dwordx4 v42, s[32:35], s63 offen offset:0 lds
    v_mfma_f32_16x16x32_bf16 v[96:99], a[4:7], v[68:71], v[56:59]
    v_mfma_f32_16x16x32_bf16 v[100:103], a[8:11], v[68:71], v[60:63]
    v_mfma_f32_16x16x32_bf16 v[92:95], a[12:15], v[72:75], v[92:95]
    ds_read_b128 v[64:67], v0 offset:16720
    v_mfma_f32_16x16x32_bf16 v[96:99], a[16:19], v[72:75], v[96:99]
    v_exp_f32 v24, v80
    v_mfma_f32_16x16x32_bf16 v[100:103], a[20:23], v[72:75], v[100:103]
    s_waitcnt lgkmcnt(2)
    v_mfma_f32_16x16x32_bf16 v[92:95], a[24:27], v[8:11], v[92:95]
    ds_read_b128 v[68:71], v0 offset:16736
    v_exp_f32 v25, v81
    v_mfma_f32_16x16x32_bf16 v[96:99], a[28:31], v[8:11], v[96:99]
    v_exp_f32 v26, v82
    buffer_load_dwordx4 v43, s[32:35], s63 offen offset:1024 lds
    v_mfma_f32_16x16x32_bf16 v[100:103], a[32:35], v[8:11], v[100:103]
    v_exp_f32 v27, v83
    v_mfma_f32_16x16x32_bf16 v[92:95], a[36:39], v[12:15], v[92:95]
    ds_read_b128 v[72:75], v0 offset:16752
    v_fma_f32 v24, v24, s84, s84
    v_mfma_f32_16x16x32_bf16 v[96:99], a[40:43], v[12:15], v[96:99]
    v_exp_f32 v32, v88
    v_mfma_f32_16x16x32_bf16 v[100:103], a[44:47], v[12:15], v[100:103]
    v_fma_f32 v25, v25, s84, s84
    v_exp_f32 v33, v89
    s_waitcnt lgkmcnt(2)
    v_mfma_f32_16x16x32_bf16 v[92:95], a[48:51], v[48:51], v[92:95]
    ds_read_b128 v[8:11], v0 offset:16768
    v_fma_f32 v26, v26, s84, s84
    v_exp_f32 v34, v90
    v_mfma_f32_16x16x32_bf16 v[96:99], a[52:55], v[48:51], v[96:99]
    v_exp_f32 v35, v91
    v_mfma_f32_16x16x32_bf16 v[100:103], a[56:59], v[48:51], v[100:103]
    v_fma_f32 v27, v27, s84, s84
    v_fma_f32 v24, v24, v24, 0.5
    v_mfma_f32_16x16x32_bf16 v[92:95], a[60:63], v[64:67], v[92:95]
    ds_read_b128 v[12:15], v0 offset:16784
    v_fma_f32 v32, v32, s84, s84
    v_exp_f32 v28, v84
    s_add_u32 m0, s70, 6144
    s_add_u32 s63, s72, 81920
    buffer_load_dwordx4 v42, s[32:35], s63 offen offset:0 lds
    v_mfma_f32_16x16x32_bf16 v[96:99], a[64:67], v[64:67], v[96:99]
    v_fma_f32 v25, v25, v25, 0.5
    v_fma_f32 v33, v33, s84, s84
    v_mfma_f32_16x16x32_bf16 v[100:103], a[68:71], v[64:67], v[100:103]
    v_fma_f32 v34, v34, s84, s84
    s_waitcnt lgkmcnt(2)
    v_mfma_f32_16x16x32_bf16 v[92:95], a[72:75], v[68:71], v[92:95]
    ds_read_b128 v[48:51], v0 offset:16800
    v_fma_f32 v35, v35, s84, s84
    v_exp_f32 v29, v85
    v_mfma_f32_16x16x32_bf16 v[96:99], a[76:79], v[68:71], v[96:99]
    v_fma_f32 v26, v26, v26, 0.5
    v_fma_f32 v32, v32, v32, 0.5
    v_mfma_f32_16x16x32_bf16 v[100:103], a[80:83], v[68:71], v[100:103]
    v_exp_f32 v30, v86
    v_fma_f32 v27, v27, v27, 0.5
    v_fma_f32 v33, v33, v33, 0.5
    v_mfma_f32_16x16x32_bf16 v[92:95], a[84:87], v[72:75], v[92:95]
    ds_read_b128 v[64:67], v0 offset:16816
    v_fma_f32 v34, v34, v34, 0.5
    v_mfma_f32_16x16x32_bf16 v[96:99], a[88:91], v[72:75], v[96:99]
    v_exp_f32 v31, v87
    v_mfma_f32_16x16x32_bf16 v[100:103], a[92:95], v[72:75], v[100:103]
    v_fma_f32 v35, v35, v35, 0.5
    buffer_load_dwordx4 v43, s[32:35], s63 offen offset:1024 lds
    s_waitcnt lgkmcnt(2)
    v_mfma_f32_16x16x32_bf16 v[92:95], a[96:99], v[8:11], v[92:95]
    ds_read_b128 v[68:71], v0 offset:16832
    v_rcp_f32 v24, v24
    v_mfma_f32_16x16x32_bf16 v[96:99], a[100:103], v[8:11], v[96:99]
    v_rcp_f32 v32, v32
    v_mfma_f32_16x16x32_bf16 v[100:103], a[104:107], v[8:11], v[100:103]
    v_rcp_f32 v33, v33
    v_rcp_f32 v34, v34
    v_mfma_f32_16x16x32_bf16 v[92:95], a[108:111], v[12:15], v[92:95]
    ds_read_b128 v[72:75], v0 offset:16848
    v_fma_f32 v28, v28, s84, s84
    v_rcp_f32 v25, v25
    v_mfma_f32_16x16x32_bf16 v[96:99], a[112:115], v[12:15], v[96:99]
    v_rcp_f32 v35, v35
    v_mfma_f32_16x16x32_bf16 v[100:103], a[116:119], v[12:15], v[100:103]
    v_fma_f32 v29, v29, s84, s84
    s_waitcnt lgkmcnt(2)
    v_mfma_f32_16x16x32_bf16 v[92:95], a[120:123], v[48:51], v[92:95]
    ds_read_b128 v[8:11], v0 offset:16864
    v_fma_f32 v32, -v88, v32, v88
    s_add_u32 m0, s70, 8192
    s_add_u32 s63, s75, 131072
    buffer_load_dwordx4 v42, s[32:35], s63 offen offset:0 lds
    v_mfma_f32_16x16x32_bf16 v[96:99], a[124:127], v[48:51], v[96:99]
    v_rcp_f32 v26, v26
    v_mfma_f32_16x16x32_bf16 v[100:103], a[128:131], v[48:51], v[100:103]
    v_fma_f32 v30, v30, s84, s84
    v_fma_f32 v33, -v89, v33, v89
    v_rcp_f32 v27, v27
    v_mfma_f32_16x16x32_bf16 v[92:95], a[132:135], v[64:67], v[92:95]
    ds_read_b128 v[12:15], v0 offset:16880
    v_fma_f32 v31, v31, s84, s84
    v_mfma_f32_16x16x32_bf16 v[96:99], a[136:139], v[64:67], v[96:99]
    v_fma_f32 v24, -v80, v24, v80
    v_fma_f32 v28, v28, v28, 0.5
    v_fma_f32 v25, -v81, v25, v81
    v_fma_f32 v29, v29, v29, 0.5
    v_mfma_f32_16x16x32_bf16 v[100:103], a[140:143], v[64:67], v[100:103]
    v_fma_f32 v26, -v82, v26, v82
    s_waitcnt vmcnt(11)
    s_barrier
    s_waitcnt lgkmcnt(2)
    v_mfma_f32_16x16x32_bf16 v[92:95], a[144:147], v[68:71], v[92:95]
    ds_read_b128 v[48:51], v0 offset:33280
    v_fma_f32 v30, v30, v30, 0.5
    v_fma_f32 v27, -v83, v27, v83
    v_fma_f32 v31, v31, v31, 0.5
    v_mfma_f32_16x16x32_bf16 v[96:99], a[148:151], v[68:71], v[96:99]
    v_cvt_pk_bf16_f32 v36, v24, v25
    v_fma_f32 v34, -v90, v34, v90
    v_mfma_f32_16x16x32_bf16 v[100:103], a[152:155], v[68:71], v[100:103]
    buffer_load_dwordx4 v43, s[32:35], s63 offen offset:1024 lds
    v_mfma_f32_16x16x32_bf16 v[92:95], a[156:159], v[72:75], v[92:95]
    ds_read_b128 v[64:67], v0 offset:33296
    v_fma_f32 v35, -v91, v35, v91
    v_mfma_f32_16x16x32_bf16 v[96:99], a[160:163], v[72:75], v[96:99]
    v_rcp_f32 v28, v28
    v_cvt_pk_bf16_f32 v37, v26, v27
    v_cvt_pk_bf16_f32 v104, v32, v33
    v_mfma_f32_16x16x32_bf16 v[100:103], a[164:167], v[72:75], v[100:103]
    v_cvt_pk_bf16_f32 v105, v34, v35
    v_rcp_f32 v29, v29
    s_waitcnt lgkmcnt(2)
    v_mfma_f32_16x16x32_bf16 v[92:95], a[168:171], v[8:11], v[92:95]
    ds_read_b128 v[68:71], v0 offset:33312
    v_rcp_f32 v30, v30
    v_mfma_f32_16x16x32_bf16 v[96:99], a[172:175], v[8:11], v[96:99]
    v_rcp_f32 v31, v31
    v_mfma_f32_16x16x32_bf16 v[100:103], a[176:179], v[8:11], v[100:103]
    v_fma_f32 v28, -v84, v28, v84
    v_fma_f32 v29, -v85, v29, v85
    v_fma_f32 v30, -v86, v30, v86
    v_fma_f32 v31, -v87, v31, v87
    v_mfma_f32_16x16x32_bf16 v[92:95], a[180:183], v[12:15], v[92:95]
    ds_read_b128 v[72:75], v0 offset:33328
    v_cvt_pk_bf16_f32 v38, v28, v29
    v_mfma_f32_16x16x32_bf16 v[96:99], a[184:187], v[12:15], v[96:99]
    v_cvt_pk_bf16_f32 v39, v30, v31
    v_mfma_f32_16x16x32_bf16 v[100:103], a[188:191], v[12:15], v[100:103]
    global_store_dwordx4 v21, v[36:39], s[26:27] offset:-4096 nt
    s_waitcnt lgkmcnt(2)
    v_mfma_f32_16x16x32_bf16 v[80:83], a[0:3], v[48:51], v[4:7]
    ds_read_b128 v[8:11], v0 offset:33344
    s_add_u32 m0, s70, 10240
    s_add_u32 s63, s73, 212992
    buffer_load_dwordx4 v42, s[32:35], s63 offen offset:0 lds
    v_mfma_f32_16x16x32_bf16 v[84:87], a[4:7], v[48:51], v[56:59]
    v_mfma_f32_16x16x32_bf16 v[88:91], a[8:11], v[48:51], v[60:63]
    v_mfma_f32_16x16x32_bf16 v[80:83], a[12:15], v[64:67], v[80:83]
    ds_read_b128 v[12:15], v0 offset:33360
    v_mfma_f32_16x16x32_bf16 v[84:87], a[16:19], v[64:67], v[84:87]
    v_exp_f32 v24, v92
    v_mfma_f32_16x16x32_bf16 v[88:91], a[20:23], v[64:67], v[88:91]
    s_waitcnt lgkmcnt(2)
    v_mfma_f32_16x16x32_bf16 v[80:83], a[24:27], v[68:71], v[80:83]
    ds_read_b128 v[48:51], v0 offset:33376
    v_exp_f32 v25, v93
    v_mfma_f32_16x16x32_bf16 v[84:87], a[28:31], v[68:71], v[84:87]
    v_exp_f32 v26, v94
    buffer_load_dwordx4 v43, s[32:35], s63 offen offset:1024 lds
    v_mfma_f32_16x16x32_bf16 v[88:91], a[32:35], v[68:71], v[88:91]
    v_exp_f32 v27, v95
    v_mfma_f32_16x16x32_bf16 v[80:83], a[36:39], v[72:75], v[80:83]
    ds_read_b128 v[64:67], v0 offset:33392
    v_fma_f32 v24, v24, s84, s84
    v_mfma_f32_16x16x32_bf16 v[84:87], a[40:43], v[72:75], v[84:87]
    v_exp_f32 v32, v100
    v_mfma_f32_16x16x32_bf16 v[88:91], a[44:47], v[72:75], v[88:91]
    v_fma_f32 v25, v25, s84, s84
    v_exp_f32 v33, v101
    s_waitcnt lgkmcnt(2)
    v_mfma_f32_16x16x32_bf16 v[80:83], a[48:51], v[8:11], v[80:83]
    ds_read_b128 v[68:71], v0 offset:33408
    v_fma_f32 v26, v26, s84, s84
    v_exp_f32 v34, v102
    v_mfma_f32_16x16x32_bf16 v[84:87], a[52:55], v[8:11], v[84:87]
    v_exp_f32 v35, v103
    v_mfma_f32_16x16x32_bf16 v[88:91], a[56:59], v[8:11], v[88:91]
    v_fma_f32 v27, v27, s84, s84
    v_fma_f32 v24, v24, v24, 0.5
    v_mfma_f32_16x16x32_bf16 v[80:83], a[60:63], v[12:15], v[80:83]
    ds_read_b128 v[72:75], v0 offset:33424
    v_fma_f32 v32, v32, s84, s84
    v_exp_f32 v28, v96
    s_add_u32 m0, s70, 12288
    s_add_u32 s63, s73, 262144
    buffer_load_dwordx4 v42, s[32:35], s63 offen offset:0 lds
    v_mfma_f32_16x16x32_bf16 v[84:87], a[64:67], v[12:15], v[84:87]
    v_fma_f32 v25, v25, v25, 0.5
    v_fma_f32 v33, v33, s84, s84
    v_mfma_f32_16x16x32_bf16 v[88:91], a[68:71], v[12:15], v[88:91]
    v_fma_f32 v34, v34, s84, s84
    s_waitcnt lgkmcnt(2)
    v_mfma_f32_16x16x32_bf16 v[80:83], a[72:75], v[48:51], v[80:83]
    ds_read_b128 v[8:11], v0 offset:33440
    v_fma_f32 v35, v35, s84, s84
    v_exp_f32 v29, v97
    v_mfma_f32_16x16x32_bf16 v[84:87], a[76:79], v[48:51], v[84:87]
    v_fma_f32 v26, v26, v26, 0.5
    v_fma_f32 v32, v32, v32, 0.5
    v_mfma_f32_16x16x32_bf16 v[88:91], a[80:83], v[48:51], v[88:91]
    v_exp_f32 v30, v98
    v_fma_f32 v27, v27, v27, 0.5
    v_fma_f32 v33, v33, v33, 0.5
    v_mfma_f32_16x16x32_bf16 v[80:83], a[84:87], v[64:67], v[80:83]
    ds_read_b128 v[12:15], v0 offset:33456
    v_fma_f32 v34, v34, v34, 0.5
    v_mfma_f32_16x16x32_bf16 v[84:87], a[88:91], v[64:67], v[84:87]
    v_fma_f32 v35, v35, v35, 0.5
    s_waitcnt vmcnt(3)
    global_store_dword v52, v1, s[26:27] offset:0
    v_mfma_f32_16x16x32_bf16 v[88:91], a[92:95], v[64:67], v[88:91]
    buffer_load_dwordx4 v43, s[32:35], s63 offen offset:1024 lds
    s_waitcnt lgkmcnt(2)
    v_mfma_f32_16x16x32_bf16 v[80:83], a[96:99], v[68:71], v[80:83]
    ds_read_b128 v[48:51], v0 offset:33472
    v_exp_f32 v31, v99
    v_mfma_f32_16x16x32_bf16 v[84:87], a[100:103], v[68:71], v[84:87]
    v_rcp_f32 v24, v24
    v_mfma_f32_16x16x32_bf16 v[88:91], a[104:107], v[68:71], v[88:91]
    v_rcp_f32 v32, v32
    v_rcp_f32 v33, v33
    v_mfma_f32_16x16x32_bf16 v[80:83], a[108:111], v[72:75], v[80:83]
    ds_read_b128 v[64:67], v0 offset:33488
    v_fma_f32 v28, v28, s84, s84
    v_rcp_f32 v25, v25
    v_mfma_f32_16x16x32_bf16 v[84:87], a[112:115], v[72:75], v[84:87]
    v_rcp_f32 v34, v34
    v_mfma_f32_16x16x32_bf16 v[88:91], a[116:119], v[72:75], v[88:91]
    v_fma_f32 v29, v29, s84, s84
    s_waitcnt lgkmcnt(2)
    v_mfma_f32_16x16x32_bf16 v[80:83], a[120:123], v[8:11], v[80:83]
    ds_read_b128 v[68:71], v0 offset:33504
    s_add_u32 m0, s70, 14336
    s_add_u32 s63, s75, 311296
    buffer_load_dwordx4 v42, s[32:35], s63 offen offset:0 lds
    v_mfma_f32_16x16x32_bf16 v[84:87], a[124:127], v[8:11], v[84:87]
    v_rcp_f32 v26, v26
    v_mfma_f32_16x16x32_bf16 v[88:91], a[128:131], v[8:11], v[88:91]
    v_rcp_f32 v35, v35
    v_fma_f32 v30, v30, s84, s84
    v_fma_f32 v32, -v100, v32, v100
    v_mfma_f32_16x16x32_bf16 v[80:83], a[132:135], v[12:15], v[80:83]
    ds_read_b128 v[72:75], v0 offset:33520
    v_fma_f32 v33, -v101, v33, v101
    v_rcp_f32 v27, v27
    v_mfma_f32_16x16x32_bf16 v[84:87], a[136:139], v[12:15], v[84:87]
    v_fma_f32 v31, v31, s84, s84
    v_fma_f32 v24, -v92, v24, v92
    v_fma_f32 v28, v28, v28, 0.5
    v_fma_f32 v25, -v93, v25, v93
    v_mfma_f32_16x16x32_bf16 v[88:91], a[140:143], v[12:15], v[88:91]
    v_fma_f32 v29, v29, v29, 0.5
    s_waitcnt lgkmcnt(2)
    v_mfma_f32_16x16x32_bf16 v[80:83], a[144:147], v[48:51], v[80:83]
    ds_read_b128 v[8:11], v0 offset:49920
    v_fma_f32 v26, -v94, v26, v94
    v_fma_f32 v30, v30, v30, 0.5
    v_fma_f32 v27, -v95, v27, v95
    v_mfma_f32_16x16x32_bf16 v[84:87], a[148:151], v[48:51], v[84:87]
    v_fma_f32 v31, v31, v31, 0.5
    v_cvt_pk_bf16_f32 v36, v24, v25
    v_mfma_f32_16x16x32_bf16 v[88:91], a[152:155], v[48:51], v[88:91]
    buffer_load_dwordx4 v43, s[32:35], s63 offen offset:1024 lds
    v_mfma_f32_16x16x32_bf16 v[80:83], a[156:159], v[64:67], v[80:83]
    ds_read_b128 v[12:15], v0 offset:49936
    v_fma_f32 v34, -v102, v34, v102
    v_rcp_f32 v28, v28
    v_mfma_f32_16x16x32_bf16 v[84:87], a[160:163], v[64:67], v[84:87]
    v_cvt_pk_bf16_f32 v37, v26, v27
    v_fma_f32 v35, -v103, v35, v103
    v_rcp_f32 v29, v29
    v_mfma_f32_16x16x32_bf16 v[88:91], a[164:167], v[64:67], v[88:91]
    v_cvt_pk_bf16_f32 v106, v32, v33
    v_rcp_f32 v30, v30
    s_waitcnt lgkmcnt(2)
    v_mfma_f32_16x16x32_bf16 v[80:83], a[168:171], v[68:71], v[80:83]
    ds_read_b128 v[48:51], v0 offset:49952
    v_cvt_pk_bf16_f32 v107, v34, v35
    v_rcp_f32 v31, v31
    v_mfma_f32_16x16x32_bf16 v[84:87], a[172:175], v[68:71], v[84:87]
    global_store_dwordx4 v23, v[104:107], s[26:27] offset:-4096 nt
    v_mfma_f32_16x16x32_bf16 v[88:91], a[176:179], v[68:71], v[88:91]
    v_fma_f32 v28, -v96, v28, v96
    v_fma_f32 v29, -v97, v29, v97
    v_fma_f32 v30, -v98, v30, v98
    v_fma_f32 v31, -v99, v31, v99
    v_mfma_f32_16x16x32_bf16 v[80:83], a[180:183], v[72:75], v[80:83]
    ds_read_b128 v[64:67], v0 offset:49968
    v_cvt_pk_bf16_f32 v38, v28, v29
    v_mfma_f32_16x16x32_bf16 v[84:87], a[184:187], v[72:75], v[84:87]
    v_cvt_pk_bf16_f32 v39, v30, v31
    v_mfma_f32_16x16x32_bf16 v[88:91], a[188:191], v[72:75], v[88:91]
    global_store_dwordx4 v21, v[36:39], s[26:27] offset:0 nt
    s_waitcnt lgkmcnt(2)
    v_mfma_f32_16x16x32_bf16 v[92:95], a[0:3], v[8:11], v[4:7]
    ds_read_b128 v[68:71], v0 offset:49984
    v_mfma_f32_16x16x32_bf16 v[96:99], a[4:7], v[8:11], v[56:59]
    v_mfma_f32_16x16x32_bf16 v[100:103], a[8:11], v[8:11], v[60:63]
    v_mfma_f32_16x16x32_bf16 v[92:95], a[12:15], v[12:15], v[92:95]
    ds_read_b128 v[72:75], v0 offset:50000
    v_mfma_f32_16x16x32_bf16 v[96:99], a[16:19], v[12:15], v[96:99]
    global_load_dword v16, v3, s[26:27] offset:0 nt
    v_mfma_f32_16x16x32_bf16 v[100:103], a[20:23], v[12:15], v[100:103]
    s_waitcnt lgkmcnt(2)
    v_mfma_f32_16x16x32_bf16 v[92:95], a[24:27], v[48:51], v[92:95]
    ds_read_b128 v[8:11], v0 offset:50016
    v_exp_f32 v24, v80
    v_mfma_f32_16x16x32_bf16 v[96:99], a[28:31], v[48:51], v[96:99]
    v_exp_f32 v25, v81
    v_exp_f32 v26, v82
    v_mfma_f32_16x16x32_bf16 v[100:103], a[32:35], v[48:51], v[100:103]
    v_exp_f32 v27, v83
    v_mfma_f32_16x16x32_bf16 v[92:95], a[36:39], v[64:67], v[92:95]
    ds_read_b128 v[12:15], v0 offset:50032
    v_fma_f32 v24, v24, s84, s84
    v_mfma_f32_16x16x32_bf16 v[96:99], a[40:43], v[64:67], v[96:99]
    v_exp_f32 v32, v88
    v_mfma_f32_16x16x32_bf16 v[100:103], a[44:47], v[64:67], v[100:103]
    v_fma_f32 v25, v25, s84, s84
    v_exp_f32 v33, v89
    s_waitcnt lgkmcnt(2)
    v_mfma_f32_16x16x32_bf16 v[92:95], a[48:51], v[68:71], v[92:95]
    ds_read_b128 v[48:51], v0 offset:50048
    v_fma_f32 v26, v26, s84, s84
    v_exp_f32 v34, v90
    v_mfma_f32_16x16x32_bf16 v[96:99], a[52:55], v[68:71], v[96:99]
    v_exp_f32 v35, v91
    v_mfma_f32_16x16x32_bf16 v[100:103], a[56:59], v[68:71], v[100:103]
    v_fma_f32 v27, v27, s84, s84
    v_fma_f32 v24, v24, v24, 0.5
    v_mfma_f32_16x16x32_bf16 v[92:95], a[60:63], v[72:75], v[92:95]
    ds_read_b128 v[64:67], v0 offset:50064
    v_fma_f32 v32, v32, s84, s84
    v_exp_f32 v28, v84
    v_mfma_f32_16x16x32_bf16 v[96:99], a[64:67], v[72:75], v[96:99]
    v_fma_f32 v25, v25, v25, 0.5
    v_fma_f32 v33, v33, s84, s84
    v_mfma_f32_16x16x32_bf16 v[100:103], a[68:71], v[72:75], v[100:103]
    v_fma_f32 v34, v34, s84, s84
    s_waitcnt lgkmcnt(2)
    v_mfma_f32_16x16x32_bf16 v[92:95], a[72:75], v[8:11], v[92:95]
    ds_read_b128 v[68:71], v0 offset:50080
    v_fma_f32 v35, v35, s84, s84
    v_exp_f32 v29, v85
    v_mfma_f32_16x16x32_bf16 v[96:99], a[76:79], v[8:11], v[96:99]
    v_fma_f32 v26, v26, v26, 0.5
    v_fma_f32 v32, v32, v32, 0.5
    v_mfma_f32_16x16x32_bf16 v[100:103], a[80:83], v[8:11], v[100:103]
    v_exp_f32 v30, v86
    s_waitcnt vmcnt(0)
L_F0:
    v_cmp_ne_u32 vcc, s52, v16
    s_cbranch_vccnz L_F0_retry
L_F0_ok:
    s_barrier
    v_mfma_f32_16x16x32_bf16 v[92:95], a[84:87], v[12:15], v[92:95]
    ds_read_b128 v[72:75], v0 offset:50096
    s_add_u32 s62, s91, 0
    buffer_load_dwordx4 v[112:115], v20, s[36:39], s62 offen offset:0 nt
    v_mfma_f32_16x16x32_bf16 v[96:99], a[88:91], v[12:15], v[96:99]
    v_fma_f32 v27, v27, v27, 0.5
    v_fma_f32 v33, v33, v33, 0.5
    v_mfma_f32_16x16x32_bf16 v[100:103], a[92:95], v[12:15], v[100:103]
    v_fma_f32 v34, v34, v34, 0.5
    s_waitcnt lgkmcnt(2)
    v_mfma_f32_16x16x32_bf16 v[92:95], a[96:99], v[48:51], v[92:95]
    ds_read_b128 v[8:11], v0 offset:50112
    v_fma_f32 v35, v35, v35, 0.5
    v_exp_f32 v31, v87
    buffer_load_dwordx4 v[116:119], v20, s[36:39], s62 offen offset:1024 nt
    v_mfma_f32_16x16x32_bf16 v[96:99], a[100:103], v[48:51], v[96:99]
    v_rcp_f32 v24, v24
    v_mfma_f32_16x16x32_bf16 v[100:103], a[104:107], v[48:51], v[100:103]
    v_fma_f32 v28, v28, s84, s84
    v_rcp_f32 v25, v25
    global_store_dword v52, v1, s[26:27] offset:128
    v_mfma_f32_16x16x32_bf16 v[92:95], a[108:111], v[64:67], v[92:95]
    ds_read_b128 v[12:15], v0 offset:50128
    v_fma_f32 v29, v29, s84, s84
    v_rcp_f32 v26, v26
    buffer_load_dwordx4 v[120:123], v20, s[36:39], s62 offen offset:2048 nt
    v_mfma_f32_16x16x32_bf16 v[96:99], a[112:115], v[64:67], v[96:99]
    v_rcp_f32 v32, v32
    v_mfma_f32_16x16x32_bf16 v[100:103], a[116:119], v[64:67], v[100:103]
    v_fma_f32 v30, v30, s84, s84
    s_waitcnt lgkmcnt(2)
    v_mfma_f32_16x16x32_bf16 v[92:95], a[120:123], v[68:71], v[92:95]
    ds_read_b128 v[48:51], v0 offset:50144
    buffer_load_dwordx4 v[124:127], v20, s[36:39], s62 offen offset:3072 nt
    v_mfma_f32_16x16x32_bf16 v[96:99], a[124:127], v[68:71], v[96:99]
    v_rcp_f32 v27, v27
    v_mfma_f32_16x16x32_bf16 v[100:103], a[128:131], v[68:71], v[100:103]
    v_rcp_f32 v33, v33
    v_rcp_f32 v34, v34
    v_mfma_f32_16x16x32_bf16 v[92:95], a[132:135], v[72:75], v[92:95]
    ds_read_b128 v[64:67], v0 offset:50160
    v_rcp_f32 v35, v35
    s_add_u32 s62, s94, 0
    buffer_load_dwordx4 v[128:131], v20, s[36:39], s62 offen offset:0 nt
    v_mfma_f32_16x16x32_bf16 v[96:99], a[136:139], v[72:75], v[96:99]
    v_fma_f32 v31, v31, s84, s84
    v_fma_f32 v24, -v80, v24, v80
    v_fma_f32 v28, v28, v28, 0.5
    v_fma_f32 v25, -v81, v25, v81
    v_mfma_f32_16x16x32_bf16 v[100:103], a[140:143], v[72:75], v[100:103]
    v_fma_f32 v29, v29, v29, 0.5
    s_waitcnt lgkmcnt(2)
    v_mfma_f32_16x16x32_bf16 v[92:95], a[144:147], v[8:11], v[92:95]
    v_fma_f32 v26, -v82, v26, v82
    v_fma_f32 v30, v30, v30, 0.5
    buffer_load_dwordx4 v[132:135], v20, s[36:39], s62 offen offset:1024 nt
    v_mfma_f32_16x16x32_bf16 v[96:99], a[148:151], v[8:11], v[96:99]
    v_fma_f32 v27, -v83, v27, v83
    v_fma_f32 v31, v31, v31, 0.5
    v_mfma_f32_16x16x32_bf16 v[100:103], a[152:155], v[8:11], v[100:103]
    v_cvt_pk_bf16_f32 v36, v24, v25
    v_fma_f32 v32, -v88, v32, v88
    v_mfma_f32_16x16x32_bf16 v[92:95], a[156:159], v[12:15], v[92:95]
    v_rcp_f32 v28, v28
    buffer_load_dwordx4 v[136:139], v20, s[36:39], s62 offen offset:2048 nt
    v_mfma_f32_16x16x32_bf16 v[96:99], a[160:163], v[12:15], v[96:99]
    v_cvt_pk_bf16_f32 v37, v26, v27
    v_fma_f32 v33, -v89, v33, v89
    v_rcp_f32 v29, v29
    v_mfma_f32_16x16x32_bf16 v[100:103], a[164:167], v[12:15], v[100:103]
    v_fma_f32 v34, -v90, v34, v90
    v_rcp_f32 v30, v30
    s_waitcnt lgkmcnt(0)
    v_mfma_f32_16x16x32_bf16 v[92:95], a[168:171], v[48:51], v[92:95]
    v_rcp_f32 v31, v31
    buffer_load_dwordx4 v[140:143], v20, s[36:39], s62 offen offset:3072 nt
    v_mfma_f32_16x16x32_bf16 v[96:99], a[172:175], v[48:51], v[96:99]
    v_fma_f32 v28, -v84, v28, v84
    v_fma_f32 v29, -v85, v29, v85
    v_mfma_f32_16x16x32_bf16 v[100:103], a[176:179], v[48:51], v[100:103]
    v_fma_f32 v30, -v86, v30, v86
    v_fma_f32 v31, -v87, v31, v87
    v_cvt_pk_bf16_f32 v38, v28, v29
    v_cvt_pk_bf16_f32 v39, v30, v31
    v_mfma_f32_16x16x32_bf16 v[92:95], a[180:183], v[64:67], v[92:95]
    global_store_dwordx4 v22, v[36:39], s[26:27] offset:-4096 nt
    v_mfma_f32_16x16x32_bf16 v[96:99], a[184:187], v[64:67], v[96:99]
    v_fma_f32 v35, -v91, v35, v91
    v_cvt_pk_bf16_f32 v104, v32, v33
    v_mfma_f32_16x16x32_bf16 v[100:103], a[188:191], v[64:67], v[100:103]
    v_cvt_pk_bf16_f32 v105, v34, v35
    s_nop 1
    v_exp_f32 v24, v92
    v_exp_f32 v25, v93
    v_exp_f32 v26, v94
    v_exp_f32 v27, v95
    v_exp_f32 v28, v96
    v_exp_f32 v29, v97
    v_exp_f32 v30, v98
    v_exp_f32 v31, v99
    v_exp_f32 v32, v100
    v_exp_f32 v33, v101
    v_exp_f32 v34, v102
    v_exp_f32 v35, v103
    v_pk_fma_f32 v[24:25], v[24:25], s[84:85], s[84:85] op_sel_hi:[1,0,0]
    v_pk_fma_f32 v[26:27], v[26:27], s[84:85], s[84:85] op_sel_hi:[1,0,0]
    v_pk_fma_f32 v[28:29], v[28:29], s[84:85], s[84:85] op_sel_hi:[1,0,0]
    v_pk_fma_f32 v[30:31], v[30:31], s[84:85], s[84:85] op_sel_hi:[1,0,0]
    v_pk_fma_f32 v[32:33], v[32:33], s[84:85], s[84:85] op_sel_hi:[1,0,0]
    v_pk_fma_f32 v[34:35], v[34:35], s[84:85], s[84:85] op_sel_hi:[1,0,0]
    v_pk_fma_f32 v[24:25], v[24:25], v[24:25], s[84:85] op_sel:[0,0,1] op_sel_hi:[1,1,1]
    v_pk_fma_f32 v[26:27], v[26:27], v[26:27], s[84:85] op_sel:[0,0,1] op_sel_hi:[1,1,1]
    global_load_dword v16, v3, s[26:27] offset:128 nt
    v_pk_fma_f32 v[28:29], v[28:29], v[28:29], s[84:85] op_sel:[0,0,1] op_sel_hi:[1,1,1]
    v_pk_fma_f32 v[30:31], v[30:31], v[30:31], s[84:85] op_sel:[0,0,1] op_sel_hi:[1,1,1]
    v_pk_fma_f32 v[32:33], v[32:33], v[32:33], s[84:85] op_sel:[0,0,1] op_sel_hi:[1,1,1]
    v_pk_fma_f32 v[34:35], v[34:35], v[34:35], s[84:85] op_sel:[0,0,1] op_sel_hi:[1,1,1]
    v_rcp_f32 v24, v24
    v_rcp_f32 v25, v25
    v_rcp_f32 v26, v26
    v_rcp_f32 v27, v27
    v_pk_fma_f32 v[24:25], v[92:93], v[24:25], v[92:93] neg_lo:[1,0,0] neg_hi:[1,0,0]
    v_pk_fma_f32 v[26:27], v[94:95], v[26:27], v[94:95] neg_lo:[1,0,0] neg_hi:[1,0,0]
    v_cvt_pk_bf16_f32 v36, v24, v25
    v_cvt_pk_bf16_f32 v37, v26, v27
    v_rcp_f32 v28, v28
    v_rcp_f32 v29, v29
    v_rcp_f32 v30, v30
    v_rcp_f32 v31, v31
    v_pk_fma_f32 v[28:29], v[96:97], v[28:29], v[96:97] neg_lo:[1,0,0] neg_hi:[1,0,0]
    v_pk_fma_f32 v[30:31], v[98:99], v[30:31], v[98:99] neg_lo:[1,0,0] neg_hi:[1,0,0]
    v_cvt_pk_bf16_f32 v38, v28, v29
    v_cvt_pk_bf16_f32 v39, v30, v31
    global_store_dwordx4 v22, v[36:39], s[26:27] offset:0 nt
    v_rcp_f32 v32, v32
    v_rcp_f32 v33, v33
    v_rcp_f32 v34, v34
    v_rcp_f32 v35, v35
    v_pk_fma_f32 v[32:33], v[100:101], v[32:33], v[100:101] neg_lo:[1,0,0] neg_hi:[1,0,0]
    v_pk_fma_f32 v[34:35], v[102:103], v[34:35], v[102:103] neg_lo:[1,0,0] neg_hi:[1,0,0]
    v_cvt_pk_bf16_f32 v106, v32, v33
    v_cvt_pk_bf16_f32 v107, v34, v35
    global_store_dwordx4 v23, v[104:107], s[26:27] offset:0 nt
    ds_read_b128 v[68:71], v2 offset:0
    ds_read_b128 v[72:75], v2 offset:16
    v_add_u32 v27, 32768, v40
    s_barrier
    s_waitcnt vmcnt(12)
    v_mfma_f32_16x16x32_bf16 a[96:99], a[192:195], v[112:115], 0
    s_waitcnt vmcnt(2)
L_F1:
    v_cmp_ne_u32 vcc, s52, v16
    s_cbranch_vccnz L_F1_retry
L_F1_ok:
    global_store_dword v52, v1, s[26:27] offset:256
    ds_read_b64_tr_b16 v[192:193], v44 offset:0
    v_mfma_f32_16x16x32_bf16 a[100:103], a[196:199], v[112:115], 0
    ds_read_b64_tr_b16 v[196:197], v45 offset:0
    v_mfma_f32_16x16x32_bf16 a[104:107], a[200:203], v[112:115], 0
    v_lshrrev_b32 v24, 1, v19
    s_add_u32 s62, s91, 4096
    buffer_load_dwordx4 a[0:3], v20, s[36:39], s62 offen offset:0 nt
    v_mfma_f32_16x16x32_bf16 a[108:111], a[204:207], v[112:115], 0
    v_lshl_add_u32 v24, v24, 1, v18
    ds_read_b64_tr_b16 v[200:201], v46 offset:0
    v_mfma_f32_16x16x32_bf16 a[96:99], a[208:211], v[116:119], a[96:99]
    buffer_load_dwordx4 a[4:7], v20, s[36:39], s62 offen offset:1024 nt
    v_mfma_f32_16x16x32_bf16 a[100:103], a[212:215], v[116:119], a[100:103]
    ds_read_b64_tr_b16 v[204:205], v47 offset:0
    v_mfma_f32_16x16x32_bf16 a[104:107], a[216:219], v[116:119], a[104:107]
    buffer_load_dwordx4 a[8:11], v20, s[36:39], s62 offen offset:2048 nt
    v_mfma_f32_16x16x32_bf16 a[108:111], a[220:223], v[116:119], a[108:111]
    s_lshl_b32 s58, s53, 12
    ds_read_b64_tr_b16 v[194:195], v44 offset:2048
    v_mfma_f32_16x16x32_bf16 a[96:99], a[224:227], v[120:123], a[96:99]
    buffer_load_dwordx4 a[12:15], v20, s[36:39], s62 offen offset:3072 nt
    ds_read_b64_tr_b16 v[198:199], v45 offset:2048
    v_mfma_f32_16x16x32_bf16 a[100:103], a[228:231], v[120:123], a[100:103]
    v_lshl_add_u32 v25, v19, 8, s58
    s_add_u32 s60, s53, 0
    v_mfma_f32_16x16x32_bf16 a[104:107], a[232:235], v[120:123], a[104:107]
    s_and_b32 s60, s60, 3
    s_add_u32 s62, s94, 4096
    buffer_load_dwordx4 a[16:19], v20, s[36:39], s62 offen offset:0 nt
    ds_read_b64_tr_b16 v[202:203], v46 offset:2048
    v_mfma_f32_16x16x32_bf16 a[108:111], a[236:239], v[120:123], a[108:111]
    v_lshl_add_u32 v26, s60, 2, v24
    v_mfma_f32_16x16x32_bf16 a[96:99], a[240:243], v[124:127], a[96:99]
    buffer_load_dwordx4 a[20:23], v20, s[36:39], s62 offen offset:1024 nt
    ds_read_b64_tr_b16 v[206:207], v47 offset:2048
    v_mfma_f32_16x16x32_bf16 a[100:103], a[244:247], v[124:127], a[100:103]
    v_and_b32 v26, 15, v26
    v_lshl_add_u32 v26, v26, 4, v25
    v_mfma_f32_16x16x32_bf16 a[104:107], a[248:251], v[124:127], a[104:107]
    ds_read_b64_tr_b16 v[208:209], v44 offset:4096
    v_mfma_f32_16x16x32_bf16 a[108:111], a[252:255], v[124:127], a[108:111]
    v_lshl_add_u32 v4, s60, 10, v26
    ds_read_b64_tr_b16 v[212:213], v45 offset:4096
    v_mfma_f32_16x16x32_bf16 a[96:99], v[144:147], v[128:131], a[96:99]
    global_load_dword v16, v3, s[26:27] offset:256 nt
    buffer_load_dwordx4 a[24:27], v20, s[36:39], s62 offen offset:2048 nt
    v_mfma_f32_16x16x32_bf16 a[100:103], v[148:151], v[128:131], a[100:103]
    ds_read_b64_tr_b16 v[216:217], v46 offset:4096
    v_mfma_f32_16x16x32_bf16 a[104:107], v[152:155], v[128:131], a[104:107]
    s_add_u32 s60, s53, 1
    s_and_b32 s60, s60, 3
    v_mfma_f32_16x16x32_bf16 a[108:111], v[156:159], v[128:131], a[108:111]
    v_lshl_add_u32 v26, s60, 2, v24
    ds_read_b64_tr_b16 v[220:221], v47 offset:4096
    v_mfma_f32_16x16x32_bf16 a[96:99], v[160:163], v[132:135], a[96:99]
    buffer_load_dwordx4 a[28:31], v20, s[36:39], s62 offen offset:3072 nt
    v_mfma_f32_16x16x32_bf16 a[100:103], v[164:167], v[132:135], a[100:103]
    ds_read_b64_tr_b16 v[210:211], v44 offset:6144
    v_mfma_f32_16x16x32_bf16 a[104:107], v[168:171], v[132:135], a[104:107]
    v_and_b32 v26, 15, v26
    s_waitcnt vmcnt(10)
    global_store_dword v52, v1, s[26:27] offset:384
    ds_read_b64_tr_b16 v[214:215], v45 offset:6144
    v_mfma_f32_16x16x32_bf16 a[108:111], v[172:175], v[132:135], a[108:111]
    v_mfma_f32_16x16x32_bf16 a[96:99], v[176:179], v[136:139], a[96:99]
    s_add_u32 s62, s93, 0
    buffer_load_dwordx4 v[8:11], v20, s[36:39], s62 offen offset:0 nt
    ds_read_b64_tr_b16 v[218:219], v46 offset:6144
    v_mfma_f32_16x16x32_bf16 a[100:103], v[180:183], v[136:139], a[100:103]
    v_mfma_f32_16x16x32_bf16 a[104:107], v[184:187], v[136:139], a[104:107]
    ds_read_b64_tr_b16 v[222:223], v47 offset:6144
    v_mfma_f32_16x16x32_bf16 a[108:111], v[188:191], v[136:139], a[108:111]
    buffer_load_dwordx4 v[12:15], v20, s[36:39], s62 offen offset:1024 nt
    s_waitcnt lgkmcnt(11)
    v_mfma_f32_16x16x32_bf16 a[96:99], v[192:195], v[140:143], a[96:99]
    s_waitcnt lgkmcnt(10)
    v_mfma_f32_16x16x32_bf16 a[100:103], v[196:199], v[140:143], a[100:103]
    s_waitcnt lgkmcnt(9)
    v_mfma_f32_16x16x32_bf16 a[104:107], v[200:203], v[140:143], a[104:107]
    s_waitcnt lgkmcnt(8)
    v_mfma_f32_16x16x32_bf16 a[108:111], v[204:207], v[140:143], a[108:111]
    s_waitcnt vmcnt(11)
    v_mfma_f32_16x16x32_bf16 a[112:115], a[192:195], a[0:3], 0
    buffer_load_dwordx4 v[48:51], v20, s[36:39], s62 offen offset:2048 nt
    ds_read_b64_tr_b16 v[224:225], v44 offset:8192
    v_mfma_f32_16x16x32_bf16 a[116:119], a[196:199], a[0:3], 0
    v_lshl_add_u32 v26, v26, 4, v25
    v_lshl_add_u32 v5, s60, 10, v26
    v_mfma_f32_16x16x32_bf16 a[120:123], a[200:203], a[0:3], 0
    ds_read_b64_tr_b16 v[228:229], v45 offset:8192
    v_mfma_f32_16x16x32_bf16 a[124:127], a[204:207], a[0:3], 0
    s_add_u32 s62, s96, 0
    buffer_load_dwordx4 v[56:59], v20, s[36:39], s62 offen offset:0 nt
    s_waitcnt vmcnt(12)
    v_mfma_f32_16x16x32_bf16 a[112:115], a[208:211], a[4:7], a[112:115]
    ds_read_b64_tr_b16 v[232:233], v46 offset:8192
    v_mfma_f32_16x16x32_bf16 a[116:119], a[212:215], a[4:7], a[116:119]
    s_add_u32 s60, s53, 2
    s_and_b32 s60, s60, 3
    v_mfma_f32_16x16x32_bf16 a[120:123], a[216:219], a[4:7], a[120:123]
    ds_read_b64_tr_b16 v[236:237], v47 offset:8192
    v_mfma_f32_16x16x32_bf16 a[124:127], a[220:223], a[4:7], a[124:127]
    v_lshl_add_u32 v26, s60, 2, v24
    s_waitcnt vmcnt(11)
    v_mfma_f32_16x16x32_bf16 a[112:115], a[224:227], a[8:11], a[112:115]
    buffer_load_dwordx4 v[60:63], v20, s[36:39], s62 offen offset:1024 nt
    ds_read_b64_tr_b16 v[226:227], v44 offset:10240
    v_mfma_f32_16x16x32_bf16 a[116:119], a[228:231], a[8:11], a[116:119]
    v_and_b32 v26, 15, v26
    v_lshl_add_u32 v26, v26, 4, v25
    v_mfma_f32_16x16x32_bf16 a[120:123], a[232:235], a[8:11], a[120:123]
    ds_read_b64_tr_b16 v[230:231], v45 offset:10240
    v_mfma_f32_16x16x32_bf16 a[124:127], a[236:239], a[8:11], a[124:127]
    v_lshl_add_u32 v6, s60, 10, v26
    buffer_load_dwordx4 v[64:67], v20, s[36:39], s62 offen offset:2048 nt
    s_waitcnt vmcnt(12)
    v_mfma_f32_16x16x32_bf16 a[112:115], a[240:243], a[12:15], a[112:115]
    ds_read_b64_tr_b16 v[234:235], v46 offset:10240
    v_mfma_f32_16x16x32_bf16 a[116:119], a[244:247], a[12:15], a[116:119]
    s_add_u32 s60, s53, 3
    s_and_b32 s60, s60, 3
    v_mfma_f32_16x16x32_bf16 a[120:123], a[248:251], a[12:15], a[120:123]
    s_waitcnt vmcnt(9)
L_F2:
    v_cmp_ne_u32 vcc, s52, v16
    s_cbranch_vccnz L_F2_retry
L_F2_ok:
    ds_read_b64_tr_b16 v[238:239], v47 offset:10240
    v_mfma_f32_16x16x32_bf16 a[124:127], a[252:255], a[12:15], a[124:127]
    global_load_dword v16, v3, s[26:27] offset:384 nt
    v_mfma_f32_16x16x32_bf16 a[112:115], v[144:147], a[16:19], a[112:115]
    s_add_u32 s62, s92, 0
    buffer_load_dwordx4 a[32:35], v20, s[36:39], s62 offen offset:0 nt
    ds_read_b64_tr_b16 v[240:241], v44 offset:12288
    v_mfma_f32_16x16x32_bf16 a[116:119], v[148:151], a[16:19], a[116:119]
    v_mfma_f32_16x16x32_bf16 a[120:123], v[152:155], a[16:19], a[120:123]
    ds_read_b64_tr_b16 v[244:245], v45 offset:12288
    v_mfma_f32_16x16x32_bf16 a[124:127], v[156:159], a[16:19], a[124:127]
    v_mfma_f32_16x16x32_bf16 a[112:115], v[160:163], a[20:23], a[112:115]
    buffer_load_dwordx4 a[36:39], v20, s[36:39], s62 offen offset:1024 nt
    ds_read_b64_tr_b16 v[248:249], v46 offset:12288
    v_mfma_f32_16x16x32_bf16 a[116:119], v[164:167], a[20:23], a[116:119]
    global_load_dwordx4 v[32:35], v40, s[26:27]
    v_mfma_f32_16x16x32_bf16 a[120:123], v[168:171], a[20:23], a[120:123]
    global_load_dwordx4 v[36:39], v27, s[26:27]
    ds_read_b64_tr_b16 v[252:253], v47 offset:12288
    v_mfma_f32_16x16x32_bf16 a[124:127], v[172:175], a[20:23], a[124:127]
    s_waitcnt vmcnt(13)
    v_mfma_f32_16x16x32_bf16 a[112:115], v[176:179], a[24:27], a[112:115]
    buffer_load_dwordx4 a[40:43], v20, s[36:39], s62 offen offset:2048 nt
    ds_read_b64_tr_b16 v[242:243], v44 offset:14336
    v_mfma_f32_16x16x32_bf16 a[116:119], v[180:183], a[24:27], a[116:119]
    v_mfma_f32_16x16x32_bf16 a[120:123], v[184:187], a[24:27], a[120:123]
    ds_read_b64_tr_b16 v[246:247], v45 offset:14336
    v_mfma_f32_16x16x32_bf16 a[124:127], v[188:191], a[24:27], a[124:127]
    s_waitcnt vmcnt(13)
    v_mfma_f32_16x16x32_bf16 a[112:115], v[192:195], a[28:31], a[112:115]
    buffer_load_dwordx4 a[44:47], v20, s[36:39], s62 offen offset:3072 nt
    ds_read_b64_tr_b16 v[250:251], v46 offset:14336
    v_mfma_f32_16x16x32_bf16 a[116:119], v[196:199], a[28:31], a[116:119]
    v_mfma_f32_16x16x32_bf16 a[120:123], v[200:203], a[28:31], a[120:123]
    s_waitcnt vmcnt(11)
    v_swap_b32 v10, v12
    v_swap_b32 v11, v13
    ds_read_b64_tr_b16 v[254:255], v47 offset:14336
    v_mfma_f32_16x16x32_bf16 a[124:127], v[204:207], a[28:31], a[124:127]
    s_waitcnt lgkmcnt(15)
    v_mfma_f32_16x16x32_bf16 a[96:99], v[208:211], v[8:11], a[96:99]
    v_lshl_add_u32 v26, s60, 2, v24
    s_add_u32 s62, s95, 0
    buffer_load_dwordx4 a[48:51], v20, s[36:39], s62 offen offset:0 nt
    s_waitcnt lgkmcnt(15)
    v_mfma_f32_16x16x32_bf16 a[100:103], v[212:215], v[8:11], a[100:103]
    v_and_b32 v26, 15, v26
    v_lshl_add_u32 v26, v26, 4, v25
    s_waitcnt lgkmcnt(15)
    v_mfma_f32_16x16x32_bf16 a[104:107], v[216:219], v[8:11], a[104:107]
    v_lshl_add_u32 v7, s60, 10, v26
    v_lshrrev_b32 v24, 3, v17
    s_waitcnt lgkmcnt(15)
    v_mfma_f32_16x16x32_bf16 a[108:111], v[220:223], v[8:11], a[108:111]
    v_and_b32 v25, 7, v17
    s_and_b32 s60, s53, 1
    v_mfma_f32_16x16x32_bf16 a[112:115], v[208:211], v[12:15], a[112:115]
    buffer_load_dwordx4 a[52:55], v20, s[36:39], s62 offen offset:1024 nt
    v_mfma_f32_16x16x32_bf16 a[116:119], v[212:215], v[12:15], a[116:119]
    s_lshl_b32 s58, s60, 3
    v_lshl_add_u32 v26, v25, 1, v24
    v_mfma_f32_16x16x32_bf16 a[120:123], v[216:219], v[12:15], a[120:123]
    s_waitcnt vmcnt(11)
    v_swap_b32 v50, v56
    v_swap_b32 v51, v57
    v_mfma_f32_16x16x32_bf16 a[124:127], v[220:223], v[12:15], a[124:127]
    v_add_u32 v26, s58, v26
    v_and_b32 v26, 15, v26
    s_waitcnt lgkmcnt(11)
    v_mfma_f32_16x16x32_bf16 a[96:99], v[224:227], v[48:51], a[96:99]
    buffer_load_dwordx4 a[56:59], v20, s[36:39], s62 offen offset:2048 nt
    s_waitcnt lgkmcnt(10)
    v_mfma_f32_16x16x32_bf16 a[100:103], v[228:231], v[48:51], a[100:103]
    v_lshlrev_b32 v26, 4, v26
    v_lshl_add_u32 v26, v25, 9, v26
    s_waitcnt lgkmcnt(9)
    v_mfma_f32_16x16x32_bf16 a[104:107], v[232:235], v[48:51], a[104:107]
    s_lshr_b32 s58, s53, 1
    s_lshl_b32 s58, s58, 14
    s_waitcnt lgkmcnt(8)
    v_mfma_f32_16x16x32_bf16 a[108:111], v[236:239], v[48:51], a[108:111]
    v_add_u32 v41, s58, v26
    v_lshrrev_b32 v26, 1, v24
    v_mfma_f32_16x16x32_bf16 a[112:115], v[224:227], v[56:59], a[112:115]
    v_lshlrev_b32 v26, 15, v26
    s_waitcnt vmcnt(9)
L_F3:
    v_cmp_ne_u32 vcc, s52, v16
    s_cbranch_vccnz L_F3_retry
L_F3_ok:
    buffer_load_dwordx4 a[60:63], v20, s[36:39], s62 offen offset:3072 nt
    v_mfma_f32_16x16x32_bf16 a[116:119], v[228:231], v[56:59], a[116:119]
    v_and_b32 v24, 1, v24
    v_lshl_add_u32 v26, v24, 10, v26
    v_mfma_f32_16x16x32_bf16 a[120:123], v[232:235], v[56:59], a[120:123]
    v_swap_b32 v62, v64
    v_swap_b32 v63, v65
    v_mfma_f32_16x16x32_bf16 a[124:127], v[236:239], v[56:59], a[124:127]
    v_lshl_add_u32 v26, v25, 4, v26
    s_lshl_b32 s60, s53, 18
    s_waitcnt lgkmcnt(3)
    v_mfma_f32_16x16x32_bf16 a[96:99], v[240:243], v[60:63], a[96:99]
    s_lshr_b32 s58, s55, 4
    s_add_u32 s62, s93, 4096
    buffer_load_dwordx4 v[84:87], v20, s[36:39], s62 offen offset:0 nt
    s_waitcnt lgkmcnt(2)
    v_mfma_f32_16x16x32_bf16 a[100:103], v[244:247], v[60:63], a[100:103]
    s_lshl_b32 s58, s58, 17
    s_add_u32 s60, s60, s58
    s_waitcnt lgkmcnt(1)
    v_mfma_f32_16x16x32_bf16 a[104:107], v[248:251], v[60:63], a[104:107]
    buffer_load_dwordx4 v[88:91], v20, s[36:39], s62 offen offset:1024 nt
    s_waitcnt lgkmcnt(0)
    v_mfma_f32_16x16x32_bf16 a[108:111], v[252:255], v[60:63], a[108:111]
    s_and_b32 s58, s55, 15
    s_lshl_b32 s58, s58, 11
    v_mfma_f32_16x16x32_bf16 a[112:115], v[240:243], v[64:67], a[112:115]
    buffer_load_dwordx4 v[92:95], v20, s[36:39], s62 offen offset:2048 nt
    v_mfma_f32_16x16x32_bf16 a[116:119], v[244:247], v[64:67], a[116:119]
    s_add_u32 s60, s60, s58
    s_lshl_b32 s58, s56, 7
    v_mfma_f32_16x16x32_bf16 a[120:123], v[248:251], v[64:67], a[120:123]
    s_add_u32 s60, s60, s58
    s_add_u32 s62, s96, 4096
    buffer_load_dwordx4 v[96:99], v20, s[36:39], s62 offen offset:0 nt
    v_mfma_f32_16x16x32_bf16 a[124:127], v[252:255], v[64:67], a[124:127]
    v_add_u32 v42, s60, v26
    v_add_u32 v43, 1048576, v42
    s_waitcnt vmcnt(13)
    v_mfma_f32_16x16x32_bf16 a[128:131], a[192:195], a[32:35], 0
    buffer_load_dwordx4 v[100:103], v20, s[36:39], s62 offen offset:1024 nt
    v_mfma_f32_16x16x32_bf16 a[132:135], a[196:199], a[32:35], 0
    v_mfma_f32_16x16x32_bf16 a[136:139], a[200:203], a[32:35], 0
    buffer_load_dwordx4 v[104:107], v20, s[36:39], s62 offen offset:2048 nt
    ds_write_b128 v4, a[96:99] offset:0
    v_mfma_f32_16x16x32_bf16 a[140:143], a[204:207], a[32:35], 0
    s_waitcnt vmcnt(14)
    v_mfma_f32_16x16x32_bf16 a[128:131], a[208:211], a[36:39], a[128:131]
    s_add_u32 s62, s92, 4096
    buffer_load_dwordx4 a[64:67], v20, s[36:39], s62 offen offset:0 nt
    v_mfma_f32_16x16x32_bf16 a[132:135], a[212:215], a[36:39], a[132:135]
    ds_write_b128 v5, a[100:103] offset:0
    v_mfma_f32_16x16x32_bf16 a[136:139], a[216:219], a[36:39], a[136:139]
    v_mfma_f32_16x16x32_bf16 a[140:143], a[220:223], a[36:39], a[140:143]
    s_waitcnt vmcnt(12)
    v_mfma_f32_16x16x32_bf16 a[128:131], a[224:227], a[40:43], a[128:131]
    buffer_load_dwordx4 a[68:71], v20, s[36:39], s62 offen offset:1024 nt
    ds_write_b128 v6, a[104:107] offset:0
    v_mfma_f32_16x16x32_bf16 a[132:135], a[228:231], a[40:43], a[132:135]
    v_mfma_f32_16x16x32_bf16 a[136:139], a[232:235], a[40:43], a[136:139]
    v_mfma_f32_16x16x32_bf16 a[140:143], a[236:239], a[40:43], a[140:143]
    ds_write_b128 v7, a[108:111] offset:0
    s_waitcnt vmcnt(12)
    v_mfma_f32_16x16x32_bf16 a[128:131], a[240:243], a[44:47], a[128:131]
    buffer_load_dwordx4 a[72:75], v20, s[36:39], s62 offen offset:2048 nt
    v_mfma_f32_16x16x32_bf16 a[132:135], a[244:247], a[44:47], a[132:135]
    v_mfma_f32_16x16x32_bf16 a[136:139], a[248:251], a[44:47], a[136:139]
    ds_write_b128 v4, a[112:115] offset:16384
    v_mfma_f32_16x16x32_bf16 a[140:143], a[252:255], a[44:47], a[140:143]
    s_waitcnt vmcnt(12)
    v_mfma_f32_16x16x32_bf16 a[128:131], v[144:147], a[48:51], a[128:131]
    buffer_load_dwordx4 a[76:79], v20, s[36:39], s62 offen offset:3072 nt
    v_mfma_f32_16x16x32_bf16 a[132:135], v[148:151], a[48:51], a[132:135]
    ds_write_b128 v5, a[116:119] offset:16384
    v_mfma_f32_16x16x32_bf16 a[136:139], v[152:155], a[48:51], a[136:139]
    v_mfma_f32_16x16x32_bf16 a[140:143], v[156:159], a[48:51], a[140:143]
    s_waitcnt vmcnt(12)
    v_mfma_f32_16x16x32_bf16 a[128:131], v[160:163], a[52:55], a[128:131]
    s_add_u32 s62, s95, 4096
    buffer_load_dwordx4 a[80:83], v20, s[36:39], s62 offen offset:0 nt
    ds_write_b128 v6, a[120:123] offset:16384
    v_mfma_f32_16x16x32_bf16 a[132:135], v[164:167], a[52:55], a[132:135]
    v_mfma_f32_16x16x32_bf16 a[136:139], v[168:171], a[52:55], a[136:139]
    v_mfma_f32_16x16x32_bf16 a[140:143], v[172:175], a[52:55], a[140:143]
    ds_write_b128 v7, a[124:127] offset:16384
    s_waitcnt vmcnt(12)
    v_mfma_f32_16x16x32_bf16 a[128:131], v[176:179], a[56:59], a[128:131]
    buffer_load_dwordx4 a[84:87], v20, s[36:39], s62 offen offset:1024 nt
    v_mfma_f32_16x16x32_bf16 a[132:135], v[180:183], a[56:59], a[132:135]
    v_mfma_f32_16x16x32_bf16 a[136:139], v[184:187], a[56:59], a[136:139]
    v_mfma_f32_16x16x32_bf16 a[140:143], v[188:191], a[56:59], a[140:143]
    s_waitcnt vmcnt(12)
    v_mfma_f32_16x16x32_bf16 a[128:131], v[192:195], a[60:63], a[128:131]
    buffer_load_dwordx4 a[88:91], v20, s[36:39], s62 offen offset:2048 nt
    v_mfma_f32_16x16x32_bf16 a[132:135], v[196:199], a[60:63], a[132:135]
    v_mfma_f32_16x16x32_bf16 a[136:139], v[200:203], a[60:63], a[136:139]
    s_waitcnt vmcnt(11)
    v_swap_b32 v86, v88
    v_swap_b32 v87, v89
    v_mfma_f32_16x16x32_bf16 a[140:143], v[204:207], a[60:63], a[140:143]
    s_waitcnt lgkmcnt(0)
    s_barrier
    v_mfma_f32_16x16x32_bf16 a[128:131], v[208:211], v[84:87], a[128:131]
    buffer_load_dwordx4 a[92:95], v20, s[36:39], s62 offen offset:3072 nt
    ds_read_b128 v[112:115], v41 offset:0
    v_mfma_f32_16x16x32_bf16 a[132:135], v[212:215], v[84:87], a[132:135]
    ds_read_b128 v[116:119], v41 offset:256
    v_mfma_f32_16x16x32_bf16 a[136:139], v[216:219], v[84:87], a[136:139]
    s_waitcnt vmcnt(10)
    v_swap_b32 v94, v96
    v_swap_b32 v95, v97
    v_mfma_f32_16x16x32_bf16 a[140:143], v[220:223], v[84:87], a[140:143]
    ds_read_b128 v[120:123], v41 offset:4096
    v_mfma_f32_16x16x32_bf16 a[128:131], v[224:227], v[92:95], a[128:131]
    ds_read_b128 v[124:127], v41 offset:4352
    v_mfma_f32_16x16x32_bf16 a[132:135], v[228:231], v[92:95], a[132:135]
    v_mfma_f32_16x16x32_bf16 a[136:139], v[232:235], v[92:95], a[136:139]
    s_waitcnt vmcnt(8)
    v_swap_b32 v102, v104
    v_swap_b32 v103, v105
    ds_read_b128 v[128:131], v41 offset:8192
    v_mfma_f32_16x16x32_bf16 a[140:143], v[236:239], v[92:95], a[140:143]
    ds_read_b128 v[132:135], v41 offset:8448
    v_mfma_f32_16x16x32_bf16 a[128:131], v[240:243], v[100:103], a[128:131]
    v_mfma_f32_16x16x32_bf16 a[132:135], v[244:247], v[100:103], a[132:135]
    ds_read_b128 v[136:139], v41 offset:12288
    v_mfma_f32_16x16x32_bf16 a[136:139], v[248:251], v[100:103], a[136:139]
    ds_read_b128 v[140:143], v41 offset:12544
    v_mfma_f32_16x16x32_bf16 a[140:143], v[252:255], v[100:103], a[140:143]
    s_waitcnt vmcnt(7)
    v_mfma_f32_16x16x32_bf16 a[144:147], a[192:195], a[64:67], 0
    s_waitcnt lgkmcnt(5)
    v_add_f32 v112, v112, v120
    v_add_f32 v113, v113, v121
    v_mfma_f32_16x16x32_bf16 a[148:151], a[196:199], a[64:67], 0
    v_add_f32 v114, v114, v122
    v_add_f32 v115, v115, v123
    v_mfma_f32_16x16x32_bf16 a[152:155], a[200:203], a[64:67], 0
    ds_write_b128 v4, a[128:131] offset:32768
    v_mfma_f32_16x16x32_bf16 a[156:159], a[204:207], a[64:67], 0
    s_waitcnt lgkmcnt(5)
    v_add_f32 v116, v116, v124
    s_waitcnt vmcnt(6)
    v_mfma_f32_16x16x32_bf16 a[144:147], a[208:211], a[68:71], a[144:147]
    v_add_f32 v117, v117, v125
    v_add_f32 v118, v118, v126
    v_mfma_f32_16x16x32_bf16 a[148:151], a[212:215], a[68:71], a[148:151]
    v_add_f32 v119, v119, v127
    s_waitcnt lgkmcnt(2)
    v_add_f32 v128, v128, v136
    v_mfma_f32_16x16x32_bf16 a[152:155], a[216:219], a[68:71], a[152:155]
    ds_write_b128 v5, a[132:135] offset:32768
    v_mfma_f32_16x16x32_bf16 a[156:159], a[220:223], a[68:71], a[156:159]
    v_add_f32 v129, v129, v137
    s_waitcnt vmcnt(5)
    v_mfma_f32_16x16x32_bf16 a[144:147], a[224:227], a[72:75], a[144:147]
    v_add_f32 v130, v130, v138
    v_add_f32 v131, v131, v139
    v_mfma_f32_16x16x32_bf16 a[148:151], a[228:231], a[72:75], a[148:151]
    s_waitcnt lgkmcnt(2)
    v_add_f32 v132, v132, v140
    v_add_f32 v133, v133, v141
    v_mfma_f32_16x16x32_bf16 a[152:155], a[232:235], a[72:75], a[152:155]
    ds_write_b128 v6, a[136:139] offset:32768
    v_mfma_f32_16x16x32_bf16 a[156:159], a[236:239], a[72:75], a[156:159]
    v_add_f32 v134, v134, v142
    s_waitcnt vmcnt(4)
    v_mfma_f32_16x16x32_bf16 a[144:147], a[240:243], a[76:79], a[144:147]
    v_add_f32 v135, v135, v143
    v_add_f32 v112, v112, v128
    v_mfma_f32_16x16x32_bf16 a[148:151], a[244:247], a[76:79], a[148:151]
    v_add_f32 v113, v113, v129
    v_add_f32 v114, v114, v130
    v_mfma_f32_16x16x32_bf16 a[152:155], a[248:251], a[76:79], a[152:155]
    ds_write_b128 v7, a[140:143] offset:32768
    v_mfma_f32_16x16x32_bf16 a[156:159], a[252:255], a[76:79], a[156:159]
    v_add_f32 v115, v115, v131
    s_waitcnt vmcnt(3)
    v_mfma_f32_16x16x32_bf16 a[144:147], v[144:147], a[80:83], a[144:147]
    v_add_f32 v116, v116, v132
    v_add_f32 v117, v117, v133
    v_mfma_f32_16x16x32_bf16 a[148:151], v[148:151], a[80:83], a[148:151]
    v_add_f32 v118, v118, v134
    v_add_f32 v119, v119, v135
    v_mfma_f32_16x16x32_bf16 a[152:155], v[152:155], a[80:83], a[152:155]
    v_lshlrev_b32 v76, 16, v32
    v_and_b32 v77, 0xffff0000, v32
    v_mfma_f32_16x16x32_bf16 a[156:159], v[156:159], a[80:83], a[156:159]
    v_lshlrev_b32 v78, 16, v33
    s_waitcnt vmcnt(2)
    v_mfma_f32_16x16x32_bf16 a[144:147], v[160:163], a[84:87], a[144:147]
    v_and_b32 v79, 0xffff0000, v33
    v_lshlrev_b32 v80, 16, v34
    v_mfma_f32_16x16x32_bf16 a[148:151], v[164:167], a[84:87], a[148:151]
    v_and_b32 v81, 0xffff0000, v34
    v_lshlrev_b32 v82, 16, v35
    v_mfma_f32_16x16x32_bf16 a[152:155], v[168:171], a[84:87], a[152:155]
    v_and_b32 v83, 0xffff0000, v35
    v_fma_f32 v112, v112, v68, v76
    v_mfma_f32_16x16x32_bf16 a[156:159], v[172:175], a[84:87], a[156:159]
    v_fma_f32 v113, v113, v69, v77
    s_waitcnt vmcnt(1)
    v_mfma_f32_16x16x32_bf16 a[144:147], v[176:179], a[88:91], a[144:147]
    v_fma_f32 v114, v114, v70, v78
    v_fma_f32 v115, v115, v71, v79
    v_mfma_f32_16x16x32_bf16 a[148:151], v[180:183], a[88:91], a[148:151]
    v_fma_f32 v116, v116, v72, v80
    v_fma_f32 v117, v117, v73, v81
    v_mfma_f32_16x16x32_bf16 a[152:155], v[184:187], a[88:91], a[152:155]
    v_fma_f32 v118, v118, v74, v82
    v_fma_f32 v119, v119, v75, v83
    v_mfma_f32_16x16x32_bf16 a[156:159], v[188:191], a[88:91], a[156:159]
    v_cvt_pk_bf16_f32 v28, v112, v113
    s_waitcnt vmcnt(0)
    v_mfma_f32_16x16x32_bf16 a[144:147], v[192:195], a[92:95], a[144:147]
    v_cvt_pk_bf16_f32 v29, v114, v115
    v_cvt_pk_bf16_f32 v30, v116, v117
    v_mfma_f32_16x16x32_bf16 a[148:151], v[196:199], a[92:95], a[148:151]
    v_cvt_pk_bf16_f32 v31, v118, v119
    v_mfma_f32_16x16x32_bf16 a[152:155], v[200:203], a[92:95], a[152:155]
    global_store_dwordx4 v42, v[28:31], s[22:23] sc1
    v_mfma_f32_16x16x32_bf16 a[156:159], v[204:207], a[92:95], a[156:159]
    v_mfma_f32_16x16x32_bf16 a[144:147], v[208:211], v[88:91], a[144:147]
    v_mfma_f32_16x16x32_bf16 a[144:147], v[224:227], v[96:99], a[144:147]
    v_mfma_f32_16x16x32_bf16 a[144:147], v[240:243], v[104:107], a[144:147]
    v_mfma_f32_16x16x32_bf16 a[148:151], v[212:215], v[88:91], a[148:151]
    v_mfma_f32_16x16x32_bf16 a[148:151], v[228:231], v[96:99], a[148:151]
    v_mfma_f32_16x16x32_bf16 a[148:151], v[244:247], v[104:107], a[148:151]
    s_nop 4
    ds_write_b128 v4, a[144:147] offset:49152
    v_mfma_f32_16x16x32_bf16 a[152:155], v[216:219], v[88:91], a[152:155]
    v_mfma_f32_16x16x32_bf16 a[152:155], v[232:235], v[96:99], a[152:155]
    v_mfma_f32_16x16x32_bf16 a[152:155], v[248:251], v[104:107], a[152:155]
    ds_write_b128 v5, a[148:151] offset:49152
    v_mfma_f32_16x16x32_bf16 a[156:159], v[220:223], v[88:91], a[156:159]
    v_mfma_f32_16x16x32_bf16 a[156:159], v[236:239], v[96:99], a[156:159]
    v_mfma_f32_16x16x32_bf16 a[156:159], v[252:255], v[104:107], a[156:159]
    s_nop 3
    ds_write_b128 v6, a[152:155] offset:49152
    s_nop 2
    ds_write_b128 v7, a[156:159] offset:49152
    s_waitcnt lgkmcnt(0)
    s_barrier
    ds_read_b128 v[112:115], v41 offset:32768
    ds_read_b128 v[116:119], v41 offset:33024
    ds_read_b128 v[120:123], v41 offset:36864
    ds_read_b128 v[124:127], v41 offset:37120
    ds_read_b128 v[128:131], v41 offset:40960
    ds_read_b128 v[132:135], v41 offset:41216
    ds_read_b128 v[136:139], v41 offset:45056
    ds_read_b128 v[140:143], v41 offset:45312
    v_lshlrev_b32 v76, 16, v36
    v_and_b32 v77, 0xffff0000, v36
    v_lshlrev_b32 v78, 16, v37
    v_and_b32 v79, 0xffff0000, v37
    v_lshlrev_b32 v80, 16, v38
    v_and_b32 v81, 0xffff0000, v38
    v_lshlrev_b32 v82, 16, v39
    v_and_b32 v83, 0xffff0000, v39
    s_waitcnt lgkmcnt(5)
    v_pk_add_f32 v[112:113], v[112:113], v[120:121]
    v_pk_add_f32 v[114:115], v[114:115], v[122:123]
    s_waitcnt lgkmcnt(4)
    v_pk_add_f32 v[116:117], v[116:117], v[124:125]
    v_pk_add_f32 v[118:119], v[118:119], v[126:127]
    s_waitcnt lgkmcnt(1)
    v_pk_add_f32 v[128:129], v[128:129], v[136:137]
    v_pk_add_f32 v[130:131], v[130:131], v[138:139]
    s_waitcnt lgkmcnt(0)
    v_pk_add_f32 v[132:133], v[132:133], v[140:141]
    v_pk_add_f32 v[134:135], v[134:135], v[142:143]
    v_pk_add_f32 v[112:113], v[112:113], v[128:129]
    v_pk_add_f32 v[114:115], v[114:115], v[130:131]
    v_pk_add_f32 v[116:117], v[116:117], v[132:133]
    v_pk_add_f32 v[118:119], v[118:119], v[134:135]
    v_pk_fma_f32 v[112:113], v[112:113], v[68:69], v[76:77]
    v_pk_fma_f32 v[114:115], v[114:115], v[70:71], v[78:79]
    v_pk_fma_f32 v[116:117], v[116:117], v[72:73], v[80:81]
    v_pk_fma_f32 v[118:119], v[118:119], v[74:75], v[82:83]
    v_cvt_pk_bf16_f32 v28, v112, v113
    v_cvt_pk_bf16_f32 v29, v114, v115
    v_cvt_pk_bf16_f32 v30, v116, v117
    v_cvt_pk_bf16_f32 v31, v118, v119
    global_store_dwordx4 v43, v[28:31], s[22:23] sc1
L_end:
    s_endpgm
L_shared:
    s_cmp_lg_u32 s2, 0
    s_cbranch_scc1 L_epoch_s
    v_mov_b32 v24, 0
    v_mov_b32 v25, s52
    s_mov_b64 exec, 1
    global_store_dword v24, v25, s[26:27] sc1
    s_mov_b64 exec, -1
L_epoch_s:
    s_add_u32 m0, s71, 4096
    s_add_u32 s63, s72, 49152
    buffer_load_dwordx4 v42, s[32:35], s63 offen offset:0 lds
    v_add_f32 v37, 0x00000000, v23
    v_mul_f32 v36, 0x3d000000, v37
    v_mul_f32 v24, v52, v36
    v_add_f32 v25, v24, v36
    v_add_f32 v26, v25, v36
    v_add_f32 v27, v26, v36
    v_cos_f32 v28, v24
    v_sin_f32 v32, v24
    v_cos_f32 v29, v25
    v_sin_f32 v33, v25
    buffer_load_dwordx4 v43, s[32:35], s63 offen offset:1024 lds
    v_cos_f32 v30, v26
    v_sin_f32 v34, v26
    v_cos_f32 v31, v27
    v_sin_f32 v35, v27
    v_cvt_pk_bf16_f32 v180, v28, v32
    v_cvt_pk_bf16_f32 v176, -v32, v28
    v_cvt_pk_bf16_f32 v181, v29, v33
    v_cvt_pk_bf16_f32 v177, -v33, v29
    v_cvt_pk_bf16_f32 v182, v30, v34
    v_cvt_pk_bf16_f32 v178, -v34, v30
    s_add_u32 m0, s71, 6144
    s_add_u32 s63, s72, 65536
    buffer_load_dwordx4 v42, s[32:35], s63 offen offset:0 lds
    v_cvt_pk_bf16_f32 v183, v31, v35
    v_cvt_pk_bf16_f32 v179, -v35, v31
    v_add_f32 v24, 0x41800000, v52
    v_mul_f32 v24, v24, v36
    v_add_f32 v25, v24, v36
    v_add_f32 v26, v25, v36
    v_add_f32 v27, v26, v36
    v_cos_f32 v28, v24
    v_sin_f32 v32, v24
    v_cos_f32 v29, v25
    v_sin_f32 v33, v25
    buffer_load_dwordx4 v43, s[32:35], s63 offen offset:1024 lds
    v_cos_f32 v30, v26
    v_sin_f32 v34, v26
    v_cos_f32 v31, v27
    v_sin_f32 v35, v27
    v_cvt_pk_bf16_f32 v172, v28, v32
    v_cvt_pk_bf16_f32 v168, -v32, v28
    v_cvt_pk_bf16_f32 v173, v29, v33
    v_cvt_pk_bf16_f32 v169, -v33, v29
    v_cvt_pk_bf16_f32 v174, v30, v34
    v_cvt_pk_bf16_f32 v170, -v34, v30
    s_add_u32 m0, s70, 0
    s_add_u32 s63, s72, 98304
    buffer_load_dwordx4 v42, s[32:35], s63 offen offset:0 lds
    v_cvt_pk_bf16_f32 v175, v31, v35
    v_cvt_pk_bf16_f32 v171, -v35, v31
    s_and_b32 s57, s53, 1
    s_lshl_b32 s57, s57, 5
    s_add_u32 s57, s57, s54
    v_cvt_f32_u32 v38, s57
    v_fmac_f32 v38, 2.0, v52
    v_mul_f32 v39, 0x3a000000, v37
    v_mul_f32 v36, 0x3a800000, v37
    v_mul_f32 v24, v38, v39
    v_add_f32 v25, v24, v36
    v_add_f32 v26, v25, v36
    v_add_f32 v27, v26, v36
    v_cos_f32 v148, v24
    buffer_load_dwordx4 v43, s[32:35], s63 offen offset:1024 lds
    v_sin_f32 v140, v24
    v_cos_f32 v149, v25
    v_sin_f32 v141, v25
    v_cos_f32 v150, v26
    v_sin_f32 v142, v26
    v_cos_f32 v151, v27
    v_sin_f32 v143, v27
    s_add_u32 m0, s70, 2048
    s_add_u32 s63, s72, 114688
    buffer_load_dwordx4 v42, s[32:35], s63 offen offset:0 lds
    v_add_f32 v37, 0x41800000, v23
    v_mul_f32 v36, 0x3d000000, v37
    v_mul_f32 v24, v52, v36
    v_add_f32 v25, v24, v36
    v_add_f32 v26, v25, v36
    v_add_f32 v27, v26, v36
    v_cos_f32 v28, v24
    v_sin_f32 v32, v24
    v_cos_f32 v29, v25
    v_sin_f32 v33, v25
    buffer_load_dwordx4 v43, s[32:35], s63 offen offset:1024 lds
    v_cos_f32 v30, v26
    v_sin_f32 v34, v26
    v_cos_f32 v31, v27
    v_sin_f32 v35, v27
    v_cvt_pk_bf16_f32 v164, v28, v32
    v_cvt_pk_bf16_f32 v160, -v32, v28
    v_cvt_pk_bf16_f32 v165, v29, v33
    v_cvt_pk_bf16_f32 v161, -v33, v29
    v_cvt_pk_bf16_f32 v166, v30, v34
    v_cvt_pk_bf16_f32 v162, -v34, v30
    s_add_u32 m0, s70, 4096
    s_add_u32 s63, s73, 147456
    buffer_load_dwordx4 v42, s[32:35], s63 offen offset:0 lds
    v_cvt_pk_bf16_f32 v167, v31, v35
    v_cvt_pk_bf16_f32 v163, -v35, v31
    v_add_f32 v24, 0x41800000, v52
    v_mul_f32 v24, v24, v36
    v_add_f32 v25, v24, v36
    v_add_f32 v26, v25, v36
    v_add_f32 v27, v26, v36
    v_cos_f32 v28, v24
    v_sin_f32 v32, v24
    v_cos_f32 v29, v25
    v_sin_f32 v33, v25
    buffer_load_dwordx4 v43, s[32:35], s63 offen offset:1024 lds
    v_cos_f32 v30, v26
    v_sin_f32 v34, v26
    v_cos_f32 v31, v27
    v_sin_f32 v35, v27
    v_cvt_pk_bf16_f32 v156, v28, v32
    v_cvt_pk_bf16_f32 v152, -v32, v28
    v_cvt_pk_bf16_f32 v157, v29, v33
    v_cvt_pk_bf16_f32 v153, -v33, v29
    v_cvt_pk_bf16_f32 v158, v30, v34
    v_cvt_pk_bf16_f32 v154, -v34, v30
    s_add_u32 m0, s70, 6144
    s_add_u32 s63, s73, 163840
    buffer_load_dwordx4 v42, s[32:35], s63 offen offset:0 lds
    v_cvt_pk_bf16_f32 v159, v31, v35
    v_cvt_pk_bf16_f32 v155, -v35, v31
    s_and_b32 s57, s53, 1
    s_lshl_b32 s57, s57, 5
    s_add_u32 s57, s57, s54
    v_cvt_f32_u32 v38, s57
    v_fmac_f32 v38, 2.0, v52
    v_mul_f32 v39, 0x3a000000, v37
    v_mul_f32 v36, 0x3a800000, v37
    v_mul_f32 v24, v38, v39
    v_add_f32 v25, v24, v36
    v_add_f32 v26, v25, v36
    v_add_f32 v27, v26, v36
    v_cos_f32 v144, v24
    buffer_load_dwordx4 v43, s[32:35], s63 offen offset:1024 lds
    v_sin_f32 v136, v24
    v_cos_f32 v145, v25
    v_sin_f32 v137, v25
    v_cos_f32 v146, v26
    v_sin_f32 v138, v26
    v_cos_f32 v147, v27
    v_sin_f32 v139, v27
    s_add_u32 m0, s70, 8192
    s_add_u32 s63, s73, 180224
    buffer_load_dwordx4 v42, s[32:35], s63 offen offset:0 lds
    s_and_b32 s57, s2, 127
    s_lshl_b32 s58, s57, 14
    s_lshl_b32 s59, s53, 12
    s_add_u32 s58, s58, s59
    s_add_u32 s58, s58, 2097152
    v_add_u32 v16, s58, v20
    s_lshr_b32 s59, s53, 1
    s_or_b32 s76, s57, s59
    s_bfe_u32 s58, s2, 0x30004
    s_lshl_b32 s58, s58, 3
    s_and_b32 s60, s2, 7
    s_add_u32 s58, s58, s60
    s_lshl_b32 s58, s58, 7
    s_and_b32 s60, s2, 8
    buffer_load_dwordx4 v43, s[32:35], s63 offen offset:1024 lds
    s_lshl_b32 s60, s60, 3
    s_add_u32 s58, s58, s60
    s_cmp_eq_u32 s76, 0
    s_cselect_b32 s58, 8192, s58
    s_lshl_b32 s59, s59, 5
    s_add_u32 s58, s58, s59
    s_and_b32 s59, s53, 1
    s_lshl_b32 s60, s54, 4
    s_add_u32 s60, s60, s59
    s_mul_i32 s60, s60, 66560
    s_add_u32 s58, s58, s60
    s_add_u32 s58, s58, 20447232
    v_lshrrev_b32 v24, 1, v18
    v_lshl_add_u32 v25, v19, 4, v24
    s_add_u32 m0, s70, 10240
    s_add_u32 s63, s73, 196608
    buffer_load_dwordx4 v42, s[32:35], s63 offen offset:0 lds
    v_mul_u32_u24 v25, 8320, v25
    v_and_b32 v26, 1, v18
    v_lshl_add_u32 v25, v26, 4, v25
    v_add_u32 v8, s58, v25
    v_add_u32 v9, 532480, v8
    s_lshl_b32 s58, s53, 9
    v_lshrrev_b32 v27, 1, v19
    v_lshl_add_u32 v27, v27, 4, v18
    v_lshl_add_u32 v27, v27, 4, s58
    v_and_b32 v28, 1, v19
    v_lshl_add_u32 v62, v28, 3, v27
    s_lshl_b32 s58, s53, 11
    v_add_u32 v63, s58, v20
    v_and_b32 v27, 3, v24
    buffer_load_dwordx4 v43, s[32:35], s63 offen offset:1024 lds
    v_lshl_add_u32 v27, v27, 2, v26
    v_lshl_add_u32 v27, v19, 4, v27
    v_lshrrev_b32 v28, 3, v18
    v_lshlrev_b32 v28, 11, v28
    v_lshl_add_u32 v27, v27, 4, v28
    s_lshl_b32 s59, s59, 10
    s_lshr_b32 s60, s53, 1
    s_lshl_b32 s60, s60, 5
    s_add_u32 s59, s59, s60
    v_add_u32 v1, s59, v27
    v_lshrrev_b32 v27, 2, v18
    v_lshl_add_u32 v27, v19, 4, v27
    v_lshlrev_b32 v27, 14, v27
    v_and_b32 v28, 3, v18
    s_add_u32 m0, s70, 12288
    s_add_u32 s63, s73, 229376
    buffer_load_dwordx4 v42, s[32:35], s63 offen offset:0 lds
    v_lshl_add_u32 v27, v28, 4, v27
    s_lshl_b32 s58, s53, 16
    s_lshl_b32 s59, s54, 13
    s_add_u32 s58, s58, s59
    s_lshl_b32 s57, s57, 6
    s_add_u32 s58, s58, s57
    s_add_u32 s58, s58, 6291456
    v_add_u32 v2, s58, v27
    v_add_u32 v3, 1048576, v2
    v_add_u32 v53, 4096, v20
    v_add_u32 v54, 8192, v20
    v_add_u32 v55, 12288, v20
    s_mul_i32 s77, s54, 0x80008000
    s_cmp_lg_u32 s76, 0
    s_cbranch_scc1 L_zaddr_s
    s_and_b32 s59, s53, 1
    s_lshl_b32 s59, s59, 4
    v_add_u32 v24, s59, v18
    v_lshlrev_b32 v25, 10, v19
    v_lshl_add_u32 v56, v24, 3, v25
    v_lshl_add_u32 v24, v24, 1, s54
    v_lshl_add_u32 v24, v19, 8, v24
    v_sub_u32 v25, 2048, v24
    v_and_b32 v25, 2046, v25
    v_lshlrev_b32 v92, 2, v25
    v_sub_u32 v25, 1984, v24
    v_and_b32 v25, 2046, v25
    v_lshlrev_b32 v93, 2, v25
    v_sub_u32 v25, 1920, v24
    v_and_b32 v25, 2046, v25
    v_lshlrev_b32 v94, 2, v25
    v_sub_u32 v25, 1856, v24
    v_and_b32 v25, 2046, v25
    v_lshlrev_b32 v95, 2, v25
    v_sub_u32 v25, 1024, v24
    v_and_b32 v25, 2046, v25
    v_lshlrev_b32 v104, 2, v25
    v_sub_u32 v25, 960, v24
    v_and_b32 v25, 2046, v25
    v_lshlrev_b32 v105, 2, v25
    v_sub_u32 v25, 896, v24
    v_and_b32 v25, 2046, v25
    v_lshlrev_b32 v106, 2, v25
    v_sub_u32 v25, 832, v24
    v_and_b32 v25, 2046, v25
    v_lshlrev_b32 v107, 2, v25
L_zaddr_s:
    buffer_load_dwordx4 v43, s[32:35], s63 offen offset:1024 lds
    s_add_u32 m0, s70, 14336
    s_add_u32 s63, s73, 245760
    buffer_load_dwordx4 v42, s[32:35], s63 offen offset:0 lds
    buffer_load_dwordx4 v43, s[32:35], s63 offen offset:1024 lds
    s_add_u32 m0, s70, 16384
    s_add_u32 s63, s73, 278528
    buffer_load_dwordx4 v42, s[32:35], s63 offen offset:0 lds
    buffer_load_dwordx4 v43, s[32:35], s63 offen offset:1024 lds
    s_add_u32 m0, s70, 18432
    s_add_u32 s63, s73, 294912
    buffer_load_dwordx4 v42, s[32:35], s63 offen offset:0 lds
    buffer_load_dwordx4 v43, s[32:35], s63 offen offset:1024 lds
    s_waitcnt vmcnt(26)
    v_lshlrev_b32 v60, 16, v60
    v_mul_f32 v32, 0xbfb8aa3b, v60
    v_exp_f32 v32, v32
    s_nop 0
    v_add_f32 v32, 1.0, v32
    v_rcp_f32 v32, v32
    s_nop 0
    v_mul_f32 v60, v60, v32
    v_cvt_pk_bf16_f32 v60, v60, v60
    v_and_b32 v60, 0xffff0000, v60
    s_waitcnt vmcnt(24)
    v_lshlrev_b32 v61, 16, v61
    v_mul_f32 v32, 0xbfb8aa3b, v61
    v_exp_f32 v32, v32
    s_nop 0
    v_add_f32 v32, 1.0, v32
    v_rcp_f32 v32, v32
    s_nop 0
    v_mul_f32 v61, v61, v32
    v_cvt_pk_bf16_f32 v61, v61, v61
    v_and_b32 v61, 0xffff0000, v61
    v_lshlrev_b32 v24, 16, v228
    v_and_b32 v25, 0xffff0000, v228
    v_lshlrev_b32 v26, 16, v229
    v_and_b32 v27, 0xffff0000, v229
    v_lshlrev_b32 v28, 16, v230
    v_and_b32 v29, 0xffff0000, v230
    v_lshlrev_b32 v30, 16, v231
    v_and_b32 v31, 0xffff0000, v231
    v_lshlrev_b32 v32, 16, v224
    v_and_b32 v33, 0xffff0000, v224
    v_lshlrev_b32 v34, 16, v225
    v_and_b32 v35, 0xffff0000, v225
    v_lshlrev_b32 v36, 16, v226
    v_and_b32 v37, 0xffff0000, v226
    v_lshlrev_b32 v38, 16, v227
    v_and_b32 v39, 0xffff0000, v227
    v_pk_mul_f32 v[24:25], v[24:25], v[60:61] op_sel_hi:[1,0]
    v_pk_mul_f32 v[26:27], v[26:27], v[60:61] op_sel_hi:[1,0]
    v_pk_mul_f32 v[28:29], v[28:29], v[60:61] op_sel_hi:[1,0]
    v_pk_mul_f32 v[30:31], v[30:31], v[60:61] op_sel_hi:[1,0]
    v_pk_fma_f32 v[24:25], v[32:33], v[60:61], v[24:25] op_sel:[0,1,0] op_sel_hi:[1,1,1]
    v_pk_fma_f32 v[26:27], v[34:35], v[60:61], v[26:27] op_sel:[0,1,0] op_sel_hi:[1,1,1]
    v_pk_fma_f32 v[28:29], v[36:37], v[60:61], v[28:29] op_sel:[0,1,0] op_sel_hi:[1,1,1]
    v_pk_fma_f32 v[30:31], v[38:39], v[60:61], v[30:31] op_sel:[0,1,0] op_sel_hi:[1,1,1]
    s_nop 0
    v_permlane32_swap_b32 v24, v28
    v_permlane32_swap_b32 v25, v29
    v_permlane32_swap_b32 v26, v30
    v_permlane32_swap_b32 v27, v31
    v_pk_add_f32 v[24:25], v[24:25], v[28:29]
    v_pk_add_f32 v[26:27], v[26:27], v[30:31]
    s_nop 1
    v_permlane16_swap_b32 v24, v26
    v_permlane16_swap_b32 v25, v27
    v_pk_add_f32 v[24:25], v[24:25], v[26:27]
    s_nop 1
    v_add_f32_dpp v24, v24, v24 row_ror:2 row_mask:0xf bank_mask:0xf
    v_add_f32_dpp v25, v25, v25 row_ror:2 row_mask:0xf bank_mask:0xf
    s_nop 0
    v_add_f32_dpp v24, v24, v24 row_ror:4 row_mask:0xf bank_mask:0xf
    v_add_f32_dpp v25, v25, v25 row_ror:4 row_mask:0xf bank_mask:0xf
    s_nop 0
    v_add_f32_dpp v24, v24, v24 row_ror:8 row_mask:0xf bank_mask:0xf
    v_add_f32_dpp v25, v25, v25 row_ror:8 row_mask:0xf bank_mask:0xf
    s_mov_b64 exec, s[64:65]
    ds_write_b64 v21, v[24:25] offset:22784
    s_mov_b64 exec, -1
    s_waitcnt lgkmcnt(0)
    s_barrier
    s_cmp_lg_u32 s53, 1
    s_cbranch_scc1 L_pubM_s
    ds_read_b128 v[24:27], v20 offset:22784
    ds_read_b128 v[28:31], v20 offset:22848
    ds_read_b128 v[32:35], v20 offset:22912
    ds_read_b128 v[36:39], v20 offset:22976
    s_waitcnt lgkmcnt(2)
    v_pk_add_f32 v[24:25], v[24:25], v[28:29]
    v_pk_add_f32 v[26:27], v[26:27], v[30:31]
    s_waitcnt lgkmcnt(0)
    v_pk_add_f32 v[32:33], v[32:33], v[36:37]
    v_pk_add_f32 v[34:35], v[34:35], v[38:39]
    v_pk_add_f32 v[24:25], v[24:25], v[32:33]
    v_pk_add_f32 v[26:27], v[26:27], v[34:35]
    v_mov_b32 v117, s52
    v_mov_b32 v119, s52
    v_cvt_pk_bf16_f32 v116, v24, v25
    v_cvt_pk_bf16_f32 v118, v26, v27
L_pubM_s:
    s_waitcnt lgkmcnt(0)
    global_load_dwordx4 v[120:123], v16, s[26:27] offset:0 sc1
    global_load_dwordx4 v[124:127], v16, s[26:27] offset:1024 sc1
    global_load_dwordx4 v[128:131], v16, s[26:27] offset:2048 sc1
    global_load_dwordx4 v[132:135], v16, s[26:27] offset:3072 sc1
    s_cmp_lg_u32 s53, 1
    s_cbranch_scc1 L_pubM2_s
    s_mov_b64 exec, 15
    global_store_dwordx4 v58, v[116:119], s[26:27] sc1
    s_mov_b64 exec, -1
L_pubM2_s:
    s_waitcnt vmcnt(0)
L_B_s:
    v_max3_u32 v24, v120, v121, v122
    v_max3_u32 v24, v24, v123, v124
    v_max3_u32 v24, v24, v125, v126
    v_max3_u32 v24, v24, v127, v128
    v_max3_u32 v24, v24, v129, v130
    v_max3_u32 v24, v24, v131, v132
    v_max3_u32 v24, v24, v133, v134
    v_max_u32 v24, v24, v135
    v_cmp_eq_u32 vcc, -1, v24
    s_cbranch_vccnz L_B_retry_s
L_B_ok_s:
    s_barrier
    global_load_dwordx4 v[4:7], v8, s[26:27] sc1
    global_load_dwordx4 v[64:67], v9, s[26:27] sc1
    s_cmp_lg_u32 s76, 0
    s_cbranch_scc1 L_bq_s
    global_load_dwordx4 v[108:111], v8, s[26:27] offset:32 sc1
    global_load_dwordx4 v[112:115], v9, s[26:27] offset:32 sc1
L_bq_s:
    s_add_u32 s63, s88, 0
    buffer_load_dwordx4 a[0:3], v20, s[36:39], s63 offen sc1
    v_mfma_f32_16x16x32_bf16 v[252:255], v[120:123], v[220:223], 0
    v_xor_b32 v128, s77, v128
    v_xor_b32 v129, s77, v129
    v_mfma_f32_16x16x32_bf16 v[244:247], v[120:123], v[216:219], 0
    v_xor_b32 v130, s77, v130
    v_xor_b32 v131, s77, v131
    v_mfma_f32_16x16x32_bf16 v[248:251], v[120:123], v[204:207], 0
    v_xor_b32 v132, s77, v132
    v_xor_b32 v133, s77, v133
    v_mfma_f32_16x16x32_bf16 v[240:243], v[120:123], v[200:203], 0
    v_xor_b32 v134, s77, v134
    v_xor_b32 v135, s77, v135
    v_mfma_f32_16x16x32_bf16 v[252:255], v[124:127], v[212:215], v[252:255]
    buffer_load_dwordx4 a[12:15], v53, s[36:39], s63 offen sc1
    v_mfma_f32_16x16x32_bf16 v[244:247], v[124:127], v[208:211], v[244:247]
    v_mfma_f32_16x16x32_bf16 v[248:251], v[124:127], v[196:199], v[248:251]
    v_mfma_f32_16x16x32_bf16 v[240:243], v[124:127], v[192:195], v[240:243]
    v_mfma_f32_16x16x32_bf16 v[252:255], v[128:131], v[220:223], v[252:255]
    v_mfma_f32_16x16x32_bf16 v[244:247], v[128:131], v[216:219], v[244:247]
    v_mfma_f32_16x16x32_bf16 v[248:251], v[128:131], v[204:207], v[248:251]
    v_mfma_f32_16x16x32_bf16 v[240:243], v[128:131], v[200:203], v[240:243]
    buffer_load_dwordx4 a[24:27], v54, s[36:39], s63 offen sc1
    v_mfma_f32_16x16x32_bf16 v[252:255], v[132:135], v[212:215], v[252:255]
    v_mfma_f32_16x16x32_bf16 v[244:247], v[132:135], v[208:211], v[244:247]
    v_mfma_f32_16x16x32_bf16 v[248:251], v[132:135], v[196:199], v[248:251]
    v_mfma_f32_16x16x32_bf16 v[240:243], v[132:135], v[192:195], v[240:243]
    s_nop 4
    v_pk_mul_f32 v[236:237], v[252:253], v[188:189]
    v_pk_mul_f32 v[228:229], v[244:245], v[188:189]
    v_pk_mul_f32 v[238:239], v[254:255], v[188:189]
    v_pk_mul_f32 v[230:231], v[246:247], v[188:189]
    v_pk_mul_f32 v[232:233], v[248:249], v[190:191]
    v_pk_mul_f32 v[224:225], v[240:241], v[190:191]
    v_pk_mul_f32 v[234:235], v[250:251], v[190:191]
    v_pk_mul_f32 v[226:227], v[242:243], v[190:191]
    v_pk_fma_f32 v[236:237], v[244:245], v[184:185], v[236:237]
    buffer_load_dwordx4 a[36:39], v55, s[36:39], s63 offen sc1
    v_pk_fma_f32 v[228:229], v[252:253], v[184:185], v[228:229] neg_lo:[0,1,0] neg_hi:[0,1,0]
    v_pk_fma_f32 v[238:239], v[246:247], v[184:185], v[238:239]
    v_pk_fma_f32 v[230:231], v[254:255], v[184:185], v[230:231] neg_lo:[0,1,0] neg_hi:[0,1,0]
    v_pk_fma_f32 v[232:233], v[240:241], v[186:187], v[232:233]
    v_pk_fma_f32 v[224:225], v[248:249], v[186:187], v[224:225] neg_lo:[0,1,0] neg_hi:[0,1,0]
    v_pk_fma_f32 v[234:235], v[242:243], v[186:187], v[234:235]
    v_pk_fma_f32 v[226:227], v[250:251], v[186:187], v[226:227] neg_lo:[0,1,0] neg_hi:[0,1,0]
    v_cvt_pk_bf16_f32 v24, v236, v228
    v_cvt_pk_bf16_f32 v25, v237, v229
    v_cvt_pk_bf16_f32 v26, v238, v230
    v_cvt_pk_bf16_f32 v27, v239, v231
    v_cvt_pk_bf16_f32 v28, v232, v224
    v_cvt_pk_bf16_f32 v29, v233, v225
    v_cvt_pk_bf16_f32 v30, v234, v226
    v_cvt_pk_bf16_f32 v31, v235, v227
    ds_write_b64 v62, v[24:25] offset:0
    ds_write_b64 v62, v[26:27] offset:4096
    ds_write_b64 v62, v[28:29] offset:2048
    ds_write_b64 v62, v[30:31] offset:6144
    s_waitcnt lgkmcnt(0)
    s_barrier
    ds_read_b128 v[120:123], v63 offset:0
    ds_read_b128 v[124:127], v63 offset:1024
    s_waitcnt lgkmcnt(1)
    v_mfma_f32_16x16x32_bf16 v[252:255], v[180:183], v[120:123], 0
    s_add_u32 s63, s89, 0
    buffer_load_dwordx4 a[4:7], v20, s[36:39], s63 offen sc1
    s_waitcnt vmcnt(6)
    v_lshlrev_b32 v68, 16, v4
    v_and_b32 v84, 0xffff0000, v4
    v_mfma_f32_16x16x32_bf16 v[244:247], v[176:179], v[120:123], 0
    v_lshlrev_b32 v69, 16, v5
    v_and_b32 v85, 0xffff0000, v5
    v_mfma_f32_16x16x32_bf16 v[248:251], v[164:167], v[120:123], 0
    v_lshlrev_b32 v70, 16, v6
    v_and_b32 v86, 0xffff0000, v6
    v_mfma_f32_16x16x32_bf16 v[240:243], v[160:163], v[120:123], 0
    v_lshlrev_b32 v71, 16, v7
    v_and_b32 v87, 0xffff0000, v7
    s_waitcnt lgkmcnt(0)
    v_mfma_f32_16x16x32_bf16 v[252:255], v[172:175], v[124:127], v[252:255]
    s_waitcnt vmcnt(5)
    v_lshlrev_b32 v80, 16, v64
    buffer_load_dwordx4 a[16:19], v53, s[36:39], s63 offen sc1
    v_and_b32 v88, 0xffff0000, v64
    v_mfma_f32_16x16x32_bf16 v[244:247], v[168:171], v[124:127], v[244:247]
    v_lshlrev_b32 v81, 16, v65
    v_and_b32 v89, 0xffff0000, v65
    v_mfma_f32_16x16x32_bf16 v[248:251], v[156:159], v[124:127], v[248:251]
    v_lshlrev_b32 v82, 16, v66
    v_and_b32 v90, 0xffff0000, v66
    v_mfma_f32_16x16x32_bf16 v[240:243], v[152:155], v[124:127], v[240:243]
    v_lshlrev_b32 v83, 16, v67
    v_and_b32 v91, 0xffff0000, v67
    v_pk_mul_f32 v[236:237], v[252:253], v[68:69]
    v_pk_mul_f32 v[228:229], v[244:245], v[68:69] neg_lo:[0,1] neg_hi:[0,1]
    v_pk_mul_f32 v[238:239], v[254:255], v[70:71]
    v_pk_mul_f32 v[230:231], v[246:247], v[70:71] neg_lo:[0,1] neg_hi:[0,1]
    v_pk_mul_f32 v[232:233], v[248:249], v[80:81]
    s_nop 0
    v_pk_mul_f32 v[224:225], v[240:241], v[80:81] neg_lo:[0,1] neg_hi:[0,1]
    buffer_load_dwordx4 a[28:31], v54, s[36:39], s63 offen sc1
    v_pk_mul_f32 v[234:235], v[250:251], v[82:83]
    v_pk_mul_f32 v[226:227], v[242:243], v[82:83] neg_lo:[0,1] neg_hi:[0,1]
    v_pk_fma_f32 v[236:237], v[244:245], v[84:85], v[236:237] neg_lo:[0,1,0] neg_hi:[0,1,0]
    v_pk_fma_f32 v[228:229], v[252:253], v[84:85], v[228:229] neg_lo:[0,1,0] neg_hi:[0,1,0]
    v_pk_fma_f32 v[238:239], v[246:247], v[86:87], v[238:239] neg_lo:[0,1,0] neg_hi:[0,1,0]
    v_pk_fma_f32 v[230:231], v[254:255], v[86:87], v[230:231] neg_lo:[0,1,0] neg_hi:[0,1,0]
    v_pk_fma_f32 v[232:233], v[240:241], v[88:89], v[232:233] neg_lo:[0,1,0] neg_hi:[0,1,0]
    v_pk_fma_f32 v[224:225], v[248:249], v[88:89], v[224:225] neg_lo:[0,1,0] neg_hi:[0,1,0]
    v_pk_fma_f32 v[234:235], v[242:243], v[90:91], v[234:235] neg_lo:[0,1,0] neg_hi:[0,1,0]
    v_pk_fma_f32 v[226:227], v[250:251], v[90:91], v[226:227] neg_lo:[0,1,0] neg_hi:[0,1,0]
    s_and_b32 s57, s2, 127
    s_cbranch_scc1 L_nospec_s
    s_cmp_lg_u32 s76, 0
    s_cbranch_scc1 L_spec_w_s
    v_add_u32 v32, 18432, v56
    ds_write2_b32 v32, v252, v244 offset0:0 offset1:1
    v_add_u32 v32, 18688, v56
    ds_write2_b32 v32, v253, v245 offset0:0 offset1:1
    v_add_u32 v32, 18944, v56
    ds_write2_b32 v32, v254, v246 offset0:0 offset1:1
    v_add_u32 v32, 19200, v56
    ds_write2_b32 v32, v255, v247 offset0:0 offset1:1
    v_add_u32 v32, 22528, v56
    ds_write2_b32 v32, v248, v240 offset0:0 offset1:1
    v_add_u32 v32, 22784, v56
    ds_write2_b32 v32, v249, v241 offset0:0 offset1:1
    v_add_u32 v32, 23040, v56
    ds_write2_b32 v32, v250, v242 offset0:0 offset1:1
    v_add_u32 v32, 23296, v56
    ds_write2_b32 v32, v251, v243 offset0:0 offset1:1
    s_waitcnt vmcnt(7)
    v_lshlrev_b32 v220, 16, v108
    v_and_b32 v212, 0xffff0000, v108
    v_lshlrev_b32 v221, 16, v109
    v_and_b32 v213, 0xffff0000, v109
    v_lshlrev_b32 v222, 16, v110
    v_and_b32 v214, 0xffff0000, v110
    v_lshlrev_b32 v223, 16, v111
    v_and_b32 v215, 0xffff0000, v111
    s_waitcnt vmcnt(7)
    v_lshlrev_b32 v216, 16, v112
    v_and_b32 v208, 0xffff0000, v112
    v_lshlrev_b32 v217, 16, v113
    v_and_b32 v209, 0xffff0000, v113
    v_lshlrev_b32 v218, 16, v114
    v_and_b32 v210, 0xffff0000, v114
    v_lshlrev_b32 v219, 16, v115
    v_and_b32 v211, 0xffff0000, v115
L_spec_w_s:
    s_waitcnt lgkmcnt(0)
    s_barrier
    s_cmp_lg_u32 s76, 0
    s_cbranch_scc1 L_spec_r_s
    ds_read_b64 v[24:25], v92 offset:18432
    ds_read_b64 v[26:27], v93 offset:18432
    ds_read_b64 v[28:29], v94 offset:18432
    ds_read_b64 v[30:31], v95 offset:18432
    ds_read_b64 v[32:33], v104 offset:18432
    ds_read_b64 v[34:35], v105 offset:18432
    ds_read_b64 v[36:37], v106 offset:18432
    ds_read_b64 v[38:39], v107 offset:18432
    s_waitcnt lgkmcnt(7)
    v_fmac_f32 v236, v220, v24
    v_fmac_f32 v228, v220, v25
    v_fmac_f32 v236, v212, v25
    v_fma_f32 v228, -v212, v24, v228
    s_waitcnt lgkmcnt(6)
    v_fmac_f32 v237, v221, v26
    v_fmac_f32 v229, v221, v27
    v_fmac_f32 v237, v213, v27
    v_fma_f32 v229, -v213, v26, v229
    s_waitcnt lgkmcnt(5)
    v_fmac_f32 v238, v222, v28
    v_fmac_f32 v230, v222, v29
    v_fmac_f32 v238, v214, v29
    v_fma_f32 v230, -v214, v28, v230
    s_waitcnt lgkmcnt(4)
    v_fmac_f32 v239, v223, v30
    v_fmac_f32 v231, v223, v31
    v_fmac_f32 v239, v215, v31
    v_fma_f32 v231, -v215, v30, v231
    s_waitcnt lgkmcnt(3)
    v_fmac_f32 v232, v216, v32
    v_fmac_f32 v224, v216, v33
    v_fmac_f32 v232, v208, v33
    v_fma_f32 v224, -v208, v32, v224
    s_waitcnt lgkmcnt(2)
    v_fmac_f32 v233, v217, v34
    v_fmac_f32 v225, v217, v35
    v_fmac_f32 v233, v209, v35
    v_fma_f32 v225, -v209, v34, v225
    s_waitcnt lgkmcnt(1)
    v_fmac_f32 v234, v218, v36
    v_fmac_f32 v226, v218, v37
    v_fmac_f32 v234, v210, v37
    v_fma_f32 v226, -v210, v36, v226
    s_waitcnt lgkmcnt(0)
    v_fmac_f32 v235, v219, v38
    v_fmac_f32 v227, v219, v39
    v_fmac_f32 v235, v211, v39
    v_fma_f32 v227, -v211, v38, v227
L_spec_r_s:
L_nospec_s:
    buffer_load_dwordx4 a[40:43], v55, s[36:39], s63 offen sc1
    v_cvt_pk_bf16_f32 v120, v236, v228
    v_cvt_pk_bf16_f32 v121, v237, v229
    v_cvt_pk_bf16_f32 v122, v238, v230
    v_cvt_pk_bf16_f32 v123, v239, v231
    v_cvt_pk_bf16_f32 v124, v232, v224
    v_cvt_pk_bf16_f32 v125, v233, v225
    v_cvt_pk_bf16_f32 v126, v234, v226
    v_cvt_pk_bf16_f32 v127, v235, v227
    v_mfma_f32_16x16x32_bf16 v[252:255], v[120:123], v[180:183], 0
    v_mfma_f32_16x16x32_bf16 v[244:247], v[120:123], v[176:179], 0
    v_mfma_f32_16x16x32_bf16 v[248:251], v[120:123], v[164:167], 0
    v_mfma_f32_16x16x32_bf16 v[240:243], v[120:123], v[160:163], 0
    v_mfma_f32_16x16x32_bf16 v[252:255], v[124:127], v[172:175], v[252:255]
    s_add_u32 s63, s90, 0
    buffer_load_dwordx4 a[8:11], v20, s[36:39], s63 offen sc1
    v_mfma_f32_16x16x32_bf16 v[244:247], v[124:127], v[168:171], v[244:247]
    v_mfma_f32_16x16x32_bf16 v[248:251], v[124:127], v[156:159], v[248:251]
    v_mfma_f32_16x16x32_bf16 v[240:243], v[124:127], v[152:155], v[240:243]
    s_nop 2
    v_pk_mul_f32 v[236:237], v[252:253], v[148:149]
    s_nop 1
    v_pk_mul_f32 v[228:229], v[244:245], v[148:149]
    v_pk_mul_f32 v[238:239], v[254:255], v[150:151]
    v_pk_mul_f32 v[230:231], v[246:247], v[150:151]
    v_pk_mul_f32 v[232:233], v[248:249], v[144:145]
    v_pk_mul_f32 v[224:225], v[240:241], v[144:145]
    v_pk_mul_f32 v[234:235], v[250:251], v[146:147]
    v_pk_mul_f32 v[226:227], v[242:243], v[146:147]
    v_pk_fma_f32 v[236:237], v[244:245], v[140:141], v[236:237]
    v_pk_fma_f32 v[228:229], v[252:253], v[140:141], v[228:229] neg_lo:[0,1,0] neg_hi:[0,1,0]
    v_pk_fma_f32 v[238:239], v[246:247], v[142:143], v[238:239]
    v_pk_fma_f32 v[230:231], v[254:255], v[142:143], v[230:231] neg_lo:[0,1,0] neg_hi:[0,1,0]
    v_pk_fma_f32 v[232:233], v[240:241], v[136:137], v[232:233]
    buffer_load_dwordx4 a[20:23], v53, s[36:39], s63 offen sc1
    v_pk_fma_f32 v[224:225], v[248:249], v[136:137], v[224:225] neg_lo:[0,1,0] neg_hi:[0,1,0]
    v_pk_fma_f32 v[234:235], v[242:243], v[138:139], v[234:235]
    v_pk_fma_f32 v[226:227], v[250:251], v[138:139], v[226:227] neg_lo:[0,1,0] neg_hi:[0,1,0]
    v_cvt_pk_bf16_f32 v24, v236, v228
    v_cvt_pk_bf16_f32 v25, v237, v229
    v_cvt_pk_bf16_f32 v26, v238, v230
    v_cvt_pk_bf16_f32 v27, v239, v231
    v_cvt_pk_bf16_f32 v28, v232, v224
    v_cvt_pk_bf16_f32 v29, v233, v225
    v_cvt_pk_bf16_f32 v30, v234, v226
    v_cvt_pk_bf16_f32 v31, v235, v227
    ds_write_b128 v1, v[24:27] offset:8192
    ds_write_b128 v1, v[28:31] offset:12288
    s_waitcnt lgkmcnt(0)
    s_barrier
    ds_read_b128 v[120:123], v63 offset:8192
    ds_read_b128 v[124:127], v63 offset:9216
    s_waitcnt lgkmcnt(1)
    v_mfma_f32_16x16x32_bf16 v[252:255], v[180:183], v[120:123], 0
    v_mfma_f32_16x16x32_bf16 v[244:247], v[176:179], v[120:123], 0
    v_mfma_f32_16x16x32_bf16 v[248:251], v[164:167], v[120:123], 0
    buffer_load_dwordx4 a[32:35], v54, s[36:39], s63 offen sc1
    v_mfma_f32_16x16x32_bf16 v[240:243], v[160:163], v[120:123], 0
    s_waitcnt lgkmcnt(0)
    v_mfma_f32_16x16x32_bf16 v[252:255], v[172:175], v[124:127], v[252:255]
    v_mfma_f32_16x16x32_bf16 v[244:247], v[168:171], v[124:127], v[244:247]
    v_mfma_f32_16x16x32_bf16 v[248:251], v[156:159], v[124:127], v[248:251]
    v_mfma_f32_16x16x32_bf16 v[240:243], v[152:155], v[124:127], v[240:243]
    s_nop 5
    v_cvt_pk_bf16_f32 v24, v252, v244
    v_cvt_pk_bf16_f32 v25, v253, v245
    v_cvt_pk_bf16_f32 v26, v254, v246
    v_cvt_pk_bf16_f32 v27, v255, v247
    v_cvt_pk_bf16_f32 v28, v248, v240
    buffer_load_dwordx4 a[44:47], v55, s[36:39], s63 offen sc1
    v_cvt_pk_bf16_f32 v29, v249, v241
    v_cvt_pk_bf16_f32 v30, v250, v242
    v_cvt_pk_bf16_f32 v31, v251, v243
    global_store_dwordx4 v2, v[24:27], s[26:27] sc1
    global_store_dwordx4 v3, v[28:31], s[26:27] sc1
    v_add_u32 v8, 22528, v10
    v_add_u32 v9, 30720, v10
    v_lshlrev_b32 v21, 5, v18
    v_lshl_add_u32 v21, v19, 3, v21
    s_lshl_b32 s57, s53, 11
    s_add_u32 s57, s57, 152576
    v_add_u32 v16, s57, v21
    ds_read_b64 v[64:65], v16 offset:0
    ds_read_b64 v[66:67], v16 offset:512
    ds_read_b64 v[68:69], v16 offset:1024
    ds_read_b64 v[70:71], v16 offset:1536
    v_lshl_add_u32 v24, v19, 3, s83
    buffer_load_dwordx2 v[136:137], v24, s[40:43], 0 offen offset:0
    buffer_load_dwordx2 v[138:139], v24, s[40:43], 0 offen offset:32
    buffer_load_dwordx2 v[140:141], v24, s[40:43], 0 offen offset:64
    ds_read_b64_tr_b16 a[192:193], v48 offset:0
    ds_read_b64_tr_b16 a[196:197], v49 offset:0
    ds_read_b64_tr_b16 a[200:201], v50 offset:0
    ds_read_b64_tr_b16 a[204:205], v51 offset:0
    ds_read_b64_tr_b16 a[194:195], v48 offset:2048
    ds_read_b64_tr_b16 a[198:199], v49 offset:2048
    ds_read_b64_tr_b16 a[202:203], v50 offset:2048
    ds_read_b64_tr_b16 a[206:207], v51 offset:2048
    ds_read_b64_tr_b16 a[208:209], v48 offset:4096
    ds_read_b64_tr_b16 a[212:213], v49 offset:4096
    ds_read_b64_tr_b16 a[216:217], v50 offset:4096
    ds_read_b64_tr_b16 a[220:221], v51 offset:4096
    ds_read_b64_tr_b16 a[210:211], v48 offset:6144
    ds_read_b64_tr_b16 a[214:215], v49 offset:6144
    ds_read_b64_tr_b16 a[218:219], v50 offset:6144
    ds_read_b64_tr_b16 a[222:223], v51 offset:6144
    ds_read_b64_tr_b16 a[224:225], v44 offset:0
    ds_read_b64_tr_b16 a[228:229], v45 offset:0
    ds_read_b64_tr_b16 a[232:233], v46 offset:0
    ds_read_b64_tr_b16 a[236:237], v47 offset:0
    ds_read_b64_tr_b16 a[226:227], v44 offset:2048
    ds_read_b64_tr_b16 a[230:231], v45 offset:2048
    ds_read_b64_tr_b16 a[234:235], v46 offset:2048
    ds_read_b64_tr_b16 a[238:239], v47 offset:2048
    ds_read_b64_tr_b16 a[240:241], v44 offset:4096
    ds_read_b64_tr_b16 a[244:245], v45 offset:4096
    ds_read_b64_tr_b16 a[248:249], v46 offset:4096
    ds_read_b64_tr_b16 a[252:253], v47 offset:4096
    ds_read_b64_tr_b16 a[242:243], v44 offset:6144
    ds_read_b64_tr_b16 a[246:247], v45 offset:6144
    ds_read_b64_tr_b16 a[250:251], v46 offset:6144
    ds_read_b64_tr_b16 a[254:255], v47 offset:6144
    global_load_dwordx4 v[104:107], v8, s[26:27] offset:-2048 sc1
    s_waitcnt vmcnt(18)
    global_load_dwordx4 v[108:111], v8, s[26:27] offset:2048 sc1
    s_waitcnt vmcnt(19)
    global_load_dwordx4 v[112:115], v9, s[26:27] offset:-2048 sc1
    global_load_dwordx4 v[116:119], v9, s[26:27] offset:2048 sc1
    s_add_u32 s63, s88, 16384
    buffer_load_dwordx4 a[48:51], v20, s[36:39], s63 offen sc1
    v_lshrrev_b32 v37, 1, v19
    v_lshlrev_b32 v1, 31, v37
    v_add_u32 v2, -1, v37
    v_and_b32 v3, 1, v18
    v_lshlrev_b32 v3, 31, v3
    v_or_b32 v3, 0.5, v3
    v_cndmask_b32 v3, 0, v3, s[68:69]
    v_mov_b32 v97, 1.0
    v_cndmask_b32 v97, v97, 0.5, s[68:69]
    s_lshr_b32 s57, s79, 15
    v_cvt_f32_u32 v98, s57
    v_mul_f32 v98, 0x3c800000, v98
    v_cvt_f32_u32 v99, v37
    v_mul_f32 v99, v99, v23
    v_mul_f32 v99, 0xbef00000, v99
    v_mul_f32 v36, 0x3d800000, v23
    v_mul_f32 v24, v52, v36
    v_add_f32 v25, v24, v36
    v_add_f32 v26, v25, v36
    v_add_f32 v27, v26, v36
    v_cos_f32 v28, v24
    buffer_load_dwordx4 a[60:63], v53, s[36:39], s63 offen sc1
    v_sin_f32 v32, v24
    v_cos_f32 v29, v25
    v_sin_f32 v33, v25
    v_cos_f32 v30, v26
    v_sin_f32 v34, v26
    v_cos_f32 v31, v27
    v_sin_f32 v35, v27
    v_cvt_pk_bf16_f32 v144, v28, v32
    v_cvt_pk_bf16_f32 v148, -v32, v28
    v_xor_b32 v144, v144, v1
    v_xor_b32 v148, v148, v1
    v_cvt_pk_bf16_f32 v145, v29, v33
    v_cvt_pk_bf16_f32 v149, -v33, v29
    v_xor_b32 v145, v145, v1
    v_xor_b32 v149, v149, v1
    buffer_load_dwordx4 a[72:75], v54, s[36:39], s63 offen sc1
    v_cvt_pk_bf16_f32 v146, v30, v34
    v_cvt_pk_bf16_f32 v150, -v34, v30
    v_xor_b32 v146, v146, v1
    v_xor_b32 v150, v150, v1
    v_cvt_pk_bf16_f32 v147, v31, v35
    v_cvt_pk_bf16_f32 v151, -v35, v31
    v_xor_b32 v147, v147, v1
    v_xor_b32 v151, v151, v1
    v_fma_f32 v24, v52, v36, v99
    v_add_f32 v25, v24, v36
    v_add_f32 v26, v25, v36
    v_add_f32 v27, v26, v36
    v_cos_f32 v28, v24
    v_sin_f32 v32, v24
    v_cos_f32 v29, v25
    v_sin_f32 v33, v25
    v_cos_f32 v30, v26
    buffer_load_dwordx4 a[84:87], v55, s[36:39], s63 offen sc1
    v_sin_f32 v34, v26
    v_cos_f32 v31, v27
    v_sin_f32 v35, v27
    v_mul_f32 v38, v97, v28
    v_mul_f32 v39, v97, v32
    v_fma_f32 v39, -v3, v28, v39
    v_fma_f32 v28, v3, v32, v38
    v_mov_b32 v32, v39
    v_cvt_pk_bf16_f32 v156, v28, v32
    v_and_b32 v152, v156, v2
    v_xor_b32 v156, v156, v152
    v_cvt_pk_bf16_f32 v157, v29, v33
    v_and_b32 v153, v157, v2
    v_xor_b32 v157, v157, v153
    v_cvt_pk_bf16_f32 v158, v30, v34
    v_and_b32 v154, v158, v2
    v_xor_b32 v158, v158, v154
    v_cvt_pk_bf16_f32 v159, v31, v35
    v_and_b32 v155, v159, v2
    s_add_u32 s63, s89, 16384
    buffer_load_dwordx4 a[52:55], v20, s[36:39], s63 offen sc1
    v_xor_b32 v159, v159, v155
    v_mul_f32 v24, v52, v36
    v_xor_b32 v38, v98, v1
    v_add_f32 v24, v24, v38
    v_add_f32 v25, v24, v36
    v_add_f32 v26, v25, v36
    v_add_f32 v27, v26, v36
    v_cos_f32 v28, v24
    v_sin_f32 v32, v24
    v_cos_f32 v29, v25
    v_sin_f32 v33, v25
    v_cos_f32 v30, v26
    v_sin_f32 v34, v26
    v_cos_f32 v31, v27
    v_sin_f32 v35, v27
    buffer_load_dwordx4 a[64:67], v53, s[36:39], s63 offen sc1
    v_cvt_pk_bf16_f32 v160, v28, v32
    v_cvt_pk_bf16_f32 v164, -v32, v28
    v_xor_b32 v160, v160, v1
    v_xor_b32 v164, v164, v1
    v_cvt_pk_bf16_f32 v161, v29, v33
    v_cvt_pk_bf16_f32 v165, -v33, v29
    v_xor_b32 v161, v161, v1
    v_xor_b32 v165, v165, v1
    v_cvt_pk_bf16_f32 v162, v30, v34
    v_cvt_pk_bf16_f32 v166, -v34, v30
    v_xor_b32 v162, v162, v1
    v_xor_b32 v166, v166, v1
    v_cvt_pk_bf16_f32 v163, v31, v35
    v_cvt_pk_bf16_f32 v167, -v35, v31
    v_xor_b32 v163, v163, v1
    v_xor_b32 v167, v167, v1
    v_fma_f32 v24, v52, v36, v99
    v_add_f32 v24, v24, v98
    v_add_f32 v25, v24, v36
    v_add_f32 v26, v25, v36
    v_add_f32 v27, v26, v36
    v_cos_f32 v28, v24
    buffer_load_dwordx4 a[76:79], v54, s[36:39], s63 offen sc1
    v_sin_f32 v32, v24
    v_cos_f32 v29, v25
    v_sin_f32 v33, v25
    v_cos_f32 v30, v26
    v_sin_f32 v34, v26
    v_cos_f32 v31, v27
    v_sin_f32 v35, v27
    v_mul_f32 v38, v97, v28
    v_mul_f32 v39, v97, v32
    v_fma_f32 v39, -v3, v28, v39
    v_fma_f32 v28, v3, v32, v38
    v_mov_b32 v32, v39
    v_cvt_pk_bf16_f32 v172, v28, v32
    v_and_b32 v168, v172, v2
    v_xor_b32 v172, v172, v168
    buffer_load_dwordx4 a[88:91], v55, s[36:39], s63 offen sc1
    v_cvt_pk_bf16_f32 v173, v29, v33
    v_and_b32 v169, v173, v2
    v_xor_b32 v173, v173, v169
    v_cvt_pk_bf16_f32 v174, v30, v34
    v_and_b32 v170, v174, v2
    v_xor_b32 v174, v174, v170
    v_cvt_pk_bf16_f32 v175, v31, v35
    v_and_b32 v171, v175, v2
    v_xor_b32 v175, v175, v171
    v_add_f32 v37, 0x00000000, v23
    v_mul_f32 v36, 0x3d000000, v37
    v_mul_f32 v24, v52, v36
    v_add_f32 v25, v24, v36
    v_add_f32 v26, v25, v36
    v_add_f32 v27, v26, v36
    v_cos_f32 v28, v24
    v_sin_f32 v32, v24
    v_cos_f32 v29, v25
    v_sin_f32 v33, v25
    s_add_u32 s63, s90, 16384
    buffer_load_dwordx4 a[56:59], v20, s[36:39], s63 offen sc1
    v_cos_f32 v30, v26
    v_sin_f32 v34, v26
    v_cos_f32 v31, v27
    v_sin_f32 v35, v27
    v_fmac_f32 v32, 2.0, v3
    v_cvt_pk_bf16_f32 v176, v28, v32
    v_cvt_pk_bf16_f32 v177, v29, v33
    v_cvt_pk_bf16_f32 v178, v30, v34
    v_cvt_pk_bf16_f32 v179, v31, v35
    v_add_f32 v37, 0x41800000, v23
    v_mul_f32 v36, 0x3d000000, v37
    v_mul_f32 v24, v52, v36
    v_add_f32 v25, v24, v36
    v_add_f32 v26, v25, v36
    v_add_f32 v27, v26, v36
    v_cos_f32 v28, v24
    v_sin_f32 v32, v24
    buffer_load_dwordx4 a[68:71], v53, s[36:39], s63 offen sc1
    v_cos_f32 v29, v25
    v_sin_f32 v33, v25
    v_cos_f32 v30, v26
    v_sin_f32 v34, v26
    v_cos_f32 v31, v27
    v_sin_f32 v35, v27
    v_fmac_f32 v32, 2.0, v3
    v_cvt_pk_bf16_f32 v180, v28, v32
    v_cvt_pk_bf16_f32 v181, v29, v33
    v_cvt_pk_bf16_f32 v182, v30, v34
    v_cvt_pk_bf16_f32 v183, v31, v35
    s_waitcnt lgkmcnt(0)
    s_barrier
    v_lshlrev_b32 v80, 16, v64
    v_and_b32 v81, 0xffff0000, v64
    v_lshlrev_b32 v82, 16, v65
    v_and_b32 v83, 0xffff0000, v65
    buffer_load_dwordx4 a[80:83], v54, s[36:39], s63 offen sc1
    v_lshlrev_b32 v84, 16, v66
    v_and_b32 v85, 0xffff0000, v66
    v_lshlrev_b32 v86, 16, v67
    v_and_b32 v87, 0xffff0000, v67
    v_lshlrev_b32 v88, 16, v68
    v_and_b32 v89, 0xffff0000, v68
    v_lshlrev_b32 v90, 16, v69
    v_and_b32 v91, 0xffff0000, v69
    v_lshlrev_b32 v92, 16, v70
    v_and_b32 v93, 0xffff0000, v70
    v_lshlrev_b32 v94, 16, v71
    v_and_b32 v95, 0xffff0000, v71
    s_waitcnt vmcnt(17)
    v_lshlrev_b32 v4, 16, v136
    v_and_b32 v5, 0xffff0000, v136
    v_lshlrev_b32 v6, 16, v137
    v_and_b32 v7, 0xffff0000, v137
    s_waitcnt vmcnt(16)
    v_lshlrev_b32 v56, 16, v138
    v_and_b32 v57, 0xffff0000, v138
    v_lshlrev_b32 v58, 16, v139
    v_and_b32 v59, 0xffff0000, v139
    s_waitcnt vmcnt(15)
    v_lshlrev_b32 v60, 16, v140
    v_and_b32 v61, 0xffff0000, v140
    buffer_load_dwordx4 a[92:95], v55, s[36:39], s63 offen sc1
    v_lshlrev_b32 v62, 16, v141
    v_and_b32 v63, 0xffff0000, v141
L_M_s:
    s_waitcnt vmcnt(15)
    v_sad_u32 v24, v105, s52, 0
    v_sad_u32 v24, v107, s52, v24
    s_waitcnt vmcnt(14)
    v_sad_u32 v24, v109, s52, v24
    v_sad_u32 v24, v111, s52, v24
    s_waitcnt vmcnt(13)
    v_sad_u32 v24, v113, s52, v24
    v_sad_u32 v24, v115, s52, v24
    s_waitcnt vmcnt(12)
    v_sad_u32 v24, v117, s52, v24
    v_sad_u32 v24, v119, s52, v24
    v_cmp_ne_u32 vcc, 0, v24
    s_cbranch_vccnz L_M_retry_s
L_M_ok_s:
    s_cmp_ge_u32 s53, 2
    s_mov_b32 s57, 0x3fb8aa3b
    s_cselect_b32 s84, s57, 0x36000000
    s_mov_b32 s85, 0
    s_cselect_b32 s86, 0x3f317218, s57
    s_cselect_b32 s87, 0, s57
    v_lshlrev_b32 v24, 16, v104
    v_and_b32 v25, 0xffff0000, v104
    v_lshlrev_b32 v26, 16, v106
    v_and_b32 v27, 0xffff0000, v106
    v_lshlrev_b32 v28, 16, v108
    v_and_b32 v29, 0xffff0000, v108
    v_lshlrev_b32 v30, 16, v110
    v_and_b32 v31, 0xffff0000, v110
    v_lshlrev_b32 v32, 16, v112
    v_and_b32 v33, 0xffff0000, v112
    v_lshlrev_b32 v34, 16, v114
    v_and_b32 v35, 0xffff0000, v114
    v_lshlrev_b32 v36, 16, v116
    v_and_b32 v37, 0xffff0000, v116
    v_lshlrev_b32 v38, 16, v118
    v_and_b32 v39, 0xffff0000, v118
    v_pk_add_f32 v[24:25], v[24:25], v[32:33]
    v_pk_add_f32 v[26:27], v[26:27], v[34:35]
    v_pk_add_f32 v[28:29], v[28:29], v[36:37]
    v_pk_add_f32 v[30:31], v[30:31], v[38:39]
    v_pk_fma_f32 v[24:25], v[24:25], s[84:85], s[84:85] op_sel:[0,0,1] op_sel_hi:[1,0,1]
    v_pk_fma_f32 v[26:27], v[26:27], s[84:85], s[84:85] op_sel:[0,0,1] op_sel_hi:[1,0,1]
    v_pk_fma_f32 v[28:29], v[28:29], s[86:87], s[86:87] op_sel:[0,0,1] op_sel_hi:[1,0,1]
    v_pk_fma_f32 v[30:31], v[30:31], s[86:87], s[86:87] op_sel:[0,0,1] op_sel_hi:[1,0,1]
    v_add_u32 v23, 152576, v10
    ds_write_b128 v23, v[24:27] offset:0
    ds_write_b128 v23, v[28:31] offset:4096
    s_mov_b32 s84, 0x3fb8aa3b
    v_pk_mul_f32 v[4:5], v[4:5], s[84:85] op_sel_hi:[1,0]
    v_pk_mul_f32 v[6:7], v[6:7], s[84:85] op_sel_hi:[1,0]
    v_pk_mul_f32 v[56:57], v[56:57], s[84:85] op_sel_hi:[1,0]
    v_pk_mul_f32 v[58:59], v[58:59], s[84:85] op_sel_hi:[1,0]
    v_pk_mul_f32 v[60:61], v[60:61], s[84:85] op_sel_hi:[1,0]
    v_pk_mul_f32 v[62:63], v[62:63], s[84:85] op_sel_hi:[1,0]
    s_and_b32 s57, s2, 127
    s_lshl_b32 s57, s57, 14
    s_add_u32 s57, s57, 6293504
    v_add_u32 v8, s57, v10
    v_add_u32 v9, 8192, v8
    v_lshlrev_b32 v16, 1, v21
    v_add_u32 v16, 152576, v16
    s_lshl_b32 s76, s55, 16
    s_and_b32 s57, s2, 127
    s_lshl_b32 s57, s57, 1
    s_add_u32 s57, s57, s54
    s_lshl_b32 s57, s57, 13
    s_lshl_b32 s58, s53, 11
    s_add_u32 s57, s57, s58
    s_add_u32 s57, s57, 2097152
    v_add_u32 v23, s57, v20
    s_lshl_b32 s58, s55, 10
    s_lshl_b32 s59, s56, 2
    s_add_u32 s59, s59, s53
    s_lshl_b32 s59, s59, 2
    s_add_u32 s59, s59, s58
    s_add_u32 s59, s59, 65536
    v_mov_b32 v52, s59
    v_mov_b32 v1, s52
    s_waitcnt lgkmcnt(0)
    s_barrier
    global_load_dwordx4 v[120:123], v8, s[26:27] offset:-2048 sc1
    global_load_dwordx4 v[124:127], v8, s[26:27] offset:2048 sc1
    global_load_dwordx4 v[128:131], v9, s[26:27] offset:-2048 sc1
    global_load_dwordx4 v[132:135], v9, s[26:27] offset:2048 sc1
    s_add_u32 s63, s88, 32768
    buffer_load_dwordx4 a[96:99], v20, s[36:39], s63 offen sc1
    buffer_load_dwordx4 a[108:111], v53, s[36:39], s63 offen sc1
    buffer_load_dwordx4 a[120:123], v54, s[36:39], s63 offen sc1
    buffer_load_dwordx4 a[132:135], v55, s[36:39], s63 offen sc1
    s_add_u32 s63, s89, 32768
    buffer_load_dwordx4 a[100:103], v20, s[36:39], s63 offen sc1
    buffer_load_dwordx4 a[112:115], v53, s[36:39], s63 offen sc1
    buffer_load_dwordx4 a[124:127], v54, s[36:39], s63 offen sc1
    buffer_load_dwordx4 a[136:139], v55, s[36:39], s63 offen sc1
    s_waitcnt vmcnt(8)
L_C_s:
    v_max3_u32 v24, v120, v121, v122
    v_max3_u32 v24, v24, v123, v124
    v_max3_u32 v24, v24, v125, v126
    v_max3_u32 v24, v24, v127, v128
    v_max3_u32 v24, v24, v129, v130
    v_max3_u32 v24, v24, v131, v132
    v_max3_u32 v24, v24, v133, v134
    v_max_u32 v24, v24, v135
    v_cmp_eq_u32 vcc, -1, v24
    s_cbranch_vccnz L_C_retry_s
L_C_ok_s:
    ds_write2st64_b32 v96, v120, v121 offset0:0 offset1:9
    ds_write2st64_b32 v96, v122, v123 offset0:18 offset1:27
    ds_write2st64_b32 v96, v124, v125 offset0:2 offset1:11
    ds_write2st64_b32 v96, v126, v127 offset0:20 offset1:29
    ds_write2st64_b32 v96, v128, v129 offset0:36 offset1:45
    ds_write2st64_b32 v96, v130, v131 offset0:54 offset1:63
    ds_write2st64_b32 v96, v132, v133 offset0:38 offset1:47
    ds_write2st64_b32 v96, v134, v135 offset0:56 offset1:65
    s_waitcnt lgkmcnt(0)
    s_barrier
    s_add_u32 s63, s90, 32768
    buffer_load_dwordx4 a[104:107], v20, s[36:39], s63 offen sc1
    ds_read_b128 v[120:123], v101 offset:0
    ds_read_b128 v[124:127], v101 offset:9216
    ds_read_b128 v[128:131], v101 offset:1088
    ds_read_b128 v[132:135], v101 offset:10304
    s_waitcnt lgkmcnt(3)
    v_mfma_f32_16x16x32_bf16 v[252:255], v[120:123], v[144:147], 0
    v_mfma_f32_16x16x32_bf16 v[244:247], v[120:123], v[148:151], 0
    v_mfma_f32_16x16x32_bf16 v[236:239], v[120:123], v[152:155], 0
    v_mfma_f32_16x16x32_bf16 v[228:231], v[120:123], v[156:159], 0
    buffer_load_dwordx4 a[116:119], v53, s[36:39], s63 offen sc1
    s_waitcnt lgkmcnt(2)
    v_mfma_f32_16x16x32_bf16 v[252:255], v[124:127], v[160:163], v[252:255]
    v_mfma_f32_16x16x32_bf16 v[244:247], v[124:127], v[164:167], v[244:247]
    v_mfma_f32_16x16x32_bf16 v[236:239], v[124:127], v[168:171], v[236:239]
    v_mfma_f32_16x16x32_bf16 v[228:231], v[124:127], v[172:175], v[228:231]
    s_waitcnt lgkmcnt(1)
    v_mfma_f32_16x16x32_bf16 v[248:251], v[128:131], v[144:147], 0
    buffer_load_dwordx4 a[128:131], v54, s[36:39], s63 offen sc1
    ds_read_b128 v[64:67], v16 offset:0
    v_mfma_f32_16x16x32_bf16 v[240:243], v[128:131], v[148:151], 0
    ds_read_b128 v[68:71], v16 offset:1024
    v_mfma_f32_16x16x32_bf16 v[232:235], v[128:131], v[152:155], 0
    ds_read_b128 v[136:139], v16 offset:2048
    v_mfma_f32_16x16x32_bf16 v[224:227], v[128:131], v[156:159], 0
    ds_read_b128 v[140:143], v16 offset:3072
    s_waitcnt lgkmcnt(4)
    v_mfma_f32_16x16x32_bf16 v[248:251], v[132:135], v[160:163], v[248:251]
    buffer_load_dwordx4 a[140:143], v55, s[36:39], s63 offen sc1
    ds_read_b128 v[184:187], v16 offset:4096
    v_mfma_f32_16x16x32_bf16 v[240:243], v[132:135], v[164:167], v[240:243]
    ds_read_b128 v[188:191], v16 offset:5120
    v_mfma_f32_16x16x32_bf16 v[232:235], v[132:135], v[168:171], v[232:235]
    v_mfma_f32_16x16x32_bf16 v[224:227], v[132:135], v[172:175], v[224:227]
    v_cndmask_b32 v252, v252, v236, s[68:69]
    v_cndmask_b32 v244, v244, v228, s[68:69]
    s_nop 4
    v_cndmask_b32 v248, v248, v232, s[68:69]
    v_cndmask_b32 v240, v240, v224, s[68:69]
    s_add_u32 s63, s88, 49152
    buffer_load_dwordx4 a[144:147], v20, s[36:39], s63 offen sc1
    v_pk_mul_f32 v[236:237], v[252:253], v[72:73]
    v_pk_mul_f32 v[228:229], v[244:245], v[72:73]
    v_pk_mul_f32 v[238:239], v[254:255], v[74:75]
    v_pk_mul_f32 v[230:231], v[246:247], v[74:75]
    v_pk_mul_f32 v[232:233], v[248:249], v[72:73]
    v_pk_mul_f32 v[224:225], v[240:241], v[72:73]
    v_pk_mul_f32 v[234:235], v[250:251], v[74:75]
    v_pk_mul_f32 v[226:227], v[242:243], v[74:75]
    v_pk_fma_f32 v[236:237], v[244:245], v[76:77], v[236:237]
    v_pk_fma_f32 v[228:229], v[252:253], v[76:77], v[228:229] neg_lo:[0,1,0] neg_hi:[0,1,0]
    v_pk_fma_f32 v[238:239], v[246:247], v[78:79], v[238:239]
    v_pk_fma_f32 v[230:231], v[254:255], v[78:79], v[230:231] neg_lo:[0,1,0] neg_hi:[0,1,0]
    v_pk_fma_f32 v[232:233], v[240:241], v[76:77], v[232:233]
    v_pk_fma_f32 v[224:225], v[248:249], v[76:77], v[224:225] neg_lo:[0,1,0] neg_hi:[0,1,0]
    v_pk_fma_f32 v[234:235], v[242:243], v[78:79], v[234:235]
    v_pk_fma_f32 v[226:227], v[250:251], v[78:79], v[226:227] neg_lo:[0,1,0] neg_hi:[0,1,0]
    v_cvt_pk_bf16_f32 v24, v236, v228
    v_cvt_pk_bf16_f32 v25, v237, v229
    buffer_load_dwordx4 a[156:159], v53, s[36:39], s63 offen sc1
    v_cvt_pk_bf16_f32 v26, v238, v230
    v_cvt_pk_bf16_f32 v27, v239, v231
    v_cvt_pk_bf16_f32 v28, v232, v224
    v_cvt_pk_bf16_f32 v29, v233, v225
    v_cvt_pk_bf16_f32 v30, v234, v226
    v_cvt_pk_bf16_f32 v31, v235, v227
    v_mfma_f32_16x16x32_bf16 v[252:255], v[24:27], v[176:179], 0
    v_mfma_f32_16x16x32_bf16 v[248:251], v[24:27], v[180:183], 0
    v_mfma_f32_16x16x32_bf16 v[244:247], v[28:31], v[176:179], 0
    buffer_load_dwordx4 a[168:171], v54, s[36:39], s63 offen sc1
    v_mfma_f32_16x16x32_bf16 v[240:243], v[28:31], v[180:183], 0
    s_waitcnt lgkmcnt(5)
    s_nop 2
    v_pk_fma_f32 v[80:81], v[252:253], v[64:65], v[80:81]
    v_pk_fma_f32 v[82:83], v[254:255], v[66:67], v[82:83]
    s_waitcnt lgkmcnt(4)
    v_pk_fma_f32 v[84:85], v[248:249], v[68:69], v[84:85]
    v_pk_fma_f32 v[86:87], v[250:251], v[70:71], v[86:87]
    v_pk_fma_f32 v[88:89], v[244:245], v[64:65], v[88:89]
    v_pk_fma_f32 v[90:91], v[246:247], v[66:67], v[90:91]
    v_pk_fma_f32 v[92:93], v[240:241], v[68:69], v[92:93]
    v_pk_fma_f32 v[94:95], v[242:243], v[70:71], v[94:95]
    buffer_load_dwordx4 a[180:183], v55, s[36:39], s63 offen sc1
    s_add_u32 s63, s89, 49152
    buffer_load_dwordx4 a[148:151], v20, s[36:39], s63 offen sc1
    buffer_load_dwordx4 a[160:163], v53, s[36:39], s63 offen sc1
    v_pk_add_f32 v[24:25], v[80:81], v[82:83]
    v_pk_mul_f32 v[26:27], v[80:81], v[80:81]
    v_pk_add_f32 v[24:25], v[24:25], v[84:85]
    v_pk_fma_f32 v[26:27], v[82:83], v[82:83], v[26:27]
    v_pk_add_f32 v[24:25], v[24:25], v[86:87]
    v_pk_fma_f32 v[26:27], v[84:85], v[84:85], v[26:27]
    v_pk_fma_f32 v[26:27], v[86:87], v[86:87], v[26:27]
    v_pk_add_f32 v[28:29], v[88:89], v[90:91]
    v_pk_mul_f32 v[30:31], v[88:89], v[88:89]
    v_pk_add_f32 v[28:29], v[28:29], v[92:93]
    v_pk_fma_f32 v[30:31], v[90:91], v[90:91], v[30:31]
    v_pk_add_f32 v[28:29], v[28:29], v[94:95]
    v_pk_fma_f32 v[30:31], v[92:93], v[92:93], v[30:31]
    v_pk_fma_f32 v[30:31], v[94:95], v[94:95], v[30:31]
    v_add_f32 v24, v24, v25
    v_add_f32 v28, v28, v29
    v_add_f32 v26, v26, v27
    v_add_f32 v30, v30, v31
    v_cvt_pk_bf16_f32 v104, v80, v81
    v_permlane32_swap_b32 v24, v28
    v_permlane32_swap_b32 v26, v30
    v_add_f32 v24, v24, v28
    v_add_f32 v26, v26, v30
    v_cvt_pk_bf16_f32 v105, v82, v83
    v_cvt_pk_bf16_f32 v106, v84, v85
    v_permlane16_swap_b32 v24, v26
    v_add_f32 v24, v24, v26
    v_cvt_pk_bf16_f32 v107, v86, v87
    v_cvt_pk_bf16_f32 v108, v88, v89
    v_add_f32_dpp v24, v24, v24 row_ror:1 row_mask:0xf bank_mask:0xf
    v_cvt_pk_bf16_f32 v109, v90, v91
    v_cvt_pk_bf16_f32 v110, v92, v93
    v_add_f32_dpp v24, v24, v24 row_ror:2 row_mask:0xf bank_mask:0xf
    v_cvt_pk_bf16_f32 v111, v94, v95
    s_nop 0
    v_add_f32_dpp v24, v24, v24 row_ror:4 row_mask:0xf bank_mask:0xf
    s_nop 1
    v_add_f32_dpp v24, v24, v24 row_ror:8 row_mask:0xf bank_mask:0xf
    v_mov_b32 v25, v24
    s_nop 1
    v_permlane16_swap_b32 v24, v25
    v_mul_f32 v24, 0x3b000000, v24
    v_mul_f32 v26, v24, v24
    v_fmamk_f32 v25, v25, 0x3b000000, v22
    v_sub_f32 v25, v25, v26
    v_max_f32 v25, v25, v22
    v_rsq_f32 v192, v25
    s_nop 0
    v_mul_f32 v193, v24, v192
    v_mov_b32 v194, v192
    v_sub_f32 v193, 0, v193
    v_mov_b32 v195, v193
    v_permlane32_swap_b32 v192, v194
    s_nop 0
    v_permlane32_swap_b32 v193, v195
    v_pk_fma_f32 v[80:81], v[80:81], v[192:193], v[192:193] op_sel:[0,0,1] op_sel_hi:[1,0,1]
    v_pk_fma_f32 v[82:83], v[82:83], v[192:193], v[192:193] op_sel:[0,0,1] op_sel_hi:[1,0,1]
    v_pk_fma_f32 v[84:85], v[84:85], v[192:193], v[192:193] op_sel:[0,0,1] op_sel_hi:[1,0,1]
    v_pk_fma_f32 v[86:87], v[86:87], v[192:193], v[192:193] op_sel:[0,0,1] op_sel_hi:[1,0,1]
    s_waitcnt lgkmcnt(1)
    v_pk_fma_f32 v[80:81], v[80:81], v[184:185], v[136:137]
    v_pk_fma_f32 v[82:83], v[82:83], v[186:187], v[138:139]
    s_waitcnt lgkmcnt(0)
    v_pk_fma_f32 v[84:85], v[84:85], v[188:189], v[140:141]
    v_pk_fma_f32 v[86:87], v[86:87], v[190:191], v[142:143]
    v_cvt_pk_bf16_f32 v24, v80, v81
    v_cvt_pk_bf16_f32 v25, v82, v83
    v_cvt_pk_bf16_f32 v26, v84, v85
    v_cvt_pk_bf16_f32 v27, v86, v87
    global_store_dwordx4 v23, v[24:27], s[26:27] offset:0 sc1
    v_pk_fma_f32 v[88:89], v[88:89], v[194:195], v[194:195] op_sel:[0,0,1] op_sel_hi:[1,0,1]
    v_pk_fma_f32 v[90:91], v[90:91], v[194:195], v[194:195] op_sel:[0,0,1] op_sel_hi:[1,0,1]
    v_pk_fma_f32 v[92:93], v[92:93], v[194:195], v[194:195] op_sel:[0,0,1] op_sel_hi:[1,0,1]
    v_pk_fma_f32 v[94:95], v[94:95], v[194:195], v[194:195] op_sel:[0,0,1] op_sel_hi:[1,0,1]
    v_pk_fma_f32 v[88:89], v[88:89], v[184:185], v[136:137]
    v_pk_fma_f32 v[90:91], v[90:91], v[186:187], v[138:139]
    v_pk_fma_f32 v[92:93], v[92:93], v[188:189], v[140:141]
    v_pk_fma_f32 v[94:95], v[94:95], v[190:191], v[142:143]
    v_cvt_pk_bf16_f32 v28, v88, v89
    v_cvt_pk_bf16_f32 v29, v90, v91
    v_cvt_pk_bf16_f32 v30, v92, v93
    v_cvt_pk_bf16_f32 v31, v94, v95
    global_store_dwordx4 v23, v[28:31], s[26:27] offset:1024 sc1
    s_lshl_b32 s57, s53, 11
    s_add_u32 s57, s57, 18432
    v_add_u32 v32, s57, v21
    v_add_u32 v33, s57, v20
    ds_write_b64 v32, v[104:105] offset:0
    ds_write_b64 v32, v[106:107] offset:512
    ds_write_b64 v32, v[108:109] offset:1024
    ds_write_b64 v32, v[110:111] offset:1536
    s_waitcnt lgkmcnt(0)
    ds_read_b128 v[112:115], v33 offset:0
    ds_read_b128 v[116:119], v33 offset:1024
    s_waitcnt lgkmcnt(0)
    buffer_load_dwordx4 a[172:175], v54, s[36:39], s63 offen sc1
    ds_read_b64_tr_b16 v[144:145], v44 offset:8192
    ds_read_b64_tr_b16 v[148:149], v45 offset:8192
    ds_read_b64_tr_b16 v[152:153], v46 offset:8192
    ds_read_b64_tr_b16 v[156:157], v47 offset:8192
    ds_read_b64_tr_b16 v[146:147], v44 offset:10240
    ds_read_b64_tr_b16 v[150:151], v45 offset:10240
    ds_read_b64_tr_b16 v[154:155], v46 offset:10240
    ds_read_b64_tr_b16 v[158:159], v47 offset:10240
    ds_read_b64_tr_b16 v[160:161], v44 offset:12288
    ds_read_b64_tr_b16 v[164:165], v45 offset:12288
    ds_read_b64_tr_b16 v[168:169], v46 offset:12288
    ds_read_b64_tr_b16 v[172:173], v47 offset:12288
    ds_read_b64_tr_b16 v[162:163], v44 offset:14336
    ds_read_b64_tr_b16 v[166:167], v45 offset:14336
    ds_read_b64_tr_b16 v[170:171], v46 offset:14336
    buffer_load_dwordx4 a[184:187], v55, s[36:39], s63 offen sc1
    ds_read_b64_tr_b16 v[174:175], v47 offset:14336
    ds_read_b64_tr_b16 v[176:177], v44 offset:16384
    ds_read_b64_tr_b16 v[180:181], v45 offset:16384
    ds_read_b64_tr_b16 v[184:185], v46 offset:16384
    ds_read_b64_tr_b16 v[188:189], v47 offset:16384
    ds_read_b64_tr_b16 v[178:179], v44 offset:18432
    ds_read_b64_tr_b16 v[182:183], v45 offset:18432
    ds_read_b64_tr_b16 v[186:187], v46 offset:18432
    ds_read_b64_tr_b16 v[190:191], v47 offset:18432
    s_waitcnt vmcnt(2)
    global_store_dword v52, v1, s[26:27] offset:512 sc1
    s_lshl_b32 s57, s56, 13
    s_lshl_b32 s58, s53, 11
    s_add_u32 s57, s57, s58
    s_add_u32 s57, s57, s76
    s_add_u32 s57, s57, 10485760
    s_add_u32 s63, s90, 49152
    buffer_load_dwordx4 a[152:155], v20, s[36:39], s63 offen sc1
    v_add_u32 v33, s57, v20
    v_mul_u32_u24 v0, 1040, v18
    v_lshl_add_u32 v0, v19, 8, v0
    s_lshr_b32 s57, s53, 1
    s_lshl_b32 s57, s57, 5
    s_add_u32 s57, s57, s55
    s_lshl_b32 s57, s57, 14
    s_and_b32 s77, s53, 1
    s_lshl_b32 s77, s77, 12
    s_add_u32 s77, s77, s57
    s_add_u32 s77, s77, 2097088
    s_mul_i32 s80, s53, 4160
    v_add_u32 v76, 64, v20
    v_add_u32 v77, 48, v20
    v_add_u32 v78, 32, v20
    buffer_load_dwordx4 a[164:167], v53, s[36:39], s63 offen sc1
    v_add_u32 v79, 16, v20
    s_lshl_b32 s57, s55, 10
    s_add_u32 s57, s57, 66048
    v_and_b32 v38, 31, v17
    v_lshl_add_u32 v38, v38, 2, s57
    buffer_load_dwordx4 a[176:179], v54, s[36:39], s63 offen sc1
    buffer_load_dwordx4 a[188:191], v55, s[36:39], s63 offen sc1
    s_waitcnt lgkmcnt(0)
    s_barrier
L_D0_s:
    global_load_dword v16, v38, s[26:27] sc1
    s_waitcnt vmcnt(0)
    v_cmp_ne_u32 vcc, s52, v16
    s_cbranch_vccnz L_D0_retry_s
L_D0_ok_s:
    s_add_u32 m0, s80, 0
    s_add_u32 s57, s77, 0
    buffer_load_dwordx4 v76, s[36:39], s57 offen offset:0 sc1 lds
    buffer_load_dwordx4 v77, s[36:39], s57 offen offset:1040 sc1 lds
    buffer_load_dwordx4 v78, s[36:39], s57 offen offset:2080 sc1 lds
    buffer_load_dwordx4 v79, s[36:39], s57 offen offset:3120 sc1 lds
    s_add_u32 m0, s80, 16640
    s_add_u32 s57, s77, 1048576
    buffer_load_dwordx4 v76, s[36:39], s57 offen offset:0 sc1 lds
    buffer_load_dwordx4 v77, s[36:39], s57 offen offset:1040 sc1 lds
    buffer_load_dwordx4 v78, s[36:39], s57 offen offset:2080 sc1 lds
    buffer_load_dwordx4 v79, s[36:39], s57 offen offset:3120 sc1 lds
    s_waitcnt vmcnt(4)
    s_barrier
    s_mov_b32 s84, 0x3f3504f3
    s_mov_b32 s85, 0.5
    ds_read_b128 v[8:11], v0 offset:0
    ds_read_b128 v[12:15], v0 offset:16
    ds_read_b128 v[48:51], v0 offset:32
    ds_read_b128 v[64:67], v0 offset:48
    s_waitcnt lgkmcnt(2)
    v_mfma_f32_16x16x32_bf16 v[80:83], a[0:3], v[8:11], v[4:7]
    ds_read_b128 v[68:71], v0 offset:64
    s_and_b32 s92, s2, 127
    s_lshl_b32 s92, s92, 1
    s_lshr_b32 s93, s2, 7
    s_add_u32 m0, s80, 33280
    s_add_u32 s57, s77, 8192
    buffer_load_dwordx4 v76, s[36:39], s57 offen offset:0 sc1 lds
    v_mfma_f32_16x16x32_bf16 v[84:87], a[4:7], v[8:11], v[56:59]
    s_add_u32 s92, s92, s93
    s_lshl_b32 s92, s92, 13
    v_mfma_f32_16x16x32_bf16 v[88:91], a[8:11], v[8:11], v[60:63]
    s_add_u32 s91, s92, 6291456
    s_add_u32 s92, s92, 2097152
    v_mfma_f32_16x16x32_bf16 v[80:83], a[12:15], v[12:15], v[80:83]
    ds_read_b128 v[72:75], v0 offset:80
    s_mul_i32 s93, s2, 8320
    v_mfma_f32_16x16x32_bf16 v[84:87], a[16:19], v[12:15], v[84:87]
    s_add_u32 s93, s93, 20447232
    s_lshl_b32 s59, s53, 10
    v_mfma_f32_16x16x32_bf16 v[88:91], a[20:23], v[12:15], v[88:91]
    s_add_u32 s59, s59, 4096
    buffer_load_dwordx4 v77, s[36:39], s57 offen offset:1040 sc1 lds
    s_waitcnt lgkmcnt(2)
    v_mfma_f32_16x16x32_bf16 v[80:83], a[24:27], v[48:51], v[80:83]
    ds_read_b128 v[8:11], v0 offset:96
    v_add_u32 v26, s59, v20
    v_mfma_f32_16x16x32_bf16 v[84:87], a[28:31], v[48:51], v[84:87]
    v_add_u32 v21, s91, v26
    v_add_u32 v22, s92, v26
    v_mfma_f32_16x16x32_bf16 v[88:91], a[32:35], v[48:51], v[88:91]
    v_add_u32 v23, s93, v26
    s_lshl_b32 s60, s53, 6
    s_add_u32 s60, s60, s55
    s_and_b32 s92, s60, 127
    v_mfma_f32_16x16x32_bf16 v[80:83], a[36:39], v[64:67], v[80:83]
    ds_read_b128 v[12:15], v0 offset:112
    s_lshl_b32 s92, s92, 1
    v_mfma_f32_16x16x32_bf16 v[84:87], a[40:43], v[64:67], v[84:87]
    buffer_load_dwordx4 v78, s[36:39], s57 offen offset:2080 sc1 lds
    v_mfma_f32_16x16x32_bf16 v[88:91], a[44:47], v[64:67], v[88:91]
    s_lshr_b32 s93, s60, 7
    s_waitcnt lgkmcnt(2)
    v_mfma_f32_16x16x32_bf16 v[80:83], a[48:51], v[68:71], v[80:83]
    ds_read_b128 v[48:51], v0 offset:128
    s_add_u32 s92, s92, s93
    v_mfma_f32_16x16x32_bf16 v[84:87], a[52:55], v[68:71], v[84:87]
    s_lshl_b32 s92, s92, 13
    s_add_u32 s91, s92, 6291456
    v_mfma_f32_16x16x32_bf16 v[88:91], a[56:59], v[68:71], v[88:91]
    s_add_u32 s92, s92, 2097152
    s_mul_i32 s93, s60, 8320
    v_mfma_f32_16x16x32_bf16 v[80:83], a[60:63], v[72:75], v[80:83]
    ds_read_b128 v[64:67], v0 offset:144
    s_add_u32 s93, s93, 20447232
    s_add_u32 s60, s60, 32
    s_and_b32 s95, s60, 127
    buffer_load_dwordx4 v79, s[36:39], s57 offen offset:3120 sc1 lds
    v_mfma_f32_16x16x32_bf16 v[84:87], a[64:67], v[72:75], v[84:87]
    s_lshl_b32 s95, s95, 1
    s_lshr_b32 s96, s60, 7
    v_mfma_f32_16x16x32_bf16 v[88:91], a[68:71], v[72:75], v[88:91]
    s_add_u32 s95, s95, s96
    s_waitcnt lgkmcnt(2)
    v_mfma_f32_16x16x32_bf16 v[80:83], a[72:75], v[8:11], v[80:83]
    ds_read_b128 v[68:71], v0 offset:160
    s_lshl_b32 s95, s95, 13
    v_mfma_f32_16x16x32_bf16 v[84:87], a[76:79], v[8:11], v[84:87]
    s_add_u32 s94, s95, 6291456
    s_add_u32 s95, s95, 2097152
    v_mfma_f32_16x16x32_bf16 v[88:91], a[80:83], v[8:11], v[88:91]
    s_add_u32 m0, s80, 49920
    s_add_u32 s57, s77, 1056768
    buffer_load_dwordx4 v76, s[36:39], s57 offen offset:0 sc1 lds
    v_mfma_f32_16x16x32_bf16 v[80:83], a[84:87], v[12:15], v[80:83]
    ds_read_b128 v[72:75], v0 offset:176
    s_mul_i32 s96, s60, 8320
    v_mfma_f32_16x16x32_bf16 v[84:87], a[88:91], v[12:15], v[84:87]
    s_add_u32 s96, s96, 20447232
    v_lshrrev_b32 v24, 3, v17
    v_mfma_f32_16x16x32_bf16 v[88:91], a[92:95], v[12:15], v[88:91]
    v_and_b32 v25, 7, v17
    s_waitcnt lgkmcnt(2)
    v_mfma_f32_16x16x32_bf16 v[80:83], a[96:99], v[48:51], v[80:83]
    ds_read_b128 v[8:11], v0 offset:192
    s_lshl_b32 s58, s56, 8
    v_mfma_f32_16x16x32_bf16 v[84:87], a[100:103], v[48:51], v[84:87]
    buffer_load_dwordx4 v77, s[36:39], s57 offen offset:1040 sc1 lds
    v_mfma_f32_16x16x32_bf16 v[88:91], a[104:107], v[48:51], v[88:91]
    s_add_u32 s58, s58, 158720
    v_lshl_add_u32 v2, v25, 5, s58
    v_mfma_f32_16x16x32_bf16 v[80:83], a[108:111], v[64:67], v[80:83]
    ds_read_b128 v[12:15], v0 offset:208
    s_lshl_b32 s60, s53, 13
    v_mfma_f32_16x16x32_bf16 v[84:87], a[112:115], v[64:67], v[84:87]
    s_lshl_b32 s58, s56, 7
    s_add_u32 s60, s60, s58
    v_mfma_f32_16x16x32_bf16 v[88:91], a[116:119], v[64:67], v[88:91]
    s_add_u32 s60, s60, s76
    s_waitcnt lgkmcnt(2)
    v_mfma_f32_16x16x32_bf16 v[80:83], a[120:123], v[68:71], v[80:83]
    ds_read_b128 v[48:51], v0 offset:224
    s_add_u32 s60, s60, 10485760
    buffer_load_dwordx4 v78, s[36:39], s57 offen offset:2080 sc1 lds
    v_mfma_f32_16x16x32_bf16 v[84:87], a[124:127], v[68:71], v[84:87]
    v_lshl_add_u32 v26, v25, 4, s60
    v_lshl_add_u32 v40, v24, 10, v26
    v_mfma_f32_16x16x32_bf16 v[88:91], a[128:131], v[68:71], v[88:91]
    s_lshl_b32 s58, s55, 10
    s_add_u32 s58, s58, 65536
    v_mfma_f32_16x16x32_bf16 v[80:83], a[132:135], v[72:75], v[80:83]
    ds_read_b128 v[64:67], v0 offset:240
    s_lshl_b32 s59, s53, 5
    v_mfma_f32_16x16x32_bf16 v[84:87], a[136:139], v[72:75], v[84:87]
    s_add_u32 s59, s59, s58
    v_lshl_add_u32 v3, v25, 2, s59
    v_mfma_f32_16x16x32_bf16 v[88:91], a[140:143], v[72:75], v[88:91]
    buffer_load_dwordx4 v79, s[36:39], s57 offen offset:3120 sc1 lds
    s_waitcnt vmcnt(8)
    s_barrier
    s_waitcnt lgkmcnt(2)
    v_mfma_f32_16x16x32_bf16 v[80:83], a[144:147], v[8:11], v[80:83]
    ds_read_b128 v[68:71], v0 offset:16640
    global_store_dwordx4 v33, v[112:115], s[26:27] offset:0 sc1
    v_mfma_f32_16x16x32_bf16 v[84:87], a[148:151], v[8:11], v[84:87]
    global_store_dwordx4 v33, v[116:119], s[26:27] offset:1024 sc1
    v_mfma_f32_16x16x32_bf16 v[88:91], a[152:155], v[8:11], v[88:91]
    v_mfma_f32_16x16x32_bf16 v[80:83], a[156:159], v[12:15], v[80:83]
    ds_read_b128 v[72:75], v0 offset:16656
    s_add_u32 m0, s70, 0
    s_add_u32 s63, s74, 327680
    buffer_load_dwordx4 v42, s[32:35], s63 offen offset:0 lds
    v_mfma_f32_16x16x32_bf16 v[84:87], a[160:163], v[12:15], v[84:87]
    v_mfma_f32_16x16x32_bf16 v[88:91], a[164:167], v[12:15], v[88:91]
    buffer_load_dwordx4 v43, s[32:35], s63 offen offset:1024 lds
    s_waitcnt lgkmcnt(2)
    v_mfma_f32_16x16x32_bf16 v[80:83], a[168:171], v[48:51], v[80:83]
    ds_read_b128 v[8:11], v0 offset:16672
    v_mfma_f32_16x16x32_bf16 v[84:87], a[172:175], v[48:51], v[84:87]
    s_add_u32 m0, s70, 2048
    s_add_u32 s63, s74, 344064
    buffer_load_dwordx4 v42, s[32:35], s63 offen offset:0 lds
    v_mfma_f32_16x16x32_bf16 v[88:91], a[176:179], v[48:51], v[88:91]
    v_mfma_f32_16x16x32_bf16 v[80:83], a[180:183], v[64:67], v[80:83]
    ds_read_b128 v[12:15], v0 offset:16688
    buffer_load_dwordx4 v43, s[32:35], s63 offen offset:1024 lds
    v_mfma_f32_16x16x32_bf16 v[84:87], a[184:187], v[64:67], v[84:87]
    v_mfma_f32_16x16x32_bf16 v[88:91], a[188:191], v[64:67], v[88:91]
    s_waitcnt lgkmcnt(2)
    v_mfma_f32_16x16x32_bf16 v[92:95], a[0:3], v[68:71], v[4:7]
    ds_read_b128 v[48:51], v0 offset:16704
    s_add_u32 m0, s70, 4096
    s_add_u32 s63, s72, 32768
    buffer_load_dwordx4 v42, s[32:35], s63 offen offset:0 lds
    v_mfma_f32_16x16x32_bf16 v[96:99], a[4:7], v[68:71], v[56:59]
    v_mfma_f32_16x16x32_bf16 v[100:103], a[8:11], v[68:71], v[60:63]
    v_mfma_f32_16x16x32_bf16 v[92:95], a[12:15], v[72:75], v[92:95]
    ds_read_b128 v[64:67], v0 offset:16720
    v_mfma_f32_16x16x32_bf16 v[96:99], a[16:19], v[72:75], v[96:99]
    v_exp_f32 v24, v80
    v_mfma_f32_16x16x32_bf16 v[100:103], a[20:23], v[72:75], v[100:103]
    s_waitcnt lgkmcnt(2)
    v_mfma_f32_16x16x32_bf16 v[92:95], a[24:27], v[8:11], v[92:95]
    ds_read_b128 v[68:71], v0 offset:16736
    v_exp_f32 v25, v81
    v_mfma_f32_16x16x32_bf16 v[96:99], a[28:31], v[8:11], v[96:99]
    v_exp_f32 v26, v82
    buffer_load_dwordx4 v43, s[32:35], s63 offen offset:1024 lds
    v_mfma_f32_16x16x32_bf16 v[100:103], a[32:35], v[8:11], v[100:103]
    v_exp_f32 v27, v83
    v_mfma_f32_16x16x32_bf16 v[92:95], a[36:39], v[12:15], v[92:95]
    ds_read_b128 v[72:75], v0 offset:16752
    v_fma_f32 v24, v24, s84, s84
    v_mfma_f32_16x16x32_bf16 v[96:99], a[40:43], v[12:15], v[96:99]
    v_exp_f32 v32, v88
    v_mfma_f32_16x16x32_bf16 v[100:103], a[44:47], v[12:15], v[100:103]
    v_fma_f32 v25, v25, s84, s84
    v_exp_f32 v33, v89
    s_waitcnt lgkmcnt(2)
    v_mfma_f32_16x16x32_bf16 v[92:95], a[48:51], v[48:51], v[92:95]
    ds_read_b128 v[8:11], v0 offset:16768
    v_fma_f32 v26, v26, s84, s84
    v_exp_f32 v34, v90
    v_mfma_f32_16x16x32_bf16 v[96:99], a[52:55], v[48:51], v[96:99]
    v_exp_f32 v35, v91
    v_mfma_f32_16x16x32_bf16 v[100:103], a[56:59], v[48:51], v[100:103]
    v_fma_f32 v27, v27, s84, s84
    v_fma_f32 v24, v24, v24, 0.5
    v_mfma_f32_16x16x32_bf16 v[92:95], a[60:63], v[64:67], v[92:95]
    ds_read_b128 v[12:15], v0 offset:16784
    v_fma_f32 v32, v32, s84, s84
    v_exp_f32 v28, v84
    s_add_u32 m0, s70, 6144
    s_add_u32 s63, s72, 81920
    buffer_load_dwordx4 v42, s[32:35], s63 offen offset:0 lds
    v_mfma_f32_16x16x32_bf16 v[96:99], a[64:67], v[64:67], v[96:99]
    v_fma_f32 v25, v25, v25, 0.5
    v_fma_f32 v33, v33, s84, s84
    v_mfma_f32_16x16x32_bf16 v[100:103], a[68:71], v[64:67], v[100:103]
    v_fma_f32 v34, v34, s84, s84
    s_waitcnt lgkmcnt(2)
    v_mfma_f32_16x16x32_bf16 v[92:95], a[72:75], v[68:71], v[92:95]
    ds_read_b128 v[48:51], v0 offset:16800
    v_fma_f32 v35, v35, s84, s84
    v_exp_f32 v29, v85
    v_mfma_f32_16x16x32_bf16 v[96:99], a[76:79], v[68:71], v[96:99]
    v_fma_f32 v26, v26, v26, 0.5
    v_fma_f32 v32, v32, v32, 0.5
    v_mfma_f32_16x16x32_bf16 v[100:103], a[80:83], v[68:71], v[100:103]
    v_exp_f32 v30, v86
    v_fma_f32 v27, v27, v27, 0.5
    v_fma_f32 v33, v33, v33, 0.5
    v_mfma_f32_16x16x32_bf16 v[92:95], a[84:87], v[72:75], v[92:95]
    ds_read_b128 v[64:67], v0 offset:16816
    v_fma_f32 v34, v34, v34, 0.5
    v_mfma_f32_16x16x32_bf16 v[96:99], a[88:91], v[72:75], v[96:99]
    v_exp_f32 v31, v87
    v_mfma_f32_16x16x32_bf16 v[100:103], a[92:95], v[72:75], v[100:103]
    v_fma_f32 v35, v35, v35, 0.5
    buffer_load_dwordx4 v43, s[32:35], s63 offen offset:1024 lds
    s_waitcnt lgkmcnt(2)
    v_mfma_f32_16x16x32_bf16 v[92:95], a[96:99], v[8:11], v[92:95]
    ds_read_b128 v[68:71], v0 offset:16832
    v_rcp_f32 v24, v24
    v_mfma_f32_16x16x32_bf16 v[96:99], a[100:103], v[8:11], v[96:99]
    v_rcp_f32 v32, v32
    v_mfma_f32_16x16x32_bf16 v[100:103], a[104:107], v[8:11], v[100:103]
    v_rcp_f32 v33, v33
    v_rcp_f32 v34, v34
    v_mfma_f32_16x16x32_bf16 v[92:95], a[108:111], v[12:15], v[92:95]
    ds_read_b128 v[72:75], v0 offset:16848
    v_fma_f32 v28, v28, s84, s84
    v_rcp_f32 v25, v25
    v_mfma_f32_16x16x32_bf16 v[96:99], a[112:115], v[12:15], v[96:99]
    v_rcp_f32 v35, v35
    v_mfma_f32_16x16x32_bf16 v[100:103], a[116:119], v[12:15], v[100:103]
    v_fma_f32 v29, v29, s84, s84
    s_waitcnt lgkmcnt(2)
    v_mfma_f32_16x16x32_bf16 v[92:95], a[120:123], v[48:51], v[92:95]
    ds_read_b128 v[8:11], v0 offset:16864
    v_fma_f32 v32, -v88, v32, v88
    s_add_u32 m0, s70, 8192
    s_add_u32 s63, s75, 131072
    buffer_load_dwordx4 v42, s[32:35], s63 offen offset:0 lds
    v_mfma_f32_16x16x32_bf16 v[96:99], a[124:127], v[48:51], v[96:99]
    v_rcp_f32 v26, v26
    v_mfma_f32_16x16x32_bf16 v[100:103], a[128:131], v[48:51], v[100:103]
    v_fma_f32 v30, v30, s84, s84
    v_fma_f32 v33, -v89, v33, v89
    v_rcp_f32 v27, v27
    v_mfma_f32_16x16x32_bf16 v[92:95], a[132:135], v[64:67], v[92:95]
    ds_read_b128 v[12:15], v0 offset:16880
    v_fma_f32 v31, v31, s84, s84
    v_mfma_f32_16x16x32_bf16 v[96:99], a[136:139], v[64:67], v[96:99]
    v_fma_f32 v24, -v80, v24, v80
    v_fma_f32 v28, v28, v28, 0.5
    v_fma_f32 v25, -v81, v25, v81
    v_fma_f32 v29, v29, v29, 0.5
    v_mfma_f32_16x16x32_bf16 v[100:103], a[140:143], v[64:67], v[100:103]
    v_fma_f32 v26, -v82, v26, v82
    s_waitcnt vmcnt(11)
    s_barrier
    s_waitcnt lgkmcnt(2)
    v_mfma_f32_16x16x32_bf16 v[92:95], a[144:147], v[68:71], v[92:95]
    ds_read_b128 v[48:51], v0 offset:33280
    v_fma_f32 v30, v30, v30, 0.5
    v_fma_f32 v27, -v83, v27, v83
    v_fma_f32 v31, v31, v31, 0.5
    v_mfma_f32_16x16x32_bf16 v[96:99], a[148:151], v[68:71], v[96:99]
    v_cvt_pk_bf16_f32 v36, v24, v25
    v_fma_f32 v34, -v90, v34, v90
    v_mfma_f32_16x16x32_bf16 v[100:103], a[152:155], v[68:71], v[100:103]
    buffer_load_dwordx4 v43, s[32:35], s63 offen offset:1024 lds
    v_mfma_f32_16x16x32_bf16 v[92:95], a[156:159], v[72:75], v[92:95]
    ds_read_b128 v[64:67], v0 offset:33296
    v_fma_f32 v35, -v91, v35, v91
    v_mfma_f32_16x16x32_bf16 v[96:99], a[160:163], v[72:75], v[96:99]
    v_rcp_f32 v28, v28
    v_cvt_pk_bf16_f32 v37, v26, v27
    v_cvt_pk_bf16_f32 v104, v32, v33
    v_mfma_f32_16x16x32_bf16 v[100:103], a[164:167], v[72:75], v[100:103]
    v_cvt_pk_bf16_f32 v105, v34, v35
    v_rcp_f32 v29, v29
    s_waitcnt lgkmcnt(2)
    v_mfma_f32_16x16x32_bf16 v[92:95], a[168:171], v[8:11], v[92:95]
    ds_read_b128 v[68:71], v0 offset:33312
    v_rcp_f32 v30, v30
    v_mfma_f32_16x16x32_bf16 v[96:99], a[172:175], v[8:11], v[96:99]
    v_rcp_f32 v31, v31
    v_mfma_f32_16x16x32_bf16 v[100:103], a[176:179], v[8:11], v[100:103]
    v_fma_f32 v28, -v84, v28, v84
    v_fma_f32 v29, -v85, v29, v85
    v_fma_f32 v30, -v86, v30, v86
    v_fma_f32 v31, -v87, v31, v87
    v_mfma_f32_16x16x32_bf16 v[92:95], a[180:183], v[12:15], v[92:95]
    ds_read_b128 v[72:75], v0 offset:33328
    v_cvt_pk_bf16_f32 v38, v28, v29
    v_mfma_f32_16x16x32_bf16 v[96:99], a[184:187], v[12:15], v[96:99]
    v_cvt_pk_bf16_f32 v39, v30, v31
    v_mfma_f32_16x16x32_bf16 v[100:103], a[188:191], v[12:15], v[100:103]
    global_store_dwordx4 v21, v[36:39], s[26:27] offset:-4096 sc1
    s_waitcnt lgkmcnt(2)
    v_mfma_f32_16x16x32_bf16 v[80:83], a[0:3], v[48:51], v[4:7]
    ds_read_b128 v[8:11], v0 offset:33344
    s_add_u32 m0, s70, 10240
    s_add_u32 s63, s73, 212992
    buffer_load_dwordx4 v42, s[32:35], s63 offen offset:0 lds
    v_mfma_f32_16x16x32_bf16 v[84:87], a[4:7], v[48:51], v[56:59]
    v_mfma_f32_16x16x32_bf16 v[88:91], a[8:11], v[48:51], v[60:63]
    v_mfma_f32_16x16x32_bf16 v[80:83], a[12:15], v[64:67], v[80:83]
    ds_read_b128 v[12:15], v0 offset:33360
    v_mfma_f32_16x16x32_bf16 v[84:87], a[16:19], v[64:67], v[84:87]
    v_exp_f32 v24, v92
    v_mfma_f32_16x16x32_bf16 v[88:91], a[20:23], v[64:67], v[88:91]
    s_waitcnt lgkmcnt(2)
    v_mfma_f32_16x16x32_bf16 v[80:83], a[24:27], v[68:71], v[80:83]
    ds_read_b128 v[48:51], v0 offset:33376
    v_exp_f32 v25, v93
    v_mfma_f32_16x16x32_bf16 v[84:87], a[28:31], v[68:71], v[84:87]
    v_exp_f32 v26, v94
    buffer_load_dwordx4 v43, s[32:35], s63 offen offset:1024 lds
    v_mfma_f32_16x16x32_bf16 v[88:91], a[32:35], v[68:71], v[88:91]
    v_exp_f32 v27, v95
    v_mfma_f32_16x16x32_bf16 v[80:83], a[36:39], v[72:75], v[80:83]
    ds_read_b128 v[64:67], v0 offset:33392
    v_fma_f32 v24, v24, s84, s84
    v_mfma_f32_16x16x32_bf16 v[84:87], a[40:43], v[72:75], v[84:87]
    v_exp_f32 v32, v100
    v_mfma_f32_16x16x32_bf16 v[88:91], a[44:47], v[72:75], v[88:91]
    v_fma_f32 v25, v25, s84, s84
    v_exp_f32 v33, v101
    s_waitcnt lgkmcnt(2)
    v_mfma_f32_16x16x32_bf16 v[80:83], a[48:51], v[8:11], v[80:83]
    ds_read_b128 v[68:71], v0 offset:33408
    v_fma_f32 v26, v26, s84, s84
    v_exp_f32 v34, v102
    v_mfma_f32_16x16x32_bf16 v[84:87], a[52:55], v[8:11], v[84:87]
    v_exp_f32 v35, v103
    v_mfma_f32_16x16x32_bf16 v[88:91], a[56:59], v[8:11], v[88:91]
    v_fma_f32 v27, v27, s84, s84
    v_fma_f32 v24, v24, v24, 0.5
    v_mfma_f32_16x16x32_bf16 v[80:83], a[60:63], v[12:15], v[80:83]
    ds_read_b128 v[72:75], v0 offset:33424
    v_fma_f32 v32, v32, s84, s84
    v_exp_f32 v28, v96
    s_add_u32 m0, s70, 12288
    s_add_u32 s63, s73, 262144
    buffer_load_dwordx4 v42, s[32:35], s63 offen offset:0 lds
    v_mfma_f32_16x16x32_bf16 v[84:87], a[64:67], v[12:15], v[84:87]
    v_fma_f32 v25, v25, v25, 0.5
    v_fma_f32 v33, v33, s84, s84
    v_mfma_f32_16x16x32_bf16 v[88:91], a[68:71], v[12:15], v[88:91]
    v_fma_f32 v34, v34, s84, s84
    s_waitcnt lgkmcnt(2)
    v_mfma_f32_16x16x32_bf16 v[80:83], a[72:75], v[48:51], v[80:83]
    ds_read_b128 v[8:11], v0 offset:33440
    v_fma_f32 v35, v35, s84, s84
    v_exp_f32 v29, v97
    v_mfma_f32_16x16x32_bf16 v[84:87], a[76:79], v[48:51], v[84:87]
    v_fma_f32 v26, v26, v26, 0.5
    v_fma_f32 v32, v32, v32, 0.5
    v_mfma_f32_16x16x32_bf16 v[88:91], a[80:83], v[48:51], v[88:91]
    v_exp_f32 v30, v98
    v_fma_f32 v27, v27, v27, 0.5
    v_fma_f32 v33, v33, v33, 0.5
    v_mfma_f32_16x16x32_bf16 v[80:83], a[84:87], v[64:67], v[80:83]
    ds_read_b128 v[12:15], v0 offset:33456
    v_fma_f32 v34, v34, v34, 0.5
    v_mfma_f32_16x16x32_bf16 v[84:87], a[88:91], v[64:67], v[84:87]
    v_fma_f32 v35, v35, v35, 0.5
    s_waitcnt vmcnt(3)
    global_store_dword v52, v1, s[26:27] offset:0 sc1
    v_mfma_f32_16x16x32_bf16 v[88:91], a[92:95], v[64:67], v[88:91]
    buffer_load_dwordx4 v43, s[32:35], s63 offen offset:1024 lds
    s_waitcnt lgkmcnt(2)
    v_mfma_f32_16x16x32_bf16 v[80:83], a[96:99], v[68:71], v[80:83]
    ds_read_b128 v[48:51], v0 offset:33472
    v_exp_f32 v31, v99
    v_mfma_f32_16x16x32_bf16 v[84:87], a[100:103], v[68:71], v[84:87]
    v_rcp_f32 v24, v24
    v_mfma_f32_16x16x32_bf16 v[88:91], a[104:107], v[68:71], v[88:91]
    v_rcp_f32 v32, v32
    v_rcp_f32 v33, v33
    v_mfma_f32_16x16x32_bf16 v[80:83], a[108:111], v[72:75], v[80:83]
    ds_read_b128 v[64:67], v0 offset:33488
    v_fma_f32 v28, v28, s84, s84
    v_rcp_f32 v25, v25
    v_mfma_f32_16x16x32_bf16 v[84:87], a[112:115], v[72:75], v[84:87]
    v_rcp_f32 v34, v34
    v_mfma_f32_16x16x32_bf16 v[88:91], a[116:119], v[72:75], v[88:91]
    v_fma_f32 v29, v29, s84, s84
    s_waitcnt lgkmcnt(2)
    v_mfma_f32_16x16x32_bf16 v[80:83], a[120:123], v[8:11], v[80:83]
    ds_read_b128 v[68:71], v0 offset:33504
    s_add_u32 m0, s70, 14336
    s_add_u32 s63, s75, 311296
    buffer_load_dwordx4 v42, s[32:35], s63 offen offset:0 lds
    v_mfma_f32_16x16x32_bf16 v[84:87], a[124:127], v[8:11], v[84:87]
    v_rcp_f32 v26, v26
    v_mfma_f32_16x16x32_bf16 v[88:91], a[128:131], v[8:11], v[88:91]
    v_rcp_f32 v35, v35
    v_fma_f32 v30, v30, s84, s84
    v_fma_f32 v32, -v100, v32, v100
    v_mfma_f32_16x16x32_bf16 v[80:83], a[132:135], v[12:15], v[80:83]
    ds_read_b128 v[72:75], v0 offset:33520
    v_fma_f32 v33, -v101, v33, v101
    v_rcp_f32 v27, v27
    v_mfma_f32_16x16x32_bf16 v[84:87], a[136:139], v[12:15], v[84:87]
    v_fma_f32 v31, v31, s84, s84
    v_fma_f32 v24, -v92, v24, v92
    v_fma_f32 v28, v28, v28, 0.5
    v_fma_f32 v25, -v93, v25, v93
    v_mfma_f32_16x16x32_bf16 v[88:91], a[140:143], v[12:15], v[88:91]
    v_fma_f32 v29, v29, v29, 0.5
    s_waitcnt lgkmcnt(2)
    v_mfma_f32_16x16x32_bf16 v[80:83], a[144:147], v[48:51], v[80:83]
    ds_read_b128 v[8:11], v0 offset:49920
    v_fma_f32 v26, -v94, v26, v94
    v_fma_f32 v30, v30, v30, 0.5
    v_fma_f32 v27, -v95, v27, v95
    v_mfma_f32_16x16x32_bf16 v[84:87], a[148:151], v[48:51], v[84:87]
    v_fma_f32 v31, v31, v31, 0.5
    v_cvt_pk_bf16_f32 v36, v24, v25
    v_mfma_f32_16x16x32_bf16 v[88:91], a[152:155], v[48:51], v[88:91]
    buffer_load_dwordx4 v43, s[32:35], s63 offen offset:1024 lds
    v_mfma_f32_16x16x32_bf16 v[80:83], a[156:159], v[64:67], v[80:83]
    ds_read_b128 v[12:15], v0 offset:49936
    v_fma_f32 v34, -v102, v34, v102
    v_rcp_f32 v28, v28
    v_mfma_f32_16x16x32_bf16 v[84:87], a[160:163], v[64:67], v[84:87]
    v_cvt_pk_bf16_f32 v37, v26, v27
    v_fma_f32 v35, -v103, v35, v103
    v_rcp_f32 v29, v29
    v_mfma_f32_16x16x32_bf16 v[88:91], a[164:167], v[64:67], v[88:91]
    v_cvt_pk_bf16_f32 v106, v32, v33
    v_rcp_f32 v30, v30
    s_waitcnt lgkmcnt(2)
    v_mfma_f32_16x16x32_bf16 v[80:83], a[168:171], v[68:71], v[80:83]
    ds_read_b128 v[48:51], v0 offset:49952
    v_cvt_pk_bf16_f32 v107, v34, v35
    v_rcp_f32 v31, v31
    v_mfma_f32_16x16x32_bf16 v[84:87], a[172:175], v[68:71], v[84:87]
    global_store_dwordx4 v23, v[104:107], s[26:27] offset:-4096 sc1
    v_mfma_f32_16x16x32_bf16 v[88:91], a[176:179], v[68:71], v[88:91]
    v_fma_f32 v28, -v96, v28, v96
    v_fma_f32 v29, -v97, v29, v97
    v_fma_f32 v30, -v98, v30, v98
    v_fma_f32 v31, -v99, v31, v99
    v_mfma_f32_16x16x32_bf16 v[80:83], a[180:183], v[72:75], v[80:83]
    ds_read_b128 v[64:67], v0 offset:49968
    v_cvt_pk_bf16_f32 v38, v28, v29
    v_mfma_f32_16x16x32_bf16 v[84:87], a[184:187], v[72:75], v[84:87]
    v_cvt_pk_bf16_f32 v39, v30, v31
    v_mfma_f32_16x16x32_bf16 v[88:91], a[188:191], v[72:75], v[88:91]
    global_store_dwordx4 v21, v[36:39], s[26:27] offset:0 sc1
    s_waitcnt lgkmcnt(2)
    v_mfma_f32_16x16x32_bf16 v[92:95], a[0:3], v[8:11], v[4:7]
    ds_read_b128 v[68:71], v0 offset:49984
    v_mfma_f32_16x16x32_bf16 v[96:99], a[4:7], v[8:11], v[56:59]
    v_mfma_f32_16x16x32_bf16 v[100:103], a[8:11], v[8:11], v[60:63]
    v_mfma_f32_16x16x32_bf16 v[92:95], a[12:15], v[12:15], v[92:95]
    ds_read_b128 v[72:75], v0 offset:50000
    v_mfma_f32_16x16x32_bf16 v[96:99], a[16:19], v[12:15], v[96:99]
    global_load_dword v16, v3, s[26:27] offset:0 sc1
    v_mfma_f32_16x16x32_bf16 v[100:103], a[20:23], v[12:15], v[100:103]
    s_waitcnt lgkmcnt(2)
    v_mfma_f32_16x16x32_bf16 v[92:95], a[24:27], v[48:51], v[92:95]
    ds_read_b128 v[8:11], v0 offset:50016
    v_exp_f32 v24, v80
    v_mfma_f32_16x16x32_bf16 v[96:99], a[28:31], v[48:51], v[96:99]
    v_exp_f32 v25, v81
    v_exp_f32 v26, v82
    v_mfma_f32_16x16x32_bf16 v[100:103], a[32:35], v[48:51], v[100:103]
    v_exp_f32 v27, v83
    v_mfma_f32_16x16x32_bf16 v[92:95], a[36:39], v[64:67], v[92:95]
    ds_read_b128 v[12:15], v0 offset:50032
    v_fma_f32 v24, v24, s84, s84
    v_mfma_f32_16x16x32_bf16 v[96:99], a[40:43], v[64:67], v[96:99]
    v_exp_f32 v32, v88
    v_mfma_f32_16x16x32_bf16 v[100:103], a[44:47], v[64:67], v[100:103]
    v_fma_f32 v25, v25, s84, s84
    v_exp_f32 v33, v89
    s_waitcnt lgkmcnt(2)
    v_mfma_f32_16x16x32_bf16 v[92:95], a[48:51], v[68:71], v[92:95]
    ds_read_b128 v[48:51], v0 offset:50048
    v_fma_f32 v26, v26, s84, s84
    v_exp_f32 v34, v90
    v_mfma_f32_16x16x32_bf16 v[96:99], a[52:55], v[68:71], v[96:99]
    v_exp_f32 v35, v91
    v_mfma_f32_16x16x32_bf16 v[100:103], a[56:59], v[68:71], v[100:103]
    v_fma_f32 v27, v27, s84, s84
    v_fma_f32 v24, v24, v24, 0.5
    v_mfma_f32_16x16x32_bf16 v[92:95], a[60:63], v[72:75], v[92:95]
    ds_read_b128 v[64:67], v0 offset:50064
    v_fma_f32 v32, v32, s84, s84
    v_exp_f32 v28, v84
    v_mfma_f32_16x16x32_bf16 v[96:99], a[64:67], v[72:75], v[96:99]
    v_fma_f32 v25, v25, v25, 0.5
    v_fma_f32 v33, v33, s84, s84
    v_mfma_f32_16x16x32_bf16 v[100:103], a[68:71], v[72:75], v[100:103]
    v_fma_f32 v34, v34, s84, s84
    s_waitcnt lgkmcnt(2)
    v_mfma_f32_16x16x32_bf16 v[92:95], a[72:75], v[8:11], v[92:95]
    ds_read_b128 v[68:71], v0 offset:50080
    v_fma_f32 v35, v35, s84, s84
    v_exp_f32 v29, v85
    v_mfma_f32_16x16x32_bf16 v[96:99], a[76:79], v[8:11], v[96:99]
    v_fma_f32 v26, v26, v26, 0.5
    v_fma_f32 v32, v32, v32, 0.5
    v_mfma_f32_16x16x32_bf16 v[100:103], a[80:83], v[8:11], v[100:103]
    v_exp_f32 v30, v86
    s_waitcnt vmcnt(0)
L_F0_s:
    v_cmp_ne_u32 vcc, s52, v16
    s_cbranch_vccnz L_F0_retry_s
L_F0_ok_s:
    s_barrier
    v_mfma_f32_16x16x32_bf16 v[92:95], a[84:87], v[12:15], v[92:95]
    ds_read_b128 v[72:75], v0 offset:50096
    s_add_u32 s62, s91, 0
    buffer_load_dwordx4 v[112:115], v20, s[36:39], s62 offen offset:0 sc1
    v_mfma_f32_16x16x32_bf16 v[96:99], a[88:91], v[12:15], v[96:99]
    v_fma_f32 v27, v27, v27, 0.5
    v_fma_f32 v33, v33, v33, 0.5
    v_mfma_f32_16x16x32_bf16 v[100:103], a[92:95], v[12:15], v[100:103]
    v_fma_f32 v34, v34, v34, 0.5
    s_waitcnt lgkmcnt(2)
    v_mfma_f32_16x16x32_bf16 v[92:95], a[96:99], v[48:51], v[92:95]
    ds_read_b128 v[8:11], v0 offset:50112
    v_fma_f32 v35, v35, v35, 0.5
    v_exp_f32 v31, v87
    buffer_load_dwordx4 v[116:119], v20, s[36:39], s62 offen offset:1024 sc1
    v_mfma_f32_16x16x32_bf16 v[96:99], a[100:103], v[48:51], v[96:99]
    v_rcp_f32 v24, v24
    v_mfma_f32_16x16x32_bf16 v[100:103], a[104:107], v[48:51], v[100:103]
    v_fma_f32 v28, v28, s84, s84
    v_rcp_f32 v25, v25
    global_store_dword v52, v1, s[26:27] offset:128 sc1
    v_mfma_f32_16x16x32_bf16 v[92:95], a[108:111], v[64:67], v[92:95]
    ds_read_b128 v[12:15], v0 offset:50128
    v_fma_f32 v29, v29, s84, s84
    v_rcp_f32 v26, v26
    buffer_load_dwordx4 v[120:123], v20, s[36:39], s62 offen offset:2048 sc1
    v_mfma_f32_16x16x32_bf16 v[96:99], a[112:115], v[64:67], v[96:99]
    v_rcp_f32 v32, v32
    v_mfma_f32_16x16x32_bf16 v[100:103], a[116:119], v[64:67], v[100:103]
    v_fma_f32 v30, v30, s84, s84
    s_waitcnt lgkmcnt(2)
    v_mfma_f32_16x16x32_bf16 v[92:95], a[120:123], v[68:71], v[92:95]
    ds_read_b128 v[48:51], v0 offset:50144
    buffer_load_dwordx4 v[124:127], v20, s[36:39], s62 offen offset:3072 sc1
    v_mfma_f32_16x16x32_bf16 v[96:99], a[124:127], v[68:71], v[96:99]
    v_rcp_f32 v27, v27
    v_mfma_f32_16x16x32_bf16 v[100:103], a[128:131], v[68:71], v[100:103]
    v_rcp_f32 v33, v33
    v_rcp_f32 v34, v34
    v_mfma_f32_16x16x32_bf16 v[92:95], a[132:135], v[72:75], v[92:95]
    ds_read_b128 v[64:67], v0 offset:50160
    v_rcp_f32 v35, v35
    s_add_u32 s62, s94, 0
    buffer_load_dwordx4 v[128:131], v20, s[36:39], s62 offen offset:0 sc1
    v_mfma_f32_16x16x32_bf16 v[96:99], a[136:139], v[72:75], v[96:99]
    v_fma_f32 v31, v31, s84, s84
    v_fma_f32 v24, -v80, v24, v80
    v_fma_f32 v28, v28, v28, 0.5
    v_fma_f32 v25, -v81, v25, v81
    v_mfma_f32_16x16x32_bf16 v[100:103], a[140:143], v[72:75], v[100:103]
    v_fma_f32 v29, v29, v29, 0.5
    s_waitcnt lgkmcnt(2)
    v_mfma_f32_16x16x32_bf16 v[92:95], a[144:147], v[8:11], v[92:95]
    v_fma_f32 v26, -v82, v26, v82
    v_fma_f32 v30, v30, v30, 0.5
    buffer_load_dwordx4 v[132:135], v20, s[36:39], s62 offen offset:1024 sc1
    v_mfma_f32_16x16x32_bf16 v[96:99], a[148:151], v[8:11], v[96:99]
    v_fma_f32 v27, -v83, v27, v83
    v_fma_f32 v31, v31, v31, 0.5
    v_mfma_f32_16x16x32_bf16 v[100:103], a[152:155], v[8:11], v[100:103]
    v_cvt_pk_bf16_f32 v36, v24, v25
    v_fma_f32 v32, -v88, v32, v88
    v_mfma_f32_16x16x32_bf16 v[92:95], a[156:159], v[12:15], v[92:95]
    v_rcp_f32 v28, v28
    buffer_load_dwordx4 v[136:139], v20, s[36:39], s62 offen offset:2048 sc1
    v_mfma_f32_16x16x32_bf16 v[96:99], a[160:163], v[12:15], v[96:99]
    v_cvt_pk_bf16_f32 v37, v26, v27
    v_fma_f32 v33, -v89, v33, v89
    v_rcp_f32 v29, v29
    v_mfma_f32_16x16x32_bf16 v[100:103], a[164:167], v[12:15], v[100:103]
    v_fma_f32 v34, -v90, v34, v90
    v_rcp_f32 v30, v30
    s_waitcnt lgkmcnt(0)
    v_mfma_f32_16x16x32_bf16 v[92:95], a[168:171], v[48:51], v[92:95]
    v_rcp_f32 v31, v31
    buffer_load_dwordx4 v[140:143], v20, s[36:39], s62 offen offset:3072 sc1
    v_mfma_f32_16x16x32_bf16 v[96:99], a[172:175], v[48:51], v[96:99]
    v_fma_f32 v28, -v84, v28, v84
    v_fma_f32 v29, -v85, v29, v85
    v_mfma_f32_16x16x32_bf16 v[100:103], a[176:179], v[48:51], v[100:103]
    v_fma_f32 v30, -v86, v30, v86
    v_fma_f32 v31, -v87, v31, v87
    v_cvt_pk_bf16_f32 v38, v28, v29
    v_cvt_pk_bf16_f32 v39, v30, v31
    v_mfma_f32_16x16x32_bf16 v[92:95], a[180:183], v[64:67], v[92:95]
    global_store_dwordx4 v22, v[36:39], s[26:27] offset:-4096 sc1
    v_mfma_f32_16x16x32_bf16 v[96:99], a[184:187], v[64:67], v[96:99]
    v_fma_f32 v35, -v91, v35, v91
    v_cvt_pk_bf16_f32 v104, v32, v33
    v_mfma_f32_16x16x32_bf16 v[100:103], a[188:191], v[64:67], v[100:103]
    v_cvt_pk_bf16_f32 v105, v34, v35
    s_nop 1
    v_exp_f32 v24, v92
    v_exp_f32 v25, v93
    v_exp_f32 v26, v94
    v_exp_f32 v27, v95
    v_exp_f32 v28, v96
    v_exp_f32 v29, v97
    v_exp_f32 v30, v98
    v_exp_f32 v31, v99
    v_exp_f32 v32, v100
    v_exp_f32 v33, v101
    v_exp_f32 v34, v102
    v_exp_f32 v35, v103
    v_pk_fma_f32 v[24:25], v[24:25], s[84:85], s[84:85] op_sel_hi:[1,0,0]
    v_pk_fma_f32 v[26:27], v[26:27], s[84:85], s[84:85] op_sel_hi:[1,0,0]
    v_pk_fma_f32 v[28:29], v[28:29], s[84:85], s[84:85] op_sel_hi:[1,0,0]
    v_pk_fma_f32 v[30:31], v[30:31], s[84:85], s[84:85] op_sel_hi:[1,0,0]
    v_pk_fma_f32 v[32:33], v[32:33], s[84:85], s[84:85] op_sel_hi:[1,0,0]
    v_pk_fma_f32 v[34:35], v[34:35], s[84:85], s[84:85] op_sel_hi:[1,0,0]
    v_pk_fma_f32 v[24:25], v[24:25], v[24:25], s[84:85] op_sel:[0,0,1] op_sel_hi:[1,1,1]
    v_pk_fma_f32 v[26:27], v[26:27], v[26:27], s[84:85] op_sel:[0,0,1] op_sel_hi:[1,1,1]
    global_load_dword v16, v3, s[26:27] offset:128 sc1
    v_pk_fma_f32 v[28:29], v[28:29], v[28:29], s[84:85] op_sel:[0,0,1] op_sel_hi:[1,1,1]
    v_pk_fma_f32 v[30:31], v[30:31], v[30:31], s[84:85] op_sel:[0,0,1] op_sel_hi:[1,1,1]
    v_pk_fma_f32 v[32:33], v[32:33], v[32:33], s[84:85] op_sel:[0,0,1] op_sel_hi:[1,1,1]
    v_pk_fma_f32 v[34:35], v[34:35], v[34:35], s[84:85] op_sel:[0,0,1] op_sel_hi:[1,1,1]
    v_rcp_f32 v24, v24
    v_rcp_f32 v25, v25
    v_rcp_f32 v26, v26
    v_rcp_f32 v27, v27
    v_pk_fma_f32 v[24:25], v[92:93], v[24:25], v[92:93] neg_lo:[1,0,0] neg_hi:[1,0,0]
    v_pk_fma_f32 v[26:27], v[94:95], v[26:27], v[94:95] neg_lo:[1,0,0] neg_hi:[1,0,0]
    v_cvt_pk_bf16_f32 v36, v24, v25
    v_cvt_pk_bf16_f32 v37, v26, v27
    v_rcp_f32 v28, v28
    v_rcp_f32 v29, v29
    v_rcp_f32 v30, v30
    v_rcp_f32 v31, v31
    v_pk_fma_f32 v[28:29], v[96:97], v[28:29], v[96:97] neg_lo:[1,0,0] neg_hi:[1,0,0]
    v_pk_fma_f32 v[30:31], v[98:99], v[30:31], v[98:99] neg_lo:[1,0,0] neg_hi:[1,0,0]
    v_cvt_pk_bf16_f32 v38, v28, v29
    v_cvt_pk_bf16_f32 v39, v30, v31
    global_store_dwordx4 v22, v[36:39], s[26:27] offset:0 sc1
    v_rcp_f32 v32, v32
    v_rcp_f32 v33, v33
    v_rcp_f32 v34, v34
    v_rcp_f32 v35, v35
    v_pk_fma_f32 v[32:33], v[100:101], v[32:33], v[100:101] neg_lo:[1,0,0] neg_hi:[1,0,0]
    v_pk_fma_f32 v[34:35], v[102:103], v[34:35], v[102:103] neg_lo:[1,0,0] neg_hi:[1,0,0]
    v_cvt_pk_bf16_f32 v106, v32, v33
    v_cvt_pk_bf16_f32 v107, v34, v35
    global_store_dwordx4 v23, v[104:107], s[26:27] offset:0 sc1
    ds_read_b128 v[68:71], v2 offset:0
    ds_read_b128 v[72:75], v2 offset:16
    v_add_u32 v27, 32768, v40
    s_barrier
    s_waitcnt vmcnt(12)
    v_mfma_f32_16x16x32_bf16 a[96:99], a[192:195], v[112:115], 0
    s_waitcnt vmcnt(2)
L_F1_s:
    v_cmp_ne_u32 vcc, s52, v16
    s_cbranch_vccnz L_F1_retry_s
L_F1_ok_s:
    global_store_dword v52, v1, s[26:27] offset:256 sc1
    ds_read_b64_tr_b16 v[192:193], v44 offset:0
    v_mfma_f32_16x16x32_bf16 a[100:103], a[196:199], v[112:115], 0
    ds_read_b64_tr_b16 v[196:197], v45 offset:0
    v_mfma_f32_16x16x32_bf16 a[104:107], a[200:203], v[112:115], 0
    v_lshrrev_b32 v24, 1, v19
    s_add_u32 s62, s91, 4096
    buffer_load_dwordx4 a[0:3], v20, s[36:39], s62 offen offset:0 sc1
    v_mfma_f32_16x16x32_bf16 a[108:111], a[204:207], v[112:115], 0
    v_lshl_add_u32 v24, v24, 1, v18
    ds_read_b64_tr_b16 v[200:201], v46 offset:0
    v_mfma_f32_16x16x32_bf16 a[96:99], a[208:211], v[116:119], a[96:99]
    buffer_load_dwordx4 a[4:7], v20, s[36:39], s62 offen offset:1024 sc1
    v_mfma_f32_16x16x32_bf16 a[100:103], a[212:215], v[116:119], a[100:103]
    ds_read_b64_tr_b16 v[204:205], v47 offset:0
    v_mfma_f32_16x16x32_bf16 a[104:107], a[216:219], v[116:119], a[104:107]
    buffer_load_dwordx4 a[8:11], v20, s[36:39], s62 offen offset:2048 sc1
    v_mfma_f32_16x16x32_bf16 a[108:111], a[220:223], v[116:119], a[108:111]
    s_lshl_b32 s58, s53, 12
    ds_read_b64_tr_b16 v[194:195], v44 offset:2048
    v_mfma_f32_16x16x32_bf16 a[96:99], a[224:227], v[120:123], a[96:99]
    buffer_load_dwordx4 a[12:15], v20, s[36:39], s62 offen offset:3072 sc1
    ds_read_b64_tr_b16 v[198:199], v45 offset:2048
    v_mfma_f32_16x16x32_bf16 a[100:103], a[228:231], v[120:123], a[100:103]
    v_lshl_add_u32 v25, v19, 8, s58
    s_add_u32 s60, s53, 0
    v_mfma_f32_16x16x32_bf16 a[104:107], a[232:235], v[120:123], a[104:107]
    s_and_b32 s60, s60, 3
    s_add_u32 s62, s94, 4096
    buffer_load_dwordx4 a[16:19], v20, s[36:39], s62 offen offset:0 sc1
    ds_read_b64_tr_b16 v[202:203], v46 offset:2048
    v_mfma_f32_16x16x32_bf16 a[108:111], a[236:239], v[120:123], a[108:111]
    v_lshl_add_u32 v26, s60, 2, v24
    v_mfma_f32_16x16x32_bf16 a[96:99], a[240:243], v[124:127], a[96:99]
    buffer_load_dwordx4 a[20:23], v20, s[36:39], s62 offen offset:1024 sc1
    ds_read_b64_tr_b16 v[206:207], v47 offset:2048
    v_mfma_f32_16x16x32_bf16 a[100:103], a[244:247], v[124:127], a[100:103]
    v_and_b32 v26, 15, v26
    v_lshl_add_u32 v26, v26, 4, v25
    v_mfma_f32_16x16x32_bf16 a[104:107], a[248:251], v[124:127], a[104:107]
    ds_read_b64_tr_b16 v[208:209], v44 offset:4096
    v_mfma_f32_16x16x32_bf16 a[108:111], a[252:255], v[124:127], a[108:111]
    v_lshl_add_u32 v4, s60, 10, v26
    ds_read_b64_tr_b16 v[212:213], v45 offset:4096
    v_mfma_f32_16x16x32_bf16 a[96:99], v[144:147], v[128:131], a[96:99]
    global_load_dword v16, v3, s[26:27] offset:256 sc1
    buffer_load_dwordx4 a[24:27], v20, s[36:39], s62 offen offset:2048 sc1
    v_mfma_f32_16x16x32_bf16 a[100:103], v[148:151], v[128:131], a[100:103]
    ds_read_b64_tr_b16 v[216:217], v46 offset:4096
    v_mfma_f32_16x16x32_bf16 a[104:107], v[152:155], v[128:131], a[104:107]
    s_add_u32 s60, s53, 1
    s_and_b32 s60, s60, 3
    v_mfma_f32_16x16x32_bf16 a[108:111], v[156:159], v[128:131], a[108:111]
    v_lshl_add_u32 v26, s60, 2, v24
    ds_read_b64_tr_b16 v[220:221], v47 offset:4096
    v_mfma_f32_16x16x32_bf16 a[96:99], v[160:163], v[132:135], a[96:99]
    buffer_load_dwordx4 a[28:31], v20, s[36:39], s62 offen offset:3072 sc1
    v_mfma_f32_16x16x32_bf16 a[100:103], v[164:167], v[132:135], a[100:103]
    ds_read_b64_tr_b16 v[210:211], v44 offset:6144
    v_mfma_f32_16x16x32_bf16 a[104:107], v[168:171], v[132:135], a[104:107]
    v_and_b32 v26, 15, v26
    s_waitcnt vmcnt(10)
    global_store_dword v52, v1, s[26:27] offset:384 sc1
    ds_read_b64_tr_b16 v[214:215], v45 offset:6144
    v_mfma_f32_16x16x32_bf16 a[108:111], v[172:175], v[132:135], a[108:111]
    v_mfma_f32_16x16x32_bf16 a[96:99], v[176:179], v[136:139], a[96:99]
    s_add_u32 s62, s93, 0
    buffer_load_dwordx4 v[8:11], v20, s[36:39], s62 offen offset:0 sc1
    ds_read_b64_tr_b16 v[218:219], v46 offset:6144
    v_mfma_f32_16x16x32_bf16 a[100:103], v[180:183], v[136:139], a[100:103]
    v_mfma_f32_16x16x32_bf16 a[104:107], v[184:187], v[136:139], a[104:107]
    ds_read_b64_tr_b16 v[222:223], v47 offset:6144
    v_mfma_f32_16x16x32_bf16 a[108:111], v[188:191], v[136:139], a[108:111]
    buffer_load_dwordx4 v[12:15], v20, s[36:39], s62 offen offset:1024 sc1
    s_waitcnt lgkmcnt(11)
    v_mfma_f32_16x16x32_bf16 a[96:99], v[192:195], v[140:143], a[96:99]
    s_waitcnt lgkmcnt(10)
    v_mfma_f32_16x16x32_bf16 a[100:103], v[196:199], v[140:143], a[100:103]
    s_waitcnt lgkmcnt(9)
    v_mfma_f32_16x16x32_bf16 a[104:107], v[200:203], v[140:143], a[104:107]
    s_waitcnt lgkmcnt(8)
    v_mfma_f32_16x16x32_bf16 a[108:111], v[204:207], v[140:143], a[108:111]
    s_waitcnt vmcnt(11)
    v_mfma_f32_16x16x32_bf16 a[112:115], a[192:195], a[0:3], 0
    buffer_load_dwordx4 v[48:51], v20, s[36:39], s62 offen offset:2048 sc1
    ds_read_b64_tr_b16 v[224:225], v44 offset:8192
    v_mfma_f32_16x16x32_bf16 a[116:119], a[196:199], a[0:3], 0
    v_lshl_add_u32 v26, v26, 4, v25
    v_lshl_add_u32 v5, s60, 10, v26
    v_mfma_f32_16x16x32_bf16 a[120:123], a[200:203], a[0:3], 0
    ds_read_b64_tr_b16 v[228:229], v45 offset:8192
    v_mfma_f32_16x16x32_bf16 a[124:127], a[204:207], a[0:3], 0
    s_add_u32 s62, s96, 0
    buffer_load_dwordx4 v[56:59], v20, s[36:39], s62 offen offset:0 sc1
    s_waitcnt vmcnt(12)
    v_mfma_f32_16x16x32_bf16 a[112:115], a[208:211], a[4:7], a[112:115]
    ds_read_b64_tr_b16 v[232:233], v46 offset:8192
    v_mfma_f32_16x16x32_bf16 a[116:119], a[212:215], a[4:7], a[116:119]
    s_add_u32 s60, s53, 2
    s_and_b32 s60, s60, 3
    v_mfma_f32_16x16x32_bf16 a[120:123], a[216:219], a[4:7], a[120:123]
    ds_read_b64_tr_b16 v[236:237], v47 offset:8192
    v_mfma_f32_16x16x32_bf16 a[124:127], a[220:223], a[4:7], a[124:127]
    v_lshl_add_u32 v26, s60, 2, v24
    s_waitcnt vmcnt(11)
    v_mfma_f32_16x16x32_bf16 a[112:115], a[224:227], a[8:11], a[112:115]
    buffer_load_dwordx4 v[60:63], v20, s[36:39], s62 offen offset:1024 sc1
    ds_read_b64_tr_b16 v[226:227], v44 offset:10240
    v_mfma_f32_16x16x32_bf16 a[116:119], a[228:231], a[8:11], a[116:119]
    v_and_b32 v26, 15, v26
    v_lshl_add_u32 v26, v26, 4, v25
    v_mfma_f32_16x16x32_bf16 a[120:123], a[232:235], a[8:11], a[120:123]
    ds_read_b64_tr_b16 v[230:231], v45 offset:10240
    v_mfma_f32_16x16x32_bf16 a[124:127], a[236:239], a[8:11], a[124:127]
    v_lshl_add_u32 v6, s60, 10, v26
    buffer_load_dwordx4 v[64:67], v20, s[36:39], s62 offen offset:2048 sc1
    s_waitcnt vmcnt(12)
    v_mfma_f32_16x16x32_bf16 a[112:115], a[240:243], a[12:15], a[112:115]
    ds_read_b64_tr_b16 v[234:235], v46 offset:10240
    v_mfma_f32_16x16x32_bf16 a[116:119], a[244:247], a[12:15], a[116:119]
    s_add_u32 s60, s53, 3
    s_and_b32 s60, s60, 3
    v_mfma_f32_16x16x32_bf16 a[120:123], a[248:251], a[12:15], a[120:123]
    s_waitcnt vmcnt(9)
L_F2_s:
    v_cmp_ne_u32 vcc, s52, v16
    s_cbranch_vccnz L_F2_retry_s
L_F2_ok_s:
    ds_read_b64_tr_b16 v[238:239], v47 offset:10240
    v_mfma_f32_16x16x32_bf16 a[124:127], a[252:255], a[12:15], a[124:127]
    global_load_dword v16, v3, s[26:27] offset:384 sc1
    v_mfma_f32_16x16x32_bf16 a[112:115], v[144:147], a[16:19], a[112:115]
    s_add_u32 s62, s92, 0
    buffer_load_dwordx4 a[32:35], v20, s[36:39], s62 offen offset:0 sc1
    ds_read_b64_tr_b16 v[240:241], v44 offset:12288
    v_mfma_f32_16x16x32_bf16 a[116:119], v[148:151], a[16:19], a[116:119]
    v_mfma_f32_16x16x32_bf16 a[120:123], v[152:155], a[16:19], a[120:123]
    ds_read_b64_tr_b16 v[244:245], v45 offset:12288
    v_mfma_f32_16x16x32_bf16 a[124:127], v[156:159], a[16:19], a[124:127]
    v_mfma_f32_16x16x32_bf16 a[112:115], v[160:163], a[20:23], a[112:115]
    buffer_load_dwordx4 a[36:39], v20, s[36:39], s62 offen offset:1024 sc1
    ds_read_b64_tr_b16 v[248:249], v46 offset:12288
    v_mfma_f32_16x16x32_bf16 a[116:119], v[164:167], a[20:23], a[116:119]
    global_load_dwordx4 v[32:35], v40, s[26:27] sc1
    v_mfma_f32_16x16x32_bf16 a[120:123], v[168:171], a[20:23], a[120:123]
    global_load_dwordx4 v[36:39], v27, s[26:27] sc1
    ds_read_b64_tr_b16 v[252:253], v47 offset:12288
    v_mfma_f32_16x16x32_bf16 a[124:127], v[172:175], a[20:23], a[124:127]
    s_waitcnt vmcnt(13)
    v_mfma_f32_16x16x32_bf16 a[112:115], v[176:179], a[24:27], a[112:115]
    buffer_load_dwordx4 a[40:43], v20, s[36:39], s62 offen offset:2048 sc1
    ds_read_b64_tr_b16 v[242:243], v44 offset:14336
    v_mfma_f32_16x16x32_bf16 a[116:119], v[180:183], a[24:27], a[116:119]
    v_mfma_f32_16x16x32_bf16 a[120:123], v[184:187], a[24:27], a[120:123]
    ds_read_b64_tr_b16 v[246:247], v45 offset:14336
    v_mfma_f32_16x16x32_bf16 a[124:127], v[188:191], a[24:27], a[124:127]
    s_waitcnt vmcnt(13)
    v_mfma_f32_16x16x32_bf16 a[112:115], v[192:195], a[28:31], a[112:115]
    buffer_load_dwordx4 a[44:47], v20, s[36:39], s62 offen offset:3072 sc1
    ds_read_b64_tr_b16 v[250:251], v46 offset:14336
    v_mfma_f32_16x16x32_bf16 a[116:119], v[196:199], a[28:31], a[116:119]
    v_mfma_f32_16x16x32_bf16 a[120:123], v[200:203], a[28:31], a[120:123]
    s_waitcnt vmcnt(11)
    v_swap_b32 v10, v12
    v_swap_b32 v11, v13
    ds_read_b64_tr_b16 v[254:255], v47 offset:14336
    v_mfma_f32_16x16x32_bf16 a[124:127], v[204:207], a[28:31], a[124:127]
    s_waitcnt lgkmcnt(15)
    v_mfma_f32_16x16x32_bf16 a[96:99], v[208:211], v[8:11], a[96:99]
    v_lshl_add_u32 v26, s60, 2, v24
    s_add_u32 s62, s95, 0
    buffer_load_dwordx4 a[48:51], v20, s[36:39], s62 offen offset:0 sc1
    s_waitcnt lgkmcnt(15)
    v_mfma_f32_16x16x32_bf16 a[100:103], v[212:215], v[8:11], a[100:103]
    v_and_b32 v26, 15, v26
    v_lshl_add_u32 v26, v26, 4, v25
    s_waitcnt lgkmcnt(15)
    v_mfma_f32_16x16x32_bf16 a[104:107], v[216:219], v[8:11], a[104:107]
    v_lshl_add_u32 v7, s60, 10, v26
    v_lshrrev_b32 v24, 3, v17
    s_waitcnt lgkmcnt(15)
    v_mfma_f32_16x16x32_bf16 a[108:111], v[220:223], v[8:11], a[108:111]
    v_and_b32 v25, 7, v17
    s_and_b32 s60, s53, 1
    v_mfma_f32_16x16x32_bf16 a[112:115], v[208:211], v[12:15], a[112:115]
    buffer_load_dwordx4 a[52:55], v20, s[36:39], s62 offen offset:1024 sc1
    v_mfma_f32_16x16x32_bf16 a[116:119], v[212:215], v[12:15], a[116:119]
    s_lshl_b32 s58, s60, 3
    v_lshl_add_u32 v26, v25, 1, v24
    v_mfma_f32_16x16x32_bf16 a[120:123], v[216:219], v[12:15], a[120:123]
    s_waitcnt vmcnt(11)
    v_swap_b32 v50, v56
    v_swap_b32 v51, v57
    v_mfma_f32_16x16x32_bf16 a[124:127], v[220:223], v[12:15], a[124:127]
    v_add_u32 v26, s58, v26
    v_and_b32 v26, 15, v26
    s_waitcnt lgkmcnt(11)
    v_mfma_f32_16x16x32_bf16 a[96:99], v[224:227], v[48:51], a[96:99]
    buffer_load_dwordx4 a[56:59], v20, s[36:39], s62 offen offset:2048 sc1
    s_waitcnt lgkmcnt(10)
    v_mfma_f32_16x16x32_bf16 a[100:103], v[228:231], v[48:51], a[100:103]
    v_lshlrev_b32 v26, 4, v26
    v_lshl_add_u32 v26, v25, 9, v26
    s_waitcnt lgkmcnt(9)
    v_mfma_f32_16x16x32_bf16 a[104:107], v[232:235], v[48:51], a[104:107]
    s_lshr_b32 s58, s53, 1
    s_lshl_b32 s58, s58, 14
    s_waitcnt lgkmcnt(8)
    v_mfma_f32_16x16x32_bf16 a[108:111], v[236:239], v[48:51], a[108:111]
    v_add_u32 v41, s58, v26
    v_lshrrev_b32 v26, 1, v24
    v_mfma_f32_16x16x32_bf16 a[112:115], v[224:227], v[56:59], a[112:115]
    v_lshlrev_b32 v26, 15, v26
    s_waitcnt vmcnt(9)
L_F3_s:
    v_cmp_ne_u32 vcc, s52, v16
    s_cbranch_vccnz L_F3_retry_s
L_F3_ok_s:
    buffer_load_dwordx4 a[60:63], v20, s[36:39], s62 offen offset:3072 sc1
    v_mfma_f32_16x16x32_bf16 a[116:119], v[228:231], v[56:59], a[116:119]
    v_and_b32 v24, 1, v24
    v_lshl_add_u32 v26, v24, 10, v26
    v_mfma_f32_16x16x32_bf16 a[120:123], v[232:235], v[56:59], a[120:123]
    v_swap_b32 v62, v64
    v_swap_b32 v63, v65
    v_mfma_f32_16x16x32_bf16 a[124:127], v[236:239], v[56:59], a[124:127]
    v_lshl_add_u32 v26, v25, 4, v26
    s_lshl_b32 s60, s53, 18
    s_waitcnt lgkmcnt(3)
    v_mfma_f32_16x16x32_bf16 a[96:99], v[240:243], v[60:63], a[96:99]
    s_lshr_b32 s58, s55, 4
    s_add_u32 s62, s93, 4096
    buffer_load_dwordx4 v[84:87], v20, s[36:39], s62 offen offset:0 sc1
    s_waitcnt lgkmcnt(2)
    v_mfma_f32_16x16x32_bf16 a[100:103], v[244:247], v[60:63], a[100:103]
    s_lshl_b32 s58, s58, 17
    s_add_u32 s60, s60, s58
    s_waitcnt lgkmcnt(1)
    v_mfma_f32_16x16x32_bf16 a[104:107], v[248:251], v[60:63], a[104:107]
    buffer_load_dwordx4 v[88:91], v20, s[36:39], s62 offen offset:1024 sc1
    s_waitcnt lgkmcnt(0)
    v_mfma_f32_16x16x32_bf16 a[108:111], v[252:255], v[60:63], a[108:111]
    s_and_b32 s58, s55, 15
    s_lshl_b32 s58, s58, 11
    v_mfma_f32_16x16x32_bf16 a[112:115], v[240:243], v[64:67], a[112:115]
    buffer_load_dwordx4 v[92:95], v20, s[36:39], s62 offen offset:2048 sc1
    v_mfma_f32_16x16x32_bf16 a[116:119], v[244:247], v[64:67], a[116:119]
    s_add_u32 s60, s60, s58
    s_lshl_b32 s58, s56, 7
    v_mfma_f32_16x16x32_bf16 a[120:123], v[248:251], v[64:67], a[120:123]
    s_add_u32 s60, s60, s58
    s_add_u32 s62, s96, 4096
    buffer_load_dwordx4 v[96:99], v20, s[36:39], s62 offen offset:0 sc1
    v_mfma_f32_16x16x32_bf16 a[124:127], v[252:255], v[64:67], a[124:127]
    v_add_u32 v42, s60, v26
    v_add_u32 v43, 1048576, v42
    s_waitcnt vmcnt(13)
    v_mfma_f32_16x16x32_bf16 a[128:131], a[192:195], a[32:35], 0
    buffer_load_dwordx4 v[100:103], v20, s[36:39], s62 offen offset:1024 sc1
    v_mfma_f32_16x16x32_bf16 a[132:135], a[196:199], a[32:35], 0
    v_mfma_f32_16x16x32_bf16 a[136:139], a[200:203], a[32:35], 0
    buffer_load_dwordx4 v[104:107], v20, s[36:39], s62 offen offset:2048 sc1
    ds_write_b128 v4, a[96:99] offset:0
    v_mfma_f32_16x16x32_bf16 a[140:143], a[204:207], a[32:35], 0
    s_waitcnt vmcnt(14)
    v_mfma_f32_16x16x32_bf16 a[128:131], a[208:211], a[36:39], a[128:131]
    s_add_u32 s62, s92, 4096
    buffer_load_dwordx4 a[64:67], v20, s[36:39], s62 offen offset:0 sc1
    v_mfma_f32_16x16x32_bf16 a[132:135], a[212:215], a[36:39], a[132:135]
    ds_write_b128 v5, a[100:103] offset:0
    v_mfma_f32_16x16x32_bf16 a[136:139], a[216:219], a[36:39], a[136:139]
    v_mfma_f32_16x16x32_bf16 a[140:143], a[220:223], a[36:39], a[140:143]
    s_waitcnt vmcnt(12)
    v_mfma_f32_16x16x32_bf16 a[128:131], a[224:227], a[40:43], a[128:131]
    buffer_load_dwordx4 a[68:71], v20, s[36:39], s62 offen offset:1024 sc1
    ds_write_b128 v6, a[104:107] offset:0
    v_mfma_f32_16x16x32_bf16 a[132:135], a[228:231], a[40:43], a[132:135]
    v_mfma_f32_16x16x32_bf16 a[136:139], a[232:235], a[40:43], a[136:139]
    v_mfma_f32_16x16x32_bf16 a[140:143], a[236:239], a[40:43], a[140:143]
    ds_write_b128 v7, a[108:111] offset:0
    s_waitcnt vmcnt(12)
    v_mfma_f32_16x16x32_bf16 a[128:131], a[240:243], a[44:47], a[128:131]
    buffer_load_dwordx4 a[72:75], v20, s[36:39], s62 offen offset:2048 sc1
    v_mfma_f32_16x16x32_bf16 a[132:135], a[244:247], a[44:47], a[132:135]
    v_mfma_f32_16x16x32_bf16 a[136:139], a[248:251], a[44:47], a[136:139]
    ds_write_b128 v4, a[112:115] offset:16384
    v_mfma_f32_16x16x32_bf16 a[140:143], a[252:255], a[44:47], a[140:143]
    s_waitcnt vmcnt(12)
    v_mfma_f32_16x16x32_bf16 a[128:131], v[144:147], a[48:51], a[128:131]
    buffer_load_dwordx4 a[76:79], v20, s[36:39], s62 offen offset:3072 sc1
    v_mfma_f32_16x16x32_bf16 a[132:135], v[148:151], a[48:51], a[132:135]
    ds_write_b128 v5, a[116:119] offset:16384
    v_mfma_f32_16x16x32_bf16 a[136:139], v[152:155], a[48:51], a[136:139]
    v_mfma_f32_16x16x32_bf16 a[140:143], v[156:159], a[48:51], a[140:143]
    s_waitcnt vmcnt(12)
    v_mfma_f32_16x16x32_bf16 a[128:131], v[160:163], a[52:55], a[128:131]
    s_add_u32 s62, s95, 4096
    buffer_load_dwordx4 a[80:83], v20, s[36:39], s62 offen offset:0 sc1
    ds_write_b128 v6, a[120:123] offset:16384
    v_mfma_f32_16x16x32_bf16 a[132:135], v[164:167], a[52:55], a[132:135]
    v_mfma_f32_16x16x32_bf16 a[136:139], v[168:171], a[52:55], a[136:139]
    v_mfma_f32_16x16x32_bf16 a[140:143], v[172:175], a[52:55], a[140:143]
    ds_write_b128 v7, a[124:127] offset:16384
    s_waitcnt vmcnt(12)
    v_mfma_f32_16x16x32_bf16 a[128:131], v[176:179], a[56:59], a[128:131]
    buffer_load_dwordx4 a[84:87], v20, s[36:39], s62 offen offset:1024 sc1
    v_mfma_f32_16x16x32_bf16 a[132:135], v[180:183], a[56:59], a[132:135]
    v_mfma_f32_16x16x32_bf16 a[136:139], v[184:187], a[56:59], a[136:139]
    v_mfma_f32_16x16x32_bf16 a[140:143], v[188:191], a[56:59], a[140:143]
    s_waitcnt vmcnt(12)
    v_mfma_f32_16x16x32_bf16 a[128:131], v[192:195], a[60:63], a[128:131]
    buffer_load_dwordx4 a[88:91], v20, s[36:39], s62 offen offset:2048 sc1
    v_mfma_f32_16x16x32_bf16 a[132:135], v[196:199], a[60:63], a[132:135]
    v_mfma_f32_16x16x32_bf16 a[136:139], v[200:203], a[60:63], a[136:139]
    s_waitcnt vmcnt(11)
    v_swap_b32 v86, v88
    v_swap_b32 v87, v89
    v_mfma_f32_16x16x32_bf16 a[140:143], v[204:207], a[60:63], a[140:143]
    s_waitcnt lgkmcnt(0)
    s_barrier
    v_mfma_f32_16x16x32_bf16 a[128:131], v[208:211], v[84:87], a[128:131]
    buffer_load_dwordx4 a[92:95], v20, s[36:39], s62 offen offset:3072 sc1
    ds_read_b128 v[112:115], v41 offset:0
    v_mfma_f32_16x16x32_bf16 a[132:135], v[212:215], v[84:87], a[132:135]
    ds_read_b128 v[116:119], v41 offset:256
    v_mfma_f32_16x16x32_bf16 a[136:139], v[216:219], v[84:87], a[136:139]
    s_waitcnt vmcnt(10)
    v_swap_b32 v94, v96
    v_swap_b32 v95, v97
    v_mfma_f32_16x16x32_bf16 a[140:143], v[220:223], v[84:87], a[140:143]
    ds_read_b128 v[120:123], v41 offset:4096
    v_mfma_f32_16x16x32_bf16 a[128:131], v[224:227], v[92:95], a[128:131]
    ds_read_b128 v[124:127], v41 offset:4352
    v_mfma_f32_16x16x32_bf16 a[132:135], v[228:231], v[92:95], a[132:135]
    v_mfma_f32_16x16x32_bf16 a[136:139], v[232:235], v[92:95], a[136:139]
    s_waitcnt vmcnt(8)
    v_swap_b32 v102, v104
    v_swap_b32 v103, v105
    ds_read_b128 v[128:131], v41 offset:8192
    v_mfma_f32_16x16x32_bf16 a[140:143], v[236:239], v[92:95], a[140:143]
    ds_read_b128 v[132:135], v41 offset:8448
    v_mfma_f32_16x16x32_bf16 a[128:131], v[240:243], v[100:103], a[128:131]
    v_mfma_f32_16x16x32_bf16 a[132:135], v[244:247], v[100:103], a[132:135]
    ds_read_b128 v[136:139], v41 offset:12288
    v_mfma_f32_16x16x32_bf16 a[136:139], v[248:251], v[100:103], a[136:139]
    ds_read_b128 v[140:143], v41 offset:12544
    v_mfma_f32_16x16x32_bf16 a[140:143], v[252:255], v[100:103], a[140:143]
    s_waitcnt vmcnt(7)
    v_mfma_f32_16x16x32_bf16 a[144:147], a[192:195], a[64:67], 0
    s_waitcnt lgkmcnt(5)
    v_add_f32 v112, v112, v120
    v_add_f32 v113, v113, v121
    v_mfma_f32_16x16x32_bf16 a[148:151], a[196:199], a[64:67], 0
    v_add_f32 v114, v114, v122
    v_add_f32 v115, v115, v123
    v_mfma_f32_16x16x32_bf16 a[152:155], a[200:203], a[64:67], 0
    ds_write_b128 v4, a[128:131] offset:32768
    v_mfma_f32_16x16x32_bf16 a[156:159], a[204:207], a[64:67], 0
    s_waitcnt lgkmcnt(5)
    v_add_f32 v116, v116, v124
    s_waitcnt vmcnt(6)
    v_mfma_f32_16x16x32_bf16 a[144:147], a[208:211], a[68:71], a[144:147]
    v_add_f32 v117, v117, v125
    v_add_f32 v118, v118, v126
    v_mfma_f32_16x16x32_bf16 a[148:151], a[212:215], a[68:71], a[148:151]
    v_add_f32 v119, v119, v127
    s_waitcnt lgkmcnt(2)
    v_add_f32 v128, v128, v136
    v_mfma_f32_16x16x32_bf16 a[152:155], a[216:219], a[68:71], a[152:155]
    ds_write_b128 v5, a[132:135] offset:32768
    v_mfma_f32_16x16x32_bf16 a[156:159], a[220:223], a[68:71], a[156:159]
    v_add_f32 v129, v129, v137
    s_waitcnt vmcnt(5)
    v_mfma_f32_16x16x32_bf16 a[144:147], a[224:227], a[72:75], a[144:147]
    v_add_f32 v130, v130, v138
    v_add_f32 v131, v131, v139
    v_mfma_f32_16x16x32_bf16 a[148:151], a[228:231], a[72:75], a[148:151]
    s_waitcnt lgkmcnt(2)
    v_add_f32 v132, v132, v140
    v_add_f32 v133, v133, v141
    v_mfma_f32_16x16x32_bf16 a[152:155], a[232:235], a[72:75], a[152:155]
    ds_write_b128 v6, a[136:139] offset:32768
    v_mfma_f32_16x16x32_bf16 a[156:159], a[236:239], a[72:75], a[156:159]
    v_add_f32 v134, v134, v142
    s_waitcnt vmcnt(4)
    v_mfma_f32_16x16x32_bf16 a[144:147], a[240:243], a[76:79], a[144:147]
    v_add_f32 v135, v135, v143
    v_add_f32 v112, v112, v128
    v_mfma_f32_16x16x32_bf16 a[148:151], a[244:247], a[76:79], a[148:151]
    v_add_f32 v113, v113, v129
    v_add_f32 v114, v114, v130
    v_mfma_f32_16x16x32_bf16 a[152:155], a[248:251], a[76:79], a[152:155]
    ds_write_b128 v7, a[140:143] offset:32768
    v_mfma_f32_16x16x32_bf16 a[156:159], a[252:255], a[76:79], a[156:159]
    v_add_f32 v115, v115, v131
    s_waitcnt vmcnt(3)
    v_mfma_f32_16x16x32_bf16 a[144:147], v[144:147], a[80:83], a[144:147]
    v_add_f32 v116, v116, v132
    v_add_f32 v117, v117, v133
    v_mfma_f32_16x16x32_bf16 a[148:151], v[148:151], a[80:83], a[148:151]
    v_add_f32 v118, v118, v134
    v_add_f32 v119, v119, v135
    v_mfma_f32_16x16x32_bf16 a[152:155], v[152:155], a[80:83], a[152:155]
    v_lshlrev_b32 v76, 16, v32
    v_and_b32 v77, 0xffff0000, v32
    v_mfma_f32_16x16x32_bf16 a[156:159], v[156:159], a[80:83], a[156:159]
    v_lshlrev_b32 v78, 16, v33
    s_waitcnt vmcnt(2)
    v_mfma_f32_16x16x32_bf16 a[144:147], v[160:163], a[84:87], a[144:147]
    v_and_b32 v79, 0xffff0000, v33
    v_lshlrev_b32 v80, 16, v34
    v_mfma_f32_16x16x32_bf16 a[148:151], v[164:167], a[84:87], a[148:151]
    v_and_b32 v81, 0xffff0000, v34
    v_lshlrev_b32 v82, 16, v35
    v_mfma_f32_16x16x32_bf16 a[152:155], v[168:171], a[84:87], a[152:155]
    v_and_b32 v83, 0xffff0000, v35
    v_fma_f32 v112, v112, v68, v76
    v_mfma_f32_16x16x32_bf16 a[156:159], v[172:175], a[84:87], a[156:159]
    v_fma_f32 v113, v113, v69, v77
    s_waitcnt vmcnt(1)
    v_mfma_f32_16x16x32_bf16 a[144:147], v[176:179], a[88:91], a[144:147]
    v_fma_f32 v114, v114, v70, v78
    v_fma_f32 v115, v115, v71, v79
    v_mfma_f32_16x16x32_bf16 a[148:151], v[180:183], a[88:91], a[148:151]
    v_fma_f32 v116, v116, v72, v80
    v_fma_f32 v117, v117, v73, v81
    v_mfma_f32_16x16x32_bf16 a[152:155], v[184:187], a[88:91], a[152:155]
    v_fma_f32 v118, v118, v74, v82
    v_fma_f32 v119, v119, v75, v83
    v_mfma_f32_16x16x32_bf16 a[156:159], v[188:191], a[88:91], a[156:159]
    v_cvt_pk_bf16_f32 v28, v112, v113
    s_waitcnt vmcnt(0)
    v_mfma_f32_16x16x32_bf16 a[144:147], v[192:195], a[92:95], a[144:147]
    v_cvt_pk_bf16_f32 v29, v114, v115
    v_cvt_pk_bf16_f32 v30, v116, v117
    v_mfma_f32_16x16x32_bf16 a[148:151], v[196:199], a[92:95], a[148:151]
    v_cvt_pk_bf16_f32 v31, v118, v119
    v_mfma_f32_16x16x32_bf16 a[152:155], v[200:203], a[92:95], a[152:155]
    global_store_dwordx4 v42, v[28:31], s[22:23] sc1
    v_mfma_f32_16x16x32_bf16 a[156:159], v[204:207], a[92:95], a[156:159]
    v_mfma_f32_16x16x32_bf16 a[144:147], v[208:211], v[88:91], a[144:147]
    v_mfma_f32_16x16x32_bf16 a[144:147], v[224:227], v[96:99], a[144:147]
    v_mfma_f32_16x16x32_bf16 a[144:147], v[240:243], v[104:107], a[144:147]
    v_mfma_f32_16x16x32_bf16 a[148:151], v[212:215], v[88:91], a[148:151]
    v_mfma_f32_16x16x32_bf16 a[148:151], v[228:231], v[96:99], a[148:151]
    v_mfma_f32_16x16x32_bf16 a[148:151], v[244:247], v[104:107], a[148:151]
    s_nop 4
    ds_write_b128 v4, a[144:147] offset:49152
    v_mfma_f32_16x16x32_bf16 a[152:155], v[216:219], v[88:91], a[152:155]
    v_mfma_f32_16x16x32_bf16 a[152:155], v[232:235], v[96:99], a[152:155]
    v_mfma_f32_16x16x32_bf16 a[152:155], v[248:251], v[104:107], a[152:155]
    ds_write_b128 v5, a[148:151] offset:49152
    v_mfma_f32_16x16x32_bf16 a[156:159], v[220:223], v[88:91], a[156:159]
    v_mfma_f32_16x16x32_bf16 a[156:159], v[236:239], v[96:99], a[156:159]
    v_mfma_f32_16x16x32_bf16 a[156:159], v[252:255], v[104:107], a[156:159]
    s_nop 3
    ds_write_b128 v6, a[152:155] offset:49152
    s_nop 2
    ds_write_b128 v7, a[156:159] offset:49152
    s_waitcnt lgkmcnt(0)
    s_barrier
    ds_read_b128 v[112:115], v41 offset:32768
    ds_read_b128 v[116:119], v41 offset:33024
    ds_read_b128 v[120:123], v41 offset:36864
    ds_read_b128 v[124:127], v41 offset:37120
    ds_read_b128 v[128:131], v41 offset:40960
    ds_read_b128 v[132:135], v41 offset:41216
    ds_read_b128 v[136:139], v41 offset:45056
    ds_read_b128 v[140:143], v41 offset:45312
    v_lshlrev_b32 v76, 16, v36
    v_and_b32 v77, 0xffff0000, v36
    v_lshlrev_b32 v78, 16, v37
    v_and_b32 v79, 0xffff0000, v37
    v_lshlrev_b32 v80, 16, v38
    v_and_b32 v81, 0xffff0000, v38
    v_lshlrev_b32 v82, 16, v39
    v_and_b32 v83, 0xffff0000, v39
    s_waitcnt lgkmcnt(5)
    v_pk_add_f32 v[112:113], v[112:113], v[120:121]
    v_pk_add_f32 v[114:115], v[114:115], v[122:123]
    s_waitcnt lgkmcnt(4)
    v_pk_add_f32 v[116:117], v[116:117], v[124:125]
    v_pk_add_f32 v[118:119], v[118:119], v[126:127]
    s_waitcnt lgkmcnt(1)
    v_pk_add_f32 v[128:129], v[128:129], v[136:137]
    v_pk_add_f32 v[130:131], v[130:131], v[138:139]
    s_waitcnt lgkmcnt(0)
    v_pk_add_f32 v[132:133], v[132:133], v[140:141]
    v_pk_add_f32 v[134:135], v[134:135], v[142:143]
    v_pk_add_f32 v[112:113], v[112:113], v[128:129]
    v_pk_add_f32 v[114:115], v[114:115], v[130:131]
    v_pk_add_f32 v[116:117], v[116:117], v[132:133]
    v_pk_add_f32 v[118:119], v[118:119], v[134:135]
    v_pk_fma_f32 v[112:113], v[112:113], v[68:69], v[76:77]
    v_pk_fma_f32 v[114:115], v[114:115], v[70:71], v[78:79]
    v_pk_fma_f32 v[116:117], v[116:117], v[72:73], v[80:81]
    v_pk_fma_f32 v[118:119], v[118:119], v[74:75], v[82:83]
    v_cvt_pk_bf16_f32 v28, v112, v113
    v_cvt_pk_bf16_f32 v29, v114, v115
    v_cvt_pk_bf16_f32 v30, v116, v117
    v_cvt_pk_bf16_f32 v31, v118, v119
    global_store_dwordx4 v43, v[28:31], s[22:23] sc1
L_end_s:
    s_endpgm
L_A_retry:
    s_sub_u32 s61, s61, 1
    s_cbranch_scc1 L_A_giveup
    global_load_dwordx4 v[236:239], v104, s[26:27] sc1
    global_load_dwordx4 v[232:235], v105, s[26:27] sc1
    global_load_dwordx4 v[228:231], v106, s[26:27] sc1
    global_load_dwordx4 v[224:227], v107, s[26:27] sc1
    global_load_dwordx2 v[252:253], v108, s[26:27] sc1
    s_waitcnt vmcnt(0) lgkmcnt(0)
    s_branch L_A
L_A_giveup:
    s_mov_b32 s61, 0
    s_branch L_A_ok
L_B_retry:
    s_sub_u32 s61, s61, 1
    s_cbranch_scc1 L_B_giveup
    global_load_dwordx4 v[120:123], v16, s[26:27] offset:0 sc1
    global_load_dwordx4 v[124:127], v16, s[26:27] offset:1024 sc1
    global_load_dwordx4 v[128:131], v16, s[26:27] offset:2048 sc1
    global_load_dwordx4 v[132:135], v16, s[26:27] offset:3072 sc1
    s_waitcnt vmcnt(0) lgkmcnt(0)
    s_branch L_B
L_B_giveup:
    s_mov_b32 s61, 0
    s_branch L_B_ok
L_M_retry:
    s_sub_u32 s61, s61, 1
    s_cbranch_scc1 L_M_giveup
    global_load_dwordx4 v[104:107], v8, s[26:27] offset:-2048 sc1
    global_load_dwordx4 v[108:111], v8, s[26:27] offset:2048 sc1
    global_load_dwordx4 v[112:115], v9, s[26:27] offset:-2048 sc1
    global_load_dwordx4 v[116:119], v9, s[26:27] offset:2048 sc1
    s_waitcnt vmcnt(0) lgkmcnt(0)
    s_branch L_M
L_M_giveup:
    s_mov_b32 s61, 0
    s_branch L_M_ok
L_C_retry:
    s_sub_u32 s61, s61, 1
    s_cbranch_scc1 L_C_giveup
    global_load_dwordx4 v[120:123], v8, s[26:27] offset:-2048 sc1
    global_load_dwordx4 v[124:127], v8, s[26:27] offset:2048 sc1
    global_load_dwordx4 v[128:131], v9, s[26:27] offset:-2048 sc1
    global_load_dwordx4 v[132:135], v9, s[26:27] offset:2048 sc1
    s_waitcnt vmcnt(0) lgkmcnt(0)
    s_branch L_C
L_C_giveup:
    s_mov_b32 s61, 0
    s_branch L_C_ok
L_D0_retry:
    s_sub_u32 s61, s61, 1
    s_cbranch_scc1 L_D0_giveup
    s_branch L_D0
L_D0_giveup:
    s_mov_b32 s61, 0
    s_branch L_D0_ok
L_F0_retry:
    s_sub_u32 s61, s61, 1
    s_cbranch_scc1 L_F0_giveup
    global_load_dword v16, v3, s[26:27] offset:0 nt
    s_waitcnt vmcnt(0) lgkmcnt(0)
    s_branch L_F0
L_F0_giveup:
    s_mov_b32 s61, 0
    s_branch L_F0_ok
L_F1_retry:
    s_sub_u32 s61, s61, 1
    s_cbranch_scc1 L_F1_giveup
    global_load_dword v16, v3, s[26:27] offset:128 nt
    s_waitcnt vmcnt(0) lgkmcnt(0)
    s_branch L_F1
L_F1_giveup:
    s_mov_b32 s61, 0
    s_branch L_F1_ok
L_F2_retry:
    s_sub_u32 s61, s61, 1
    s_cbranch_scc1 L_F2_giveup
    global_load_dword v16, v3, s[26:27] offset:256 nt
    s_waitcnt vmcnt(0) lgkmcnt(0)
    s_branch L_F2
L_F2_giveup:
    s_mov_b32 s61, 0
    s_branch L_F2_ok
L_F3_retry:
    s_sub_u32 s61, s61, 1
    s_cbranch_scc1 L_F3_giveup
    global_load_dword v16, v3, s[26:27] offset:384 nt
    s_waitcnt vmcnt(0) lgkmcnt(0)
    s_branch L_F3
L_F3_giveup:
    s_mov_b32 s61, 0
    s_branch L_F3_ok
L_B_retry_s:
    s_sub_u32 s61, s61, 1
    s_cbranch_scc1 L_B_giveup_s
    global_load_dwordx4 v[120:123], v16, s[26:27] offset:0 sc1
    global_load_dwordx4 v[124:127], v16, s[26:27] offset:1024 sc1
    global_load_dwordx4 v[128:131], v16, s[26:27] offset:2048 sc1
    global_load_dwordx4 v[132:135], v16, s[26:27] offset:3072 sc1
    s_waitcnt vmcnt(0) lgkmcnt(0)
    s_branch L_B_s
L_B_giveup_s:
    s_mov_b32 s61, 0
    s_branch L_B_ok_s
L_M_retry_s:
    s_sub_u32 s61, s61, 1
    s_cbranch_scc1 L_M_giveup_s
    global_load_dwordx4 v[104:107], v8, s[26:27] offset:-2048 sc1
    global_load_dwordx4 v[108:111], v8, s[26:27] offset:2048 sc1
    global_load_dwordx4 v[112:115], v9, s[26:27] offset:-2048 sc1
    global_load_dwordx4 v[116:119], v9, s[26:27] offset:2048 sc1
    s_waitcnt vmcnt(0) lgkmcnt(0)
    s_branch L_M_s
L_M_giveup_s:
    s_mov_b32 s61, 0
    s_branch L_M_ok_s
L_C_retry_s:
    s_sub_u32 s61, s61, 1
    s_cbranch_scc1 L_C_giveup_s
    global_load_dwordx4 v[120:123], v8, s[26:27] offset:-2048 sc1
    global_load_dwordx4 v[124:127], v8, s[26:27] offset:2048 sc1
    global_load_dwordx4 v[128:131], v9, s[26:27] offset:-2048 sc1
    global_load_dwordx4 v[132:135], v9, s[26:27] offset:2048 sc1
    s_waitcnt vmcnt(0) lgkmcnt(0)
    s_branch L_C_s
L_C_giveup_s:
    s_mov_b32 s61, 0
    s_branch L_C_ok_s
L_D0_retry_s:
    s_sub_u32 s61, s61, 1
    s_cbranch_scc1 L_D0_giveup_s
    s_branch L_D0_s
L_D0_giveup_s:
    s_mov_b32 s61, 0
    s_branch L_D0_ok_s
L_F0_retry_s:
    s_sub_u32 s61, s61, 1
    s_cbranch_scc1 L_F0_giveup_s
    global_load_dword v16, v3, s[26:27] offset:0 sc1
    s_waitcnt vmcnt(0) lgkmcnt(0)
    s_branch L_F0_s
L_F0_giveup_s:
    s_mov_b32 s61, 0
    s_branch L_F0_ok_s
L_F1_retry_s:
    s_sub_u32 s61, s61, 1
    s_cbranch_scc1 L_F1_giveup_s
    global_load_dword v16, v3, s[26:27] offset:128 sc1
    s_waitcnt vmcnt(0) lgkmcnt(0)
    s_branch L_F1_s
L_F1_giveup_s:
    s_mov_b32 s61, 0
    s_branch L_F1_ok_s
L_F2_retry_s:
    s_sub_u32 s61, s61, 1
    s_cbranch_scc1 L_F2_giveup_s
    global_load_dword v16, v3, s[26:27] offset:256 sc1
    s_waitcnt vmcnt(0) lgkmcnt(0)
    s_branch L_F2_s
L_F2_giveup_s:
    s_mov_b32 s61, 0
    s_branch L_F2_ok_s
L_F3_retry_s:
    s_sub_u32 s61, s61, 1
    s_cbranch_scc1 L_F3_giveup_s
    global_load_dword v16, v3, s[26:27] offset:384 sc1
    s_waitcnt vmcnt(0) lgkmcnt(0)
    s_branch L_F3_s
L_F3_giveup_s:
    s_mov_b32 s61, 0
    s_branch L_F3_ok_s
.section .rodata,"a"
.p2align 6
.amdhsa_kernel adaLN_cond__spectral_gfnet__dense_activation_mish__prompt_kernel
  .amdhsa_next_free_vgpr 512
  .amdhsa_next_free_sgpr 102
  .amdhsa_accum_offset 256
  .amdhsa_group_segment_fixed_size 0
  .amdhsa_kernarg_size 96
  .amdhsa_user_sgpr_count 2
  .amdhsa_user_sgpr_kernarg_segment_ptr 1
  .amdhsa_system_sgpr_workgroup_id_x 1
.end_amdhsa_kernel
```
